```python
import torch

def _softmax(x, axis=-1):
    return torch.softmax(x, dim=axis)
def _gelu(x):
    return torch.nn.functional.gelu(x, approximate="tanh")
def _silu(x):
    return torch.nn.functional.silu(x)
def _sigmoid(x):
    return torch.sigmoid(x)
def _layernorm(x, axis=-1, eps=1e-5):
    m = x.mean(dim=axis, keepdim=True)
    v = x.var(dim=axis, keepdim=True, unbiased=False)
    return (x - m) / torch.sqrt(v + eps)
def _scatter_add(tgt, idx, src, axis=0):
    return tgt.clone().index_add_(axis, idx, src)
def _segment_sum(src, seg, n):
    out = torch.zeros((n,) + src.shape[1:], dtype=src.dtype)
    return out.index_add_(0, seg, src)
def _pad(x, pw):
    flat = tuple(v for pair in reversed(pw) for v in pair)
    return torch.nn.functional.pad(x, flat)

kernel_name = 'gated_mix__linear_kernel_hedgehog__dense_activation_gelu__prompt'

def setup_inputs():

    _w = (lambda a: (lambda t: t.to(torch.bfloat16) if t.is_floating_point() else t)(torch.as_tensor(a)))
    def _A_setup():
        B, S, D, H = 1, 2048, 448, 16
        Dh = D // H
        return {
            "x": _w((lambda *s: torch.randn(*s, dtype=torch.bfloat16) * 0.05)(B, S, D)),
            "wqkv": _w((lambda *s: torch.randn(*s, dtype=torch.bfloat16) * 0.8)(D, 3 * D)),
            "w_phi": _w((lambda *s: torch.randn(*s, dtype=torch.bfloat16) * 0.8)(H, Dh, Dh) * (Dh ** -0.5)),
            "wo": _w((lambda *s: torch.randn(*s, dtype=torch.bfloat16) * 0.05)(D, D)),
        }
    _A_in = _A_setup()

    def _B_setup():
        B, S, D, F = 1, 2048, 448, 1792
        return {
            "x": _w((lambda *s: torch.randn(*s, dtype=torch.bfloat16) * 0.05)(B, S, D)),
            "w1": _w((lambda *s: torch.randn(*s, dtype=torch.bfloat16) * 3.2)(D, F) * (D ** -0.5)),
            "b1": _w((lambda *s: torch.randn(*s, dtype=torch.bfloat16) * 3.2)(F) * 0.01),
            "w2": _w((lambda *s: torch.randn(*s, dtype=torch.bfloat16) * 0.2)(F, D) * (F ** -0.5)),
            "b2": _w((lambda *s: torch.randn(*s, dtype=torch.bfloat16) * 0.4)(D) * 0.01),
        }
    _B_in = _B_setup()

    return {
        "A_x": _A_in["x"],
        "A_wqkv": _A_in["wqkv"],
        "A_w_phi": _A_in["w_phi"],
        "A_wo": _A_in["wo"],
        "B_x": _B_in["x"],
        "B_w1": _B_in["w1"],
        "B_b1": _B_in["b1"],
        "B_w2": _B_in["w2"],
        "B_b2": _B_in["b2"],
        "gate_w": _w((lambda *s: torch.randn(*s, dtype=torch.bfloat16) * 0.05)(448) * 16.0),
    }

def reference(A_x, A_wqkv, A_w_phi, A_wo, B_x, B_w1, B_b1, B_w2, B_b2, gate_w):
    def _A_ref(x, wqkv, w_phi, wo):
        B, S, D = x.shape
        H = 16; Dh = D // H
        qkv = (lambda x, *d: x.permute(*d))((x @ wqkv).reshape(B, S, 3, H, Dh), 2, 0, 3, 1, 4)
        q, k, v = qkv[0], qkv[1], qkv[2]
        pq = torch.einsum("bhsd,hdf->bhsf", q, w_phi)
        pk = torch.einsum("bhsd,hdf->bhsf", k, w_phi)
        phi_q = torch.concatenate([_softmax(pq, axis=-1), _softmax(-pq, axis=-1)], axis=-1)
        phi_k = torch.concatenate([_softmax(pk, axis=-1), _softmax(-pk, axis=-1)], axis=-1)
        kv = torch.einsum("bhsf,bhsd->bhfd", phi_k, v)
        z  = torch.einsum("bhsf->bhf", phi_k)
        num = torch.einsum("bhqf,bhfd->bhqd", phi_q, kv)
        den = torch.einsum("bhqf,bhf->bhq", phi_q, z)[..., None] + 1e-6
        o = num / den
        return (lambda x, *d: x.permute(*d))(o, 0, 2, 1, 3).reshape(B, S, D) @ wo

    def _B_ref(x, w1, b1, w2, b2):
        h = torch.einsum("bsd,df->bsf", x, w1) + b1
        h = _gelu(h)
        return torch.einsum("bsf,fd->bsd", h, w2) + b2

    x = A_x
    g = _sigmoid((x * gate_w).sum(-1, keepdims=True))
    a = _A_ref(x, A_wqkv, A_w_phi, A_wo)
    b = _B_ref(x, B_w1, B_b1, B_w2, B_b2)
    return g * a + (1 - g) * b
```

```asm
; @launch grid=(256,1,1) block=(512,1,1) lds=163840
.amdgcn_target "amdgcn-amd-amdhsa--gfx950"
.text
.globl gated_mix__linear_kernel_hedgehog__dense_activation_gelu__prompt_kernel
.p2align 8
.type gated_mix__linear_kernel_hedgehog__dense_activation_gelu__prompt_kernel,@function
gated_mix__linear_kernel_hedgehog__dense_activation_gelu__prompt_kernel:
    s_cmp_ge_u32 s2, 256
    s_cbranch_scc1 the_end
    s_load_dwordx2 s[4:5], s[0:1], 0
    s_cmp_lt_u32 s2, 128
    s_cbranch_scc1 role_attn
    s_load_dwordx2 s[8:9], s[0:1], 40
    s_load_dwordx2 s[16:17], s[0:1], 48
    s_load_dwordx2 s[12:13], s[0:1], 96
    s_load_dwordx2 s[40:41], s[0:1], 88
    s_load_dwordx2 s[24:25], s[0:1], 56
    s_load_dwordx2 s[28:29], s[0:1], 24
    s_load_dwordx2 s[32:33], s[0:1], 64
    s_load_dwordx2 s[36:37], s[0:1], 80
    v_and_b32 v1, 63, v0
    v_lshrrev_b32 v12, 6, v0
    s_nop 0
    v_readfirstlane_b32 s47, v12
    s_and_b32 s62, s2, 7
    s_bfe_u32 s65, s2, 0x20003
    s_and_b32 s64, s62, 6
    s_lshl_b32 s64, s64, 1
    s_add_u32 s44, s64, s65
    s_bfe_u32 s65, s2, 0x20005
    s_and_b32 s64, s62, 1
    s_lshl_b32 s64, s64, 2
    s_add_u32 s45, s64, s65
    s_cmp_eq_u32 s62, 7
    s_cselect_b32 s48, 3, s62
    s_mul_i32 s51, s44, 114688
    s_lshl_b32 s55, s47, 10
    s_mov_b32 s6, 0x1c0000
    s_mov_b32 s7, 0x20000
    s_mov_b32 s10, 0x188000
    s_mov_b32 s11, 0x20000
    s_mov_b32 s18, 0xe00
    s_mov_b32 s19, 0x20000
    v_lshrrev_b32 v12, 3, v1
    s_lshl_b32 s62, s47, 4
    v_add_u32 v13, s62, v12
    v_mul_u32_u24 v13, 896, v13
    v_and_b32 v14, 7, v1
    v_lshrrev_b32 v15, 4, v1
    v_xor_b32 v15, v14, v15
    v_lshl_add_u32 v2, v15, 4, v13
    v_xor_b32 v3, 64, v2
    v_add_u32 v3, 7168, v3
    s_lshl_b32 s62, s47, 3
    v_add_u32 v13, s62, v12
    v_mul_u32_u24 v13, 3584, v13
    v_lshrrev_b32 v15, 2, v1
    s_and_b32 s63, s47, 3
    s_lshl_b32 s63, s63, 4
    v_add_u32 v242, s63, v15
    v_mul_u32_u24 v242, 3584, v242
    v_and_b32 v16, 3, v1
    v_lshl_add_u32 v242, v16, 4, v242
    v_and_b32 v15, 4, v15
    v_xor_b32 v15, v14, v15
    v_lshl_add_u32 v4, v15, 4, v13
    v_mul_u32_u24 v243, 896, v12
    v_lshl_add_u32 v243, v15, 4, v243
    s_mul_i32 s62, s45, 448
    s_and_b32 s63, s45, 1
    s_lshl_b32 s64, s63, 6
    s_add_u32 s52, s62, s64
    s_mov_b32 s56, -320
    s_cmp_eq_u32 s63, 0
    s_cselect_b32 s56, 128, s56
    s_waitcnt lgkmcnt(0)
    s_lshl_b32 s3, s55, 1
    s_add_u32 m0, s3, 0x8000
    s_lshl_b32 s49, s48, 7
    s_add_u32 s49, s49, s51
    buffer_load_dwordx4 v2, s[4:7], s49 offen lds
    s_add_u32 m0, s55, 0xc000
    s_mul_i32 s50, s48, 229376
    s_add_u32 s50, s50, s52
    buffer_load_dwordx4 v4, s[8:11], s50 offen lds
    s_lshl_b32 s3, s55, 1
    s_add_u32 m0, s3, 0x8400
    s_nop 0
    buffer_load_dwordx4 v3, s[4:7], s49 offen lds
    s_add_u32 m0, s55, 0xe000
    s_add_u32 s50, s50, 128
    buffer_load_dwordx4 v4, s[8:11], s50 offen lds
    s_add_u32 s48, s48, 1
    s_cmp_eq_u32 s48, 7
    s_cselect_b32 s48, 0, s48
    s_lshr_b32 s62, s47, 2
    s_lshl_b32 s63, s62, 8
    s_add_u32 s20, s52, s63
    s_add_u32 s21, s20, 64
    s_add_u32 s23, s20, 192
    s_cmp_eq_u32 s62, 0
    s_cselect_b32 s63, 128, s56
    s_add_u32 s22, s20, s63
    v_and_b32 v12, 31, v1
    v_lshlrev_b32 v12, 1, v12
    buffer_load_ushort v20, v12, s[16:19], s20 offen
    buffer_load_ushort v22, v12, s[16:19], s21 offen
    buffer_load_ushort v24, v12, s[16:19], s22 offen
    buffer_load_ushort v26, v12, s[16:19], s23 offen
    s_mov_b32 s14, 0x10000000
    s_mov_b32 s15, 0x20000
    s_mov_b32 s42, 0x100
    s_mov_b32 s43, 0x20000
    s_mov_b32 s26, 0x188000
    s_mov_b32 s27, 0x20000
    s_mov_b32 s30, 0x62000
    s_mov_b32 s31, 0x20000
    s_mov_b32 s34, 0x380
    s_mov_b32 s35, 0x20000
    s_mov_b32 s38, 0x1c0000
    s_mov_b32 s39, 0x20000
    v_mov_b32 v21, 0
    v_mov_b32 v23, 0
    v_mov_b32 v25, 0
    v_mov_b32 v27, 0
    v_mov_b32 v29, 0
    v_mov_b32 v30, 0
    v_mov_b32 v31, 0
    v_mov_b32 v28, 0x3f80
    s_mov_b32 exec_lo, 0
    v_mov_b32 v28, 0
    s_mov_b32 exec_lo, -1
    s_and_b32 s62, s47, 3
    s_lshl_b32 s62, s62, 5
    v_and_b32 v12, 31, v1
    v_add_u32 v12, s62, v12
    v_bfe_u32 v13, v12, 1, 3
    v_lshrrev_b32 v14, 5, v1
    v_xor_b32 v13, v13, v14
    v_lshlrev_b32 v13, 4, v13
    v_lshl_add_u32 v5, v12, 7, v13
    v_add_u32 v5, 32768, v5
    v_xor_b32 v6, 32, v5
    v_xor_b32 v7, 64, v5
    v_xor_b32 v8, 96, v5
    v_bfe_u32 v12, v1, 2, 2
    v_lshrrev_b32 v13, 5, v1
    v_lshl_add_u32 v12, v13, 3, v12
    v_and_b32 v13, 3, v1
    v_lshlrev_b32 v13, 3, v13
    v_and_b32 v14, 16, v1
    v_lshl_add_u32 v13, v14, 1, v13
    v_and_b32 v14, 8, v1
    v_lshlrev_b32 v14, 3, v14
    v_lshl_add_u32 v241, v12, 6, v13
    v_add_u32 v241, 65536, v241
    v_xor_b32 v13, v13, v14
    v_lshl_add_u32 v12, v12, 7, v13
    s_mov_b32 s63, 98304
    s_cmp_lt_u32 s47, 4
    s_cselect_b32 s63, 32768, s63
    v_add_u32 v9, s63, v12
    v_xor_b32 v10, 64, v9
    v_mov_b32 v252, 0xc0135761
    v_mov_b32 v253, 0xc0135761
    s_mov_b32 s58, 0xbdd2d3e8
    s_mov_b32 s59, 0xbdd2d3e8
    s_and_b32 s63, s47, 3
    s_lshl_b32 s64, s44, 2
    s_add_u32 s63, s63, s64
    s_mul_i32 s63, s63, 114688
    s_lshl_b32 s20, s20, 5
    s_add_u32 s20, s20, s63
    s_lshl_b32 s21, s21, 5
    s_add_u32 s21, s21, s63
    s_lshl_b32 s22, s22, 5
    s_add_u32 s22, s22, s63
    s_lshl_b32 s23, s23, 5
    s_add_u32 s23, s23, s63
    s_lshl_b32 s57, s44, 3
    s_add_u32 s57, s57, s45
    s_lshl_b32 s57, s57, 5
    s_add_u32 s57, s57, s47
    s_lshl_b32 s57, s57, 2
    s_add_u32 s57, s57, 0x1500000
    s_bfe_u32 s65, s2, 0x20003
    s_bfe_u32 s54, s2, 0x20005
    s_and_b32 s62, s2, 6
    s_lshl_b32 s62, s62, 3
    s_lshr_b32 s63, s47, 2
    s_xor_b32 s63, s63, s2
    s_andn2_b32 s63, 1, s63
    s_cmp_eq_u32 s54, 0
    s_cselect_b32 s64, 3, s65
    s_add_u32 s54, s54, 3
    s_cmp_eq_u32 s54, 3
    s_cselect_b32 s54, s65, s54
    s_lshl_b32 s64, s64, 2
    s_add_u32 s62, s62, s64
    s_mul_i32 s62, s62, 65793
    s_mul_i32 s63, s63, 514
    s_add_u32 s62, s62, s63
    s_add_u32 s62, s62, 256
    s_and_b32 s63, s2, 1
    s_lshl_b32 s63, s63, 1
    s_lshr_b32 s64, s47, 2
    s_add_u32 s63, s63, s64
    s_lshl_b32 s63, s63, 16
    s_add_u32 s53, s62, s63
    s_lshl_b32 s64, s65, 1
    s_add_u32 s64, s54, s64
    s_and_b32 s62, s64, 3
    s_lshl_b32 s62, s62, 2
    s_and_b32 s65, s47, 1
    s_lshr_b32 s63, 0x2103210, s62
    s_and_b32 s63, s63, 65535
    s_mul_i32 s62, s64, 86
    s_lshr_b32 s62, s62, 8
    s_mul_i32 s62, s62, 3
    s_sub_u32 s62, s64, s62
    s_lshl_b32 s62, s62, 2
    s_mov_b32 s64, 0x54654
    s_cmp_eq_u32 s65, 1
    s_cselect_b32 s64, 0x65065, s64
    s_lshr_b32 s64, s64, s62
    s_and_b32 s64, s64, 4095
    s_lshl_b32 s64, s64, 16
    s_mul_i32 s65, s65, 4369
    s_add_u32 s63, s63, s65
    s_or_b32 s46, s63, s64
    v_lshlrev_b32 v244, 4, v1
    s_and_b32 s63, s2, 1
    s_lshl_b32 s63, s63, 2
    s_and_b32 s62, s47, 3
    s_add_u32 s63, s63, s62
    s_mul_i32 s0, s63, 200704
    s_lshl_b32 s62, s54, 7
    s_add_u32 s0, s0, s62
    s_lshr_b32 s62, s47, 2
    s_mul_i32 s62, s62, 14336
    s_add_u32 s0, s0, s62
    v_bfe_u32 v249, v1, 2, 2
    v_lshrrev_b32 v250, 5, v1
    v_lshl_add_u32 v249, v250, 2, v249
    v_and_b32 v250, 3, v1
    v_lshlrev_b32 v250, 3, v250
    v_and_b32 v251, 16, v1
    v_lshl_add_u32 v250, v251, 1, v250
    v_and_b32 v251, 8, v1
    v_lshlrev_b32 v251, 3, v251
    v_xor_b32 v250, v250, v251
    v_lshl_add_u32 v249, v249, 7, v250
    s_and_b32 s62, s47, 3
    s_lshl_b32 s62, s62, 12
    v_add_u32 v245, s62, v249
    s_and_b32 s63, s47, 4
    s_lshl_b32 s63, s63, 9
    s_add_u32 s61, s62, s63
    v_add_u32 v251, 6144, v243
    s_lshl_b32 s3, s55, 1
    s_add_u32 m0, s3, 0x10000
    s_lshl_b32 s49, s48, 7
    s_add_u32 s49, s49, s51
    buffer_load_dwordx4 v2, s[4:7], s49 offen lds
    s_add_u32 m0, s55, 0x14000
    s_mul_i32 s50, s48, 229376
    s_add_u32 s50, s50, s52
    buffer_load_dwordx4 v4, s[8:11], s50 offen lds
    s_lshl_b32 s3, s55, 1
    s_add_u32 m0, s3, 0x10400
    s_nop 0
    buffer_load_dwordx4 v3, s[4:7], s49 offen lds
    s_add_u32 m0, s55, 0x16000
    s_add_u32 s50, s50, 128
    buffer_load_dwordx4 v4, s[8:11], s50 offen lds
    s_add_u32 s48, s48, 1
    s_cmp_eq_u32 s48, 7
    s_cselect_b32 s48, 0, s48
    s_getpc_b64 s[64:65]
pc_1:
    s_sub_u32 s64, s64, pc_1-gated_mix__linear_kernel_hedgehog__dense_activation_gelu__prompt_kernel
    s_subb_u32 s65, s65, 0
    s_and_b32 s62, s2, -8
    s_add_u32 s62, s62, s47
    s_lshl_b32 s62, s62, 7
    v_lshlrev_b32 v250, 15, v1
    v_add_u32 v250, s62, v250
    s_mov_b32 s62, code_end-gated_mix__linear_kernel_hedgehog__dense_activation_gelu__prompt_kernel-4
    v_min_u32 v250, s62, v250
    s_mov_b64 exec, 3
    global_load_dword v249, v250, s[64:65]
    s_mov_b64 exec, -1
    s_mov_b32 s67, 2
    s_cmp_ge_u32 s47, 4
    s_cbranch_scc1 ffn_ch1
    s_waitcnt vmcnt(5)
    s_barrier
    ds_read_b128 v[64:67], v5
    ds_read_b64_tr_b16 v[68:69], v9 offset:16384
    ds_read_b64_tr_b16 v[70:71], v9 offset:16896
    ds_read_b64_tr_b16 v[72:73], v10 offset:16384
    ds_read_b64_tr_b16 v[74:75], v10 offset:16896
    ds_read_b64_tr_b16 v[76:77], v9 offset:24576
    ds_read_b64_tr_b16 v[78:79], v9 offset:25088
    ds_read_b64_tr_b16 v[80:81], v10 offset:24576
    ds_read_b64_tr_b16 v[82:83], v10 offset:25088
    ds_read_b128 v[208:211], v6
    ds_read_b64_tr_b16 v[212:213], v9 offset:18432
    ds_read_b64_tr_b16 v[214:215], v9 offset:18944
    ds_read_b64_tr_b16 v[216:217], v10 offset:18432
    ds_read_b64_tr_b16 v[218:219], v10 offset:18944
    ds_read_b64_tr_b16 v[220:221], v9 offset:26624
    ds_read_b64_tr_b16 v[222:223], v9 offset:27136
    ds_read_b64_tr_b16 v[224:225], v10 offset:26624
    ds_read_b64_tr_b16 v[226:227], v10 offset:27136
    v_mfma_f32_32x32x16_bf16 v[32:47], v[20:23], v[28:31], 0
    v_mfma_f32_32x32x16_bf16 v[48:63], v[22:25], v[28:31], 0
    v_mfma_f32_32x32x16_bf16 v[96:111], v[24:27], v[28:31], 0
    v_mfma_f32_32x32x16_bf16 v[112:127], v[26:29], v[28:31], 0
    s_waitcnt lgkmcnt(9)
    v_mfma_f32_32x32x16_bf16 v[32:47], v[68:71], v[64:67], v[32:47]
    ds_read_b128 v[84:87], v7
    ds_read_b64_tr_b16 v[88:89], v9 offset:20480
    ds_read_b64_tr_b16 v[90:91], v9 offset:20992
    v_mfma_f32_32x32x16_bf16 v[48:63], v[72:75], v[64:67], v[48:63]
    ds_read_b64_tr_b16 v[92:93], v10 offset:20480
    ds_read_b64_tr_b16 v[94:95], v10 offset:20992
    ds_read_b64_tr_b16 v[228:229], v9 offset:28672
    v_mfma_f32_32x32x16_bf16 v[96:111], v[76:79], v[64:67], v[96:111]
    ds_read_b64_tr_b16 v[230:231], v9 offset:29184
    ds_read_b64_tr_b16 v[232:233], v10 offset:28672
    ds_read_b64_tr_b16 v[234:235], v10 offset:29184
    v_mfma_f32_32x32x16_bf16 v[112:127], v[80:83], v[64:67], v[112:127]
    s_waitcnt lgkmcnt(9)
    v_mfma_f32_32x32x16_bf16 v[32:47], v[212:215], v[208:211], v[32:47]
    ds_read_b128 v[64:67], v8
    ds_read_b64_tr_b16 v[68:69], v9 offset:22528
    ds_read_b64_tr_b16 v[70:71], v9 offset:23040
    v_mfma_f32_32x32x16_bf16 v[48:63], v[216:219], v[208:211], v[48:63]
    ds_read_b64_tr_b16 v[72:73], v10 offset:22528
    ds_read_b64_tr_b16 v[74:75], v10 offset:23040
    ds_read_b64_tr_b16 v[76:77], v9 offset:30720
    v_mfma_f32_32x32x16_bf16 v[96:111], v[220:223], v[208:211], v[96:111]
    ds_read_b64_tr_b16 v[78:79], v9 offset:31232
    ds_read_b64_tr_b16 v[80:81], v10 offset:30720
    ds_read_b64_tr_b16 v[82:83], v10 offset:31232
    v_mfma_f32_32x32x16_bf16 v[112:127], v[224:227], v[208:211], v[112:127]
    s_waitcnt vmcnt(1) lgkmcnt(0)
    s_barrier
    v_mfma_f32_32x32x16_bf16 v[32:47], v[88:91], v[84:87], v[32:47]
    v_add_u32 v5, 0x8000, v5
    v_add_u32 v6, 0x8000, v6
    v_add_u32 v7, 0x8000, v7
    v_add_u32 v8, 0x8000, v8
    v_add_u32 v9, 0x8000, v9
    v_add_u32 v10, 0x8000, v10
    ds_read_b128 v[208:211], v5
    ds_read_b64_tr_b16 v[212:213], v9 offset:16384
    ds_read_b64_tr_b16 v[214:215], v9 offset:16896
    v_mfma_f32_32x32x16_bf16 v[48:63], v[92:95], v[84:87], v[48:63]
    ds_read_b64_tr_b16 v[216:217], v10 offset:16384
    ds_read_b64_tr_b16 v[218:219], v10 offset:16896
    ds_read_b64_tr_b16 v[220:221], v9 offset:24576
    v_mfma_f32_32x32x16_bf16 v[96:111], v[228:231], v[84:87], v[96:111]
    ds_read_b64_tr_b16 v[222:223], v9 offset:25088
    ds_read_b64_tr_b16 v[224:225], v10 offset:24576
    ds_read_b64_tr_b16 v[226:227], v10 offset:25088
    buffer_load_dword v11, off, s[40:43], 0 sc1
    v_mfma_f32_32x32x16_bf16 v[112:127], v[232:235], v[84:87], v[112:127]
    v_lshlrev_b32 v250, 7, v1
    s_and_b32 s62, s2, 127
    s_lshl_b32 s62, s62, 2
    s_add_u32 s62, s62, s47
    s_mul_i32 s62, s62, 3584
    s_mov_b64 exec, 0x993264c
    buffer_load_dword v249, v250, s[8:11], s62 offen
    s_mov_b64 exec, 127
    buffer_load_dword v249, v250, s[32:35], 0 offen
    s_mov_b64 exec, -1
    s_waitcnt lgkmcnt(9)
    v_mfma_f32_32x32x16_bf16 v[32:47], v[68:71], v[64:67], v[32:47]
    ds_read_b128 v[84:87], v6
    ds_read_b64_tr_b16 v[88:89], v9 offset:18432
    ds_read_b64_tr_b16 v[90:91], v9 offset:18944
    v_mfma_f32_32x32x16_bf16 v[48:63], v[72:75], v[64:67], v[48:63]
    ds_read_b64_tr_b16 v[92:93], v10 offset:18432
    ds_read_b64_tr_b16 v[94:95], v10 offset:18944
    ds_read_b64_tr_b16 v[228:229], v9 offset:26624
    v_mfma_f32_32x32x16_bf16 v[96:111], v[76:79], v[64:67], v[96:111]
    ds_read_b64_tr_b16 v[230:231], v9 offset:27136
    ds_read_b64_tr_b16 v[232:233], v10 offset:26624
    ds_read_b64_tr_b16 v[234:235], v10 offset:27136
    v_mfma_f32_32x32x16_bf16 v[112:127], v[80:83], v[64:67], v[112:127]
    s_waitcnt lgkmcnt(9)
    v_mfma_f32_32x32x16_bf16 v[32:47], v[212:215], v[208:211], v[32:47]
    ds_read_b128 v[64:67], v7
    ds_read_b64_tr_b16 v[68:69], v9 offset:20480
    ds_read_b64_tr_b16 v[70:71], v9 offset:20992
    v_mfma_f32_32x32x16_bf16 v[48:63], v[216:219], v[208:211], v[48:63]
    ds_read_b64_tr_b16 v[72:73], v10 offset:20480
    ds_read_b64_tr_b16 v[74:75], v10 offset:20992
    ds_read_b64_tr_b16 v[76:77], v9 offset:28672
    v_mfma_f32_32x32x16_bf16 v[96:111], v[220:223], v[208:211], v[96:111]
    ds_read_b64_tr_b16 v[78:79], v9 offset:29184
    ds_read_b64_tr_b16 v[80:81], v10 offset:28672
    ds_read_b64_tr_b16 v[82:83], v10 offset:29184
    v_mfma_f32_32x32x16_bf16 v[112:127], v[224:227], v[208:211], v[112:127]
    s_waitcnt lgkmcnt(9)
    v_mfma_f32_32x32x16_bf16 v[32:47], v[88:91], v[84:87], v[32:47]
    ds_read_b128 v[208:211], v8
    ds_read_b64_tr_b16 v[212:213], v9 offset:22528
    ds_read_b64_tr_b16 v[214:215], v9 offset:23040
    v_mfma_f32_32x32x16_bf16 v[48:63], v[92:95], v[84:87], v[48:63]
    ds_read_b64_tr_b16 v[216:217], v10 offset:22528
    ds_read_b64_tr_b16 v[218:219], v10 offset:23040
    ds_read_b64_tr_b16 v[220:221], v9 offset:30720
    v_mfma_f32_32x32x16_bf16 v[96:111], v[228:231], v[84:87], v[96:111]
    ds_read_b64_tr_b16 v[222:223], v9 offset:31232
    ds_read_b64_tr_b16 v[224:225], v10 offset:30720
    ds_read_b64_tr_b16 v[226:227], v10 offset:31232
    v_mfma_f32_32x32x16_bf16 v[112:127], v[232:235], v[84:87], v[112:127]
    s_waitcnt lgkmcnt(0)
    s_barrier
    v_mfma_f32_32x32x16_bf16 v[32:47], v[68:71], v[64:67], v[32:47]
    v_add_u32 v5, 0xffff0000, v5
    v_add_u32 v6, 0xffff0000, v6
    v_add_u32 v7, 0xffff0000, v7
    v_add_u32 v8, 0xffff0000, v8
    v_add_u32 v9, 0xffff0000, v9
    v_add_u32 v10, 0xffff0000, v10
    ds_read_b128 v[84:87], v5
    ds_read_b64_tr_b16 v[88:89], v9 offset:16384
    ds_read_b64_tr_b16 v[90:91], v9 offset:16896
    v_mfma_f32_32x32x16_bf16 v[48:63], v[72:75], v[64:67], v[48:63]
    ds_read_b64_tr_b16 v[92:93], v10 offset:16384
    ds_read_b64_tr_b16 v[94:95], v10 offset:16896
    ds_read_b64_tr_b16 v[228:229], v9 offset:24576
    v_mfma_f32_32x32x16_bf16 v[96:111], v[76:79], v[64:67], v[96:111]
    ds_read_b64_tr_b16 v[230:231], v9 offset:25088
    ds_read_b64_tr_b16 v[232:233], v10 offset:24576
    ds_read_b64_tr_b16 v[234:235], v10 offset:25088
    v_mfma_f32_32x32x16_bf16 v[112:127], v[80:83], v[64:67], v[112:127]
    s_waitcnt lgkmcnt(9)
    v_mfma_f32_32x32x16_bf16 v[32:47], v[212:215], v[208:211], v[32:47]
    ds_read_b128 v[64:67], v6
    ds_read_b64_tr_b16 v[68:69], v9 offset:18432
    ds_read_b64_tr_b16 v[70:71], v9 offset:18944
    v_mfma_f32_32x32x16_bf16 v[48:63], v[216:219], v[208:211], v[48:63]
    ds_read_b64_tr_b16 v[72:73], v10 offset:18432
    ds_read_b64_tr_b16 v[74:75], v10 offset:18944
    ds_read_b64_tr_b16 v[76:77], v9 offset:26624
    v_mfma_f32_32x32x16_bf16 v[96:111], v[220:223], v[208:211], v[96:111]
    ds_read_b64_tr_b16 v[78:79], v9 offset:27136
    ds_read_b64_tr_b16 v[80:81], v10 offset:26624
    ds_read_b64_tr_b16 v[82:83], v10 offset:27136
    v_mfma_f32_32x32x16_bf16 v[112:127], v[224:227], v[208:211], v[112:127]
    s_waitcnt lgkmcnt(9)
    v_mfma_f32_32x32x16_bf16 v[32:47], v[88:91], v[84:87], v[32:47]
    ds_read_b128 v[208:211], v7
    ds_read_b64_tr_b16 v[212:213], v9 offset:20480
    ds_read_b64_tr_b16 v[214:215], v9 offset:20992
    v_mfma_f32_32x32x16_bf16 v[48:63], v[92:95], v[84:87], v[48:63]
    ds_read_b64_tr_b16 v[216:217], v10 offset:20480
    ds_read_b64_tr_b16 v[218:219], v10 offset:20992
    ds_read_b64_tr_b16 v[220:221], v9 offset:28672
    v_mfma_f32_32x32x16_bf16 v[96:111], v[228:231], v[84:87], v[96:111]
    ds_read_b64_tr_b16 v[222:223], v9 offset:29184
    ds_read_b64_tr_b16 v[224:225], v10 offset:28672
    ds_read_b64_tr_b16 v[226:227], v10 offset:29184
    v_mfma_f32_32x32x16_bf16 v[112:127], v[232:235], v[84:87], v[112:127]
    s_waitcnt lgkmcnt(9)
    v_mfma_f32_32x32x16_bf16 v[32:47], v[68:71], v[64:67], v[32:47]
    ds_read_b128 v[84:87], v8
    ds_read_b64_tr_b16 v[88:89], v9 offset:22528
    ds_read_b64_tr_b16 v[90:91], v9 offset:23040
    v_mfma_f32_32x32x16_bf16 v[48:63], v[72:75], v[64:67], v[48:63]
    ds_read_b64_tr_b16 v[92:93], v10 offset:22528
    ds_read_b64_tr_b16 v[94:95], v10 offset:23040
    ds_read_b64_tr_b16 v[228:229], v9 offset:30720
    v_mfma_f32_32x32x16_bf16 v[96:111], v[76:79], v[64:67], v[96:111]
    ds_read_b64_tr_b16 v[230:231], v9 offset:31232
    ds_read_b64_tr_b16 v[232:233], v10 offset:30720
    ds_read_b64_tr_b16 v[234:235], v10 offset:31232
    v_mfma_f32_32x32x16_bf16 v[112:127], v[80:83], v[64:67], v[112:127]
    s_waitcnt lgkmcnt(0)
    s_barrier
    v_mfma_f32_32x32x16_bf16 v[32:47], v[212:215], v[208:211], v[32:47]
    v_add_u32 v5, 0x8000, v5
    v_add_u32 v6, 0x8000, v6
    v_add_u32 v7, 0x8000, v7
    v_add_u32 v8, 0x8000, v8
    v_add_u32 v9, 0x8000, v9
    v_add_u32 v10, 0x8000, v10
    ds_read_b128 v[64:67], v5
    ds_read_b64_tr_b16 v[68:69], v9 offset:16384
    ds_read_b64_tr_b16 v[70:71], v9 offset:16896
    s_waitcnt vmcnt(2)
    v_cmp_ne_u32 vcc, 0, v11
    s_nop 3
    s_cmp_eq_u64 vcc, exec
    s_cbranch_scc1 pd_2
    s_mov_b32 s3, 200000
pl_3:
    s_sleep 1
    buffer_load_dword v11, off, s[40:43], 0 sc1
    s_waitcnt vmcnt(0)
    v_cmp_ne_u32 vcc, 0, v11
    s_nop 3
    s_cmp_eq_u64 vcc, exec
    s_cbranch_scc1 pd_2
    s_sub_u32 s3, s3, 1
    s_cbranch_scc0 pl_3
pd_2:
    s_getreg_b32 s62, hwreg(HW_REG_XCC_ID, 0, 4)
    s_lshl_b32 s62, s62, 1
    s_add_u32 s62, s62, 2
    v_add_u32 v255, s62, v11
    s_and_b32 s66, s2, 7
    s_lshl_b32 s66, s66, 7
    s_add_u32 s66, s66, 0x1520000
    s_cmp_lg_u32 s47, 0
    s_cbranch_scc1 xp_4
    s_lshr_b32 s63, s2, 3
    s_lshl_b32 s63, s63, 2
    s_add_u32 s63, s63, s66
    s_mov_b64 exec, 1
    buffer_store_dword v255, off, s[12:15], s63
    s_mov_b64 exec, -1
xp_4:
    v_mfma_f32_32x32x16_bf16 v[48:63], v[216:219], v[208:211], v[48:63]
    ds_read_b64_tr_b16 v[72:73], v10 offset:16384
    ds_read_b64_tr_b16 v[74:75], v10 offset:16896
    ds_read_b64_tr_b16 v[76:77], v9 offset:24576
    v_mfma_f32_32x32x16_bf16 v[96:111], v[220:223], v[208:211], v[96:111]
    ds_read_b64_tr_b16 v[78:79], v9 offset:25088
    ds_read_b64_tr_b16 v[80:81], v10 offset:24576
    ds_read_b64_tr_b16 v[82:83], v10 offset:25088
    v_mfma_f32_32x32x16_bf16 v[112:127], v[224:227], v[208:211], v[112:127]
    s_waitcnt lgkmcnt(9)
    v_mfma_f32_32x32x16_bf16 v[32:47], v[88:91], v[84:87], v[32:47]
    ds_read_b128 v[208:211], v6
    ds_read_b64_tr_b16 v[212:213], v9 offset:18432
    ds_read_b64_tr_b16 v[214:215], v9 offset:18944
    v_mfma_f32_32x32x16_bf16 v[48:63], v[92:95], v[84:87], v[48:63]
    ds_read_b64_tr_b16 v[216:217], v10 offset:18432
    ds_read_b64_tr_b16 v[218:219], v10 offset:18944
    ds_read_b64_tr_b16 v[220:221], v9 offset:26624
    v_mfma_f32_32x32x16_bf16 v[96:111], v[228:231], v[84:87], v[96:111]
    ds_read_b64_tr_b16 v[222:223], v9 offset:27136
    ds_read_b64_tr_b16 v[224:225], v10 offset:26624
    ds_read_b64_tr_b16 v[226:227], v10 offset:27136
    v_mfma_f32_32x32x16_bf16 v[112:127], v[232:235], v[84:87], v[112:127]
    s_waitcnt lgkmcnt(9)
    v_mfma_f32_32x32x16_bf16 v[32:47], v[68:71], v[64:67], v[32:47]
    ds_read_b128 v[84:87], v7
    ds_read_b64_tr_b16 v[88:89], v9 offset:20480
    ds_read_b64_tr_b16 v[90:91], v9 offset:20992
    v_mfma_f32_32x32x16_bf16 v[48:63], v[72:75], v[64:67], v[48:63]
    ds_read_b64_tr_b16 v[92:93], v10 offset:20480
    ds_read_b64_tr_b16 v[94:95], v10 offset:20992
    ds_read_b64_tr_b16 v[228:229], v9 offset:28672
    v_mfma_f32_32x32x16_bf16 v[96:111], v[76:79], v[64:67], v[96:111]
    ds_read_b64_tr_b16 v[230:231], v9 offset:29184
    ds_read_b64_tr_b16 v[232:233], v10 offset:28672
    ds_read_b64_tr_b16 v[234:235], v10 offset:29184
    v_mfma_f32_32x32x16_bf16 v[112:127], v[80:83], v[64:67], v[112:127]
    s_waitcnt lgkmcnt(9)
    v_mfma_f32_32x32x16_bf16 v[32:47], v[212:215], v[208:211], v[32:47]
    ds_read_b128 v[64:67], v8
    ds_read_b64_tr_b16 v[68:69], v9 offset:22528
    ds_read_b64_tr_b16 v[70:71], v9 offset:23040
    v_mfma_f32_32x32x16_bf16 v[48:63], v[216:219], v[208:211], v[48:63]
    ds_read_b64_tr_b16 v[72:73], v10 offset:22528
    ds_read_b64_tr_b16 v[74:75], v10 offset:23040
    ds_read_b64_tr_b16 v[76:77], v9 offset:30720
    v_mfma_f32_32x32x16_bf16 v[96:111], v[220:223], v[208:211], v[96:111]
    ds_read_b64_tr_b16 v[78:79], v9 offset:31232
    ds_read_b64_tr_b16 v[80:81], v10 offset:30720
    ds_read_b64_tr_b16 v[82:83], v10 offset:31232
    v_mfma_f32_32x32x16_bf16 v[112:127], v[224:227], v[208:211], v[112:127]
    s_waitcnt lgkmcnt(0)
    s_barrier
    v_mfma_f32_32x32x16_bf16 v[32:47], v[88:91], v[84:87], v[32:47]
    v_add_u32 v5, 0x8000, v5
    v_add_u32 v6, 0x8000, v6
    v_add_u32 v7, 0x8000, v7
    v_add_u32 v8, 0x8000, v8
    v_add_u32 v9, 0x8000, v9
    v_add_u32 v10, 0x8000, v10
    ds_read_b128 v[208:211], v5
    ds_read_b64_tr_b16 v[212:213], v9 offset:16384
    ds_read_b64_tr_b16 v[214:215], v9 offset:16896
    v_mfma_f32_32x32x16_bf16 v[48:63], v[92:95], v[84:87], v[48:63]
    ds_read_b64_tr_b16 v[216:217], v10 offset:16384
    ds_read_b64_tr_b16 v[218:219], v10 offset:16896
    ds_read_b64_tr_b16 v[220:221], v9 offset:24576
    v_mfma_f32_32x32x16_bf16 v[96:111], v[228:231], v[84:87], v[96:111]
    ds_read_b64_tr_b16 v[222:223], v9 offset:25088
    ds_read_b64_tr_b16 v[224:225], v10 offset:24576
    ds_read_b64_tr_b16 v[226:227], v10 offset:25088
    s_and_b32 s62, s47, 3
    s_lshl_b32 s63, s44, 2
    s_add_u32 s62, s62, s63
    s_lshl_b32 s62, s62, 3
    s_add_u32 s62, s62, s45
    s_lshl_b32 s62, s62, 12
    s_add_u32 s4, s62, 0x800000
    s_lshl_b32 s62, s44, 3
    s_add_u32 s62, s62, s45
    s_lshl_b32 s62, s62, 9
    s_and_b32 s63, s47, 3
    s_lshl_b32 s63, s63, 7
    s_add_u32 s62, s62, s63
    s_add_u32 s5, s62, 0x1400000
    s_lshl_b32 s6, s44, 3
    s_add_u32 s6, s6, s45
    s_lshl_b32 s6, s6, 5
    s_add_u32 s6, s6, s47
    s_lshl_b32 s6, s6, 2
    s_add_u32 s6, s6, 0x1510000
    v_lshlrev_b32 v250, 7, v1
    v_add_u32 v250, s4, v250
    v_writelane_b32 v250, s5, 32
    v_writelane_b32 v250, s6, 33
    s_mov_b32 exec_hi, 2
    s_mov_b32 exec_lo, 0
    buffer_load_dword v249, v250, s[12:15], 0 offen sc1
    s_mov_b64 exec, -1
    v_mfma_f32_32x32x16_bf16 v[112:127], v[232:235], v[84:87], v[112:127]
    buffer_load_dword v249, off, s[12:15], s57 sc1
    s_waitcnt lgkmcnt(9)
    v_mfma_f32_32x32x16_bf16 v[32:47], v[68:71], v[64:67], v[32:47]
    ds_read_b128 v[84:87], v6
    ds_read_b64_tr_b16 v[88:89], v9 offset:18432
    ds_read_b64_tr_b16 v[90:91], v9 offset:18944
    v_mfma_f32_32x32x16_bf16 v[48:63], v[72:75], v[64:67], v[48:63]
    ds_read_b64_tr_b16 v[92:93], v10 offset:18432
    ds_read_b64_tr_b16 v[94:95], v10 offset:18944
    ds_read_b64_tr_b16 v[228:229], v9 offset:26624
    v_mfma_f32_32x32x16_bf16 v[96:111], v[76:79], v[64:67], v[96:111]
    ds_read_b64_tr_b16 v[230:231], v9 offset:27136
    ds_read_b64_tr_b16 v[232:233], v10 offset:26624
    ds_read_b64_tr_b16 v[234:235], v10 offset:27136
    v_mfma_f32_32x32x16_bf16 v[112:127], v[80:83], v[64:67], v[112:127]
    s_waitcnt lgkmcnt(9)
    v_mfma_f32_32x32x16_bf16 v[32:47], v[212:215], v[208:211], v[32:47]
    ds_read_b128 v[64:67], v7
    ds_read_b64_tr_b16 v[68:69], v9 offset:20480
    ds_read_b64_tr_b16 v[70:71], v9 offset:20992
    v_mfma_f32_32x32x16_bf16 v[48:63], v[216:219], v[208:211], v[48:63]
    ds_read_b64_tr_b16 v[72:73], v10 offset:20480
    ds_read_b64_tr_b16 v[74:75], v10 offset:20992
    ds_read_b64_tr_b16 v[76:77], v9 offset:28672
    v_mfma_f32_32x32x16_bf16 v[96:111], v[220:223], v[208:211], v[96:111]
    ds_read_b64_tr_b16 v[78:79], v9 offset:29184
    ds_read_b64_tr_b16 v[80:81], v10 offset:28672
    ds_read_b64_tr_b16 v[82:83], v10 offset:29184
    v_mfma_f32_32x32x16_bf16 v[112:127], v[224:227], v[208:211], v[112:127]
    s_waitcnt lgkmcnt(9)
    v_mfma_f32_32x32x16_bf16 v[32:47], v[88:91], v[84:87], v[32:47]
    ds_read_b128 v[208:211], v8
    ds_read_b64_tr_b16 v[212:213], v9 offset:22528
    ds_read_b64_tr_b16 v[214:215], v9 offset:23040
    v_mfma_f32_32x32x16_bf16 v[48:63], v[92:95], v[84:87], v[48:63]
    ds_read_b64_tr_b16 v[216:217], v10 offset:22528
    ds_read_b64_tr_b16 v[218:219], v10 offset:23040
    ds_read_b64_tr_b16 v[220:221], v9 offset:30720
    v_mfma_f32_32x32x16_bf16 v[96:111], v[228:231], v[84:87], v[96:111]
    ds_read_b64_tr_b16 v[222:223], v9 offset:31232
    ds_read_b64_tr_b16 v[224:225], v10 offset:30720
    ds_read_b64_tr_b16 v[226:227], v10 offset:31232
    v_mfma_f32_32x32x16_bf16 v[112:127], v[232:235], v[84:87], v[112:127]
    s_waitcnt lgkmcnt(0)
    s_barrier
    v_mfma_f32_32x32x16_bf16 v[32:47], v[68:71], v[64:67], v[32:47]
    v_add_u32 v5, 0xffff0000, v5
    v_add_u32 v6, 0xffff0000, v6
    v_add_u32 v7, 0xffff0000, v7
    v_add_u32 v8, 0xffff0000, v8
    v_add_u32 v9, 0xffff0000, v9
    v_add_u32 v10, 0xffff0000, v10
    ds_read_b128 v[84:87], v5
    ds_read_b64_tr_b16 v[88:89], v9 offset:16384
    ds_read_b64_tr_b16 v[90:91], v9 offset:16896
    v_mfma_f32_32x32x16_bf16 v[48:63], v[72:75], v[64:67], v[48:63]
    ds_read_b64_tr_b16 v[92:93], v10 offset:16384
    ds_read_b64_tr_b16 v[94:95], v10 offset:16896
    ds_read_b64_tr_b16 v[228:229], v9 offset:24576
    v_mfma_f32_32x32x16_bf16 v[96:111], v[76:79], v[64:67], v[96:111]
    ds_read_b64_tr_b16 v[230:231], v9 offset:25088
    ds_read_b64_tr_b16 v[232:233], v10 offset:24576
    ds_read_b64_tr_b16 v[234:235], v10 offset:25088
    v_lshlrev_b32 v250, 7, v1
    s_and_b32 s62, s2, 127
    s_lshl_b32 s62, s62, 12
    s_add_u32 s62, s62, s55
    s_lshl_b32 s62, s62, 2
    s_mov_b32 exec_hi, 0
    s_cmp_ge_u32 s62, 1605632
    s_cbranch_scc1 pf_5
    buffer_load_dword v249, v250, s[24:27], s62 offen
    s_branch pf_6
pf_5:
    s_sub_u32 s62, s62, 1605632
    buffer_load_dword v249, v250, s[28:31], s62 offen
pf_6:
    s_lshl_b32 s62, s2, 2
    s_add_u32 s62, s62, s47
    s_and_b32 s62, s62, 511
    s_lshl_b32 s62, s62, 8
    s_add_u32 s62, s62, 0xf00000
    s_mov_b64 exec, 3
    buffer_load_dword v249, v250, s[12:15], s62 offen
    s_mov_b64 exec, -1
    v_mfma_f32_32x32x16_bf16 v[112:127], v[80:83], v[64:67], v[112:127]
    s_waitcnt lgkmcnt(9)
    v_mfma_f32_32x32x16_bf16 v[32:47], v[212:215], v[208:211], v[32:47]
    ds_read_b128 v[64:67], v6
    ds_read_b64_tr_b16 v[68:69], v9 offset:18432
    ds_read_b64_tr_b16 v[70:71], v9 offset:18944
    v_mfma_f32_32x32x16_bf16 v[48:63], v[216:219], v[208:211], v[48:63]
    ds_read_b64_tr_b16 v[72:73], v10 offset:18432
    ds_read_b64_tr_b16 v[74:75], v10 offset:18944
    ds_read_b64_tr_b16 v[76:77], v9 offset:26624
    v_mfma_f32_32x32x16_bf16 v[96:111], v[220:223], v[208:211], v[96:111]
    ds_read_b64_tr_b16 v[78:79], v9 offset:27136
    ds_read_b64_tr_b16 v[80:81], v10 offset:26624
    ds_read_b64_tr_b16 v[82:83], v10 offset:27136
    v_mfma_f32_32x32x16_bf16 v[112:127], v[224:227], v[208:211], v[112:127]
    s_waitcnt lgkmcnt(9)
    v_mfma_f32_32x32x16_bf16 v[32:47], v[88:91], v[84:87], v[32:47]
    ds_read_b128 v[208:211], v7
    ds_read_b64_tr_b16 v[212:213], v9 offset:20480
    ds_read_b64_tr_b16 v[214:215], v9 offset:20992
    v_mfma_f32_32x32x16_bf16 v[48:63], v[92:95], v[84:87], v[48:63]
    ds_read_b64_tr_b16 v[216:217], v10 offset:20480
    ds_read_b64_tr_b16 v[218:219], v10 offset:20992
    ds_read_b64_tr_b16 v[220:221], v9 offset:28672
    v_mfma_f32_32x32x16_bf16 v[96:111], v[228:231], v[84:87], v[96:111]
    ds_read_b64_tr_b16 v[222:223], v9 offset:29184
    ds_read_b64_tr_b16 v[224:225], v10 offset:28672
    ds_read_b64_tr_b16 v[226:227], v10 offset:29184
    v_mfma_f32_32x32x16_bf16 v[112:127], v[232:235], v[84:87], v[112:127]
    s_waitcnt lgkmcnt(9)
    v_mfma_f32_32x32x16_bf16 v[32:47], v[68:71], v[64:67], v[32:47]
    ds_read_b128 v[84:87], v8
    ds_read_b64_tr_b16 v[88:89], v9 offset:22528
    ds_read_b64_tr_b16 v[90:91], v9 offset:23040
    v_mfma_f32_32x32x16_bf16 v[48:63], v[72:75], v[64:67], v[48:63]
    ds_read_b64_tr_b16 v[92:93], v10 offset:22528
    ds_read_b64_tr_b16 v[94:95], v10 offset:23040
    ds_read_b64_tr_b16 v[228:229], v9 offset:30720
    v_mfma_f32_32x32x16_bf16 v[96:111], v[76:79], v[64:67], v[96:111]
    ds_read_b64_tr_b16 v[230:231], v9 offset:31232
    ds_read_b64_tr_b16 v[232:233], v10 offset:30720
    ds_read_b64_tr_b16 v[234:235], v10 offset:31232
    v_mfma_f32_32x32x16_bf16 v[112:127], v[80:83], v[64:67], v[112:127]
    s_waitcnt lgkmcnt(0)
    s_barrier
    v_mfma_f32_32x32x16_bf16 v[32:47], v[212:215], v[208:211], v[32:47]
    v_add_u32 v5, 0x8000, v5
    v_add_u32 v6, 0x8000, v6
    v_add_u32 v7, 0x8000, v7
    v_add_u32 v8, 0x8000, v8
    v_add_u32 v9, 0x8000, v9
    v_add_u32 v10, 0x8000, v10
    ds_read_b128 v[64:67], v5
    ds_read_b64_tr_b16 v[68:69], v9 offset:16384
    ds_read_b64_tr_b16 v[70:71], v9 offset:16896
    v_mfma_f32_32x32x16_bf16 v[48:63], v[216:219], v[208:211], v[48:63]
    ds_read_b64_tr_b16 v[72:73], v10 offset:16384
    ds_read_b64_tr_b16 v[74:75], v10 offset:16896
    ds_read_b64_tr_b16 v[76:77], v9 offset:24576
    v_mfma_f32_32x32x16_bf16 v[96:111], v[220:223], v[208:211], v[96:111]
    ds_read_b64_tr_b16 v[78:79], v9 offset:25088
    ds_read_b64_tr_b16 v[80:81], v10 offset:24576
    ds_read_b64_tr_b16 v[82:83], v10 offset:25088
    v_and_b32 v248, 31, v1
    v_lshlrev_b32 v248, 2, v248
    buffer_load_dword v248, v248, s[12:15], s66 offen sc1
    v_mfma_f32_32x32x16_bf16 v[112:127], v[224:227], v[208:211], v[112:127]
    s_waitcnt lgkmcnt(9)
    v_mfma_f32_32x32x16_bf16 v[32:47], v[88:91], v[84:87], v[32:47]
    ds_read_b128 v[208:211], v6
    ds_read_b64_tr_b16 v[212:213], v9 offset:18432
    ds_read_b64_tr_b16 v[214:215], v9 offset:18944
    v_mfma_f32_32x32x16_bf16 v[48:63], v[92:95], v[84:87], v[48:63]
    ds_read_b64_tr_b16 v[216:217], v10 offset:18432
    ds_read_b64_tr_b16 v[218:219], v10 offset:18944
    ds_read_b64_tr_b16 v[220:221], v9 offset:26624
    v_mfma_f32_32x32x16_bf16 v[96:111], v[228:231], v[84:87], v[96:111]
    ds_read_b64_tr_b16 v[222:223], v9 offset:27136
    ds_read_b64_tr_b16 v[224:225], v10 offset:26624
    ds_read_b64_tr_b16 v[226:227], v10 offset:27136
    v_mfma_f32_32x32x16_bf16 v[112:127], v[232:235], v[84:87], v[112:127]
    s_waitcnt lgkmcnt(9)
    v_mfma_f32_32x32x16_bf16 v[32:47], v[68:71], v[64:67], v[32:47]
    ds_read_b128 v[84:87], v7
    ds_read_b64_tr_b16 v[88:89], v9 offset:20480
    ds_read_b64_tr_b16 v[90:91], v9 offset:20992
    v_mfma_f32_32x32x16_bf16 v[48:63], v[72:75], v[64:67], v[48:63]
    ds_read_b64_tr_b16 v[92:93], v10 offset:20480
    ds_read_b64_tr_b16 v[94:95], v10 offset:20992
    ds_read_b64_tr_b16 v[228:229], v9 offset:28672
    v_mfma_f32_32x32x16_bf16 v[96:111], v[76:79], v[64:67], v[96:111]
    ds_read_b64_tr_b16 v[230:231], v9 offset:29184
    ds_read_b64_tr_b16 v[232:233], v10 offset:28672
    ds_read_b64_tr_b16 v[234:235], v10 offset:29184
    v_mfma_f32_32x32x16_bf16 v[112:127], v[80:83], v[64:67], v[112:127]
    s_waitcnt lgkmcnt(9)
    v_mfma_f32_32x32x16_bf16 v[32:47], v[212:215], v[208:211], v[32:47]
    ds_read_b128 v[64:67], v8
    ds_read_b64_tr_b16 v[68:69], v9 offset:22528
    ds_read_b64_tr_b16 v[70:71], v9 offset:23040
    v_mfma_f32_32x32x16_bf16 v[48:63], v[216:219], v[208:211], v[48:63]
    ds_read_b64_tr_b16 v[72:73], v10 offset:22528
    ds_read_b64_tr_b16 v[74:75], v10 offset:23040
    ds_read_b64_tr_b16 v[76:77], v9 offset:30720
    v_mfma_f32_32x32x16_bf16 v[96:111], v[220:223], v[208:211], v[96:111]
    ds_read_b64_tr_b16 v[78:79], v9 offset:31232
    ds_read_b64_tr_b16 v[80:81], v10 offset:30720
    ds_read_b64_tr_b16 v[82:83], v10 offset:31232
    v_mfma_f32_32x32x16_bf16 v[112:127], v[224:227], v[208:211], v[112:127]
    s_waitcnt lgkmcnt(0)
    s_barrier
    v_mfma_f32_32x32x16_bf16 v[32:47], v[88:91], v[84:87], v[32:47]
    v_mfma_f32_32x32x16_bf16 v[48:63], v[92:95], v[84:87], v[48:63]
    v_mfma_f32_32x32x16_bf16 v[96:111], v[228:231], v[84:87], v[96:111]
    v_mfma_f32_32x32x16_bf16 v[112:127], v[232:235], v[84:87], v[112:127]
    s_waitcnt lgkmcnt(0)
    v_mfma_f32_32x32x16_bf16 v[32:47], v[68:71], v[64:67], v[32:47]
    v_mfma_f32_32x32x16_bf16 v[48:63], v[72:75], v[64:67], v[48:63]
    v_mfma_f32_32x32x16_bf16 v[96:111], v[76:79], v[64:67], v[96:111]
    v_mfma_f32_32x32x16_bf16 v[112:127], v[80:83], v[64:67], v[112:127]
    s_setprio 1
    s_nop 7
    v_mul_f32 v12, v32, v32
    v_mul_f32 v13, v33, v33
    v_mul_f32 v14, v34, v34
    v_mul_f32 v15, v35, v35
    v_mul_f32 v16, v36, v36
    v_mul_f32 v17, v37, v37
    v_mul_f32 v18, v38, v38
    v_mul_f32 v19, v39, v39
    v_fma_f32 v12, v12, s58, v252
    v_fma_f32 v13, v13, s59, v253
    v_fma_f32 v14, v14, s58, v252
    v_fma_f32 v15, v15, s59, v253
    v_fma_f32 v16, v16, s58, v252
    v_fma_f32 v17, v17, s59, v253
    v_fma_f32 v18, v18, s58, v252
    v_fma_f32 v19, v19, s59, v253
    v_mul_f32 v12, v12, v32
    v_mul_f32 v13, v13, v33
    v_mul_f32 v14, v14, v34
    v_mul_f32 v15, v15, v35
    v_mul_f32 v16, v16, v36
    v_mul_f32 v17, v17, v37
    v_mul_f32 v18, v18, v38
    v_mul_f32 v19, v19, v39
    v_exp_f32 v12, v12
    v_exp_f32 v13, v13
    v_exp_f32 v14, v14
    v_exp_f32 v15, v15
    v_exp_f32 v16, v16
    v_exp_f32 v17, v17
    v_exp_f32 v18, v18
    v_exp_f32 v19, v19
    v_add_f32 v12, 1.0, v12
    v_add_f32 v13, 1.0, v13
    v_add_f32 v14, 1.0, v14
    v_add_f32 v15, 1.0, v15
    v_add_f32 v16, 1.0, v16
    v_add_f32 v17, 1.0, v17
    v_add_f32 v18, 1.0, v18
    v_add_f32 v19, 1.0, v19
    v_rcp_f32 v12, v12
    v_rcp_f32 v13, v13
    v_rcp_f32 v14, v14
    v_rcp_f32 v15, v15
    v_rcp_f32 v16, v16
    v_rcp_f32 v17, v17
    v_rcp_f32 v18, v18
    v_rcp_f32 v19, v19
    v_mul_f32 v12, v12, v32
    v_mul_f32 v13, v13, v33
    v_mul_f32 v14, v14, v34
    v_mul_f32 v15, v15, v35
    v_mul_f32 v16, v16, v36
    v_mul_f32 v17, v17, v37
    v_mul_f32 v18, v18, v38
    v_mul_f32 v19, v19, v39
    v_cvt_pk_bf16_f32 v32, v12, v13
    v_cvt_pk_bf16_f32 v33, v14, v15
    v_cvt_pk_bf16_f32 v34, v16, v17
    v_cvt_pk_bf16_f32 v35, v18, v19
    buffer_store_dwordx4 v[32:35], v244, s[12:15], s20 offen sc1
    v_mul_f32 v12, v40, v40
    v_mul_f32 v13, v41, v41
    v_mul_f32 v14, v42, v42
    v_mul_f32 v15, v43, v43
    v_mul_f32 v16, v44, v44
    v_mul_f32 v17, v45, v45
    v_mul_f32 v18, v46, v46
    v_mul_f32 v19, v47, v47
    v_fma_f32 v12, v12, s58, v252
    v_fma_f32 v13, v13, s59, v253
    v_fma_f32 v14, v14, s58, v252
    v_fma_f32 v15, v15, s59, v253
    v_fma_f32 v16, v16, s58, v252
    v_fma_f32 v17, v17, s59, v253
    v_fma_f32 v18, v18, s58, v252
    v_fma_f32 v19, v19, s59, v253
    v_mul_f32 v12, v12, v40
    v_mul_f32 v13, v13, v41
    v_mul_f32 v14, v14, v42
    v_mul_f32 v15, v15, v43
    v_mul_f32 v16, v16, v44
    v_mul_f32 v17, v17, v45
    v_mul_f32 v18, v18, v46
    v_mul_f32 v19, v19, v47
    v_exp_f32 v12, v12
    v_exp_f32 v13, v13
    v_exp_f32 v14, v14
    v_exp_f32 v15, v15
    v_exp_f32 v16, v16
    v_exp_f32 v17, v17
    v_exp_f32 v18, v18
    v_exp_f32 v19, v19
    v_add_f32 v12, 1.0, v12
    v_add_f32 v13, 1.0, v13
    v_add_f32 v14, 1.0, v14
    v_add_f32 v15, 1.0, v15
    v_add_f32 v16, 1.0, v16
    v_add_f32 v17, 1.0, v17
    v_add_f32 v18, 1.0, v18
    v_add_f32 v19, 1.0, v19
    v_rcp_f32 v12, v12
    v_rcp_f32 v13, v13
    v_rcp_f32 v14, v14
    v_rcp_f32 v15, v15
    v_rcp_f32 v16, v16
    v_rcp_f32 v17, v17
    v_rcp_f32 v18, v18
    v_rcp_f32 v19, v19
    v_mul_f32 v12, v12, v40
    v_mul_f32 v13, v13, v41
    v_mul_f32 v14, v14, v42
    v_mul_f32 v15, v15, v43
    v_mul_f32 v16, v16, v44
    v_mul_f32 v17, v17, v45
    v_mul_f32 v18, v18, v46
    v_mul_f32 v19, v19, v47
    v_cvt_pk_bf16_f32 v40, v12, v13
    v_cvt_pk_bf16_f32 v41, v14, v15
    v_cvt_pk_bf16_f32 v42, v16, v17
    v_cvt_pk_bf16_f32 v43, v18, v19
    buffer_store_dwordx4 v[40:43], v244, s[12:15], s20 offen offset:1024 sc1
    v_mul_f32 v12, v48, v48
    v_mul_f32 v13, v49, v49
    v_mul_f32 v14, v50, v50
    v_mul_f32 v15, v51, v51
    v_mul_f32 v16, v52, v52
    v_mul_f32 v17, v53, v53
    v_mul_f32 v18, v54, v54
    v_mul_f32 v19, v55, v55
    v_fma_f32 v12, v12, s58, v252
    v_fma_f32 v13, v13, s59, v253
    v_fma_f32 v14, v14, s58, v252
    v_fma_f32 v15, v15, s59, v253
    v_fma_f32 v16, v16, s58, v252
    v_fma_f32 v17, v17, s59, v253
    v_fma_f32 v18, v18, s58, v252
    v_fma_f32 v19, v19, s59, v253
    v_mul_f32 v12, v12, v48
    v_mul_f32 v13, v13, v49
    v_mul_f32 v14, v14, v50
    v_mul_f32 v15, v15, v51
    v_mul_f32 v16, v16, v52
    v_mul_f32 v17, v17, v53
    v_mul_f32 v18, v18, v54
    v_mul_f32 v19, v19, v55
    s_add_u32 m0, s61, 0x4000
    s_bfe_u32 s50, s46, 0x40000
    s_mul_i32 s50, s50, 28672
    s_add_u32 s50, s50, s0
    buffer_load_dwordx4 v243, s[24:27], s50 offen lds
    v_exp_f32 v12, v12
    v_exp_f32 v13, v13
    v_exp_f32 v14, v14
    v_exp_f32 v15, v15
    v_exp_f32 v16, v16
    v_exp_f32 v17, v17
    v_exp_f32 v18, v18
    v_exp_f32 v19, v19
    v_add_f32 v12, 1.0, v12
    v_add_f32 v13, 1.0, v13
    v_add_f32 v14, 1.0, v14
    v_add_f32 v15, 1.0, v15
    v_add_f32 v16, 1.0, v16
    v_add_f32 v17, 1.0, v17
    v_add_f32 v18, 1.0, v18
    v_add_f32 v19, 1.0, v19
    v_rcp_f32 v12, v12
    v_rcp_f32 v13, v13
    v_rcp_f32 v14, v14
    v_rcp_f32 v15, v15
    v_rcp_f32 v16, v16
    v_rcp_f32 v17, v17
    v_rcp_f32 v18, v18
    v_rcp_f32 v19, v19
    buffer_load_dwordx4 v251, s[24:27], s50 offen offset:1024 lds
    v_mul_f32 v12, v12, v48
    v_mul_f32 v13, v13, v49
    v_mul_f32 v14, v14, v50
    v_mul_f32 v15, v15, v51
    v_mul_f32 v16, v16, v52
    v_mul_f32 v17, v17, v53
    v_mul_f32 v18, v18, v54
    v_mul_f32 v19, v19, v55
    v_cvt_pk_bf16_f32 v48, v12, v13
    v_cvt_pk_bf16_f32 v49, v14, v15
    v_cvt_pk_bf16_f32 v50, v16, v17
    v_cvt_pk_bf16_f32 v51, v18, v19
    buffer_store_dwordx4 v[48:51], v244, s[12:15], s21 offen sc1
    v_mul_f32 v12, v56, v56
    v_mul_f32 v13, v57, v57
    v_mul_f32 v14, v58, v58
    v_mul_f32 v15, v59, v59
    v_mul_f32 v16, v60, v60
    v_mul_f32 v17, v61, v61
    v_mul_f32 v18, v62, v62
    v_mul_f32 v19, v63, v63
    v_fma_f32 v12, v12, s58, v252
    v_fma_f32 v13, v13, s59, v253
    v_fma_f32 v14, v14, s58, v252
    v_fma_f32 v15, v15, s59, v253
    v_fma_f32 v16, v16, s58, v252
    v_fma_f32 v17, v17, s59, v253
    v_fma_f32 v18, v18, s58, v252
    v_fma_f32 v19, v19, s59, v253
    v_mul_f32 v12, v12, v56
    v_mul_f32 v13, v13, v57
    v_mul_f32 v14, v14, v58
    v_mul_f32 v15, v15, v59
    v_mul_f32 v16, v16, v60
    v_mul_f32 v17, v17, v61
    v_mul_f32 v18, v18, v62
    v_mul_f32 v19, v19, v63
    s_add_u32 m0, s61, 0x4800
    s_add_u32 s50, s50, 14336
    buffer_load_dwordx4 v243, s[24:27], s50 offen lds
    buffer_load_dwordx4 v251, s[24:27], s50 offen offset:1024 lds
    v_exp_f32 v12, v12
    v_exp_f32 v13, v13
    v_exp_f32 v14, v14
    v_exp_f32 v15, v15
    v_exp_f32 v16, v16
    v_exp_f32 v17, v17
    v_exp_f32 v18, v18
    v_exp_f32 v19, v19
    v_add_f32 v12, 1.0, v12
    v_add_f32 v13, 1.0, v13
    v_add_f32 v14, 1.0, v14
    v_add_f32 v15, 1.0, v15
    v_add_f32 v16, 1.0, v16
    v_add_f32 v17, 1.0, v17
    v_add_f32 v18, 1.0, v18
    v_add_f32 v19, 1.0, v19
    v_rcp_f32 v12, v12
    v_rcp_f32 v13, v13
    v_rcp_f32 v14, v14
    v_rcp_f32 v15, v15
    v_rcp_f32 v16, v16
    v_rcp_f32 v17, v17
    v_rcp_f32 v18, v18
    v_rcp_f32 v19, v19
    s_add_u32 m0, s61, 0x8000
    s_bfe_u32 s50, s46, 0x40004
    s_mul_i32 s50, s50, 28672
    s_add_u32 s50, s50, s0
    buffer_load_dwordx4 v243, s[24:27], s50 offen lds
    v_mul_f32 v12, v12, v56
    v_mul_f32 v13, v13, v57
    v_mul_f32 v14, v14, v58
    v_mul_f32 v15, v15, v59
    v_mul_f32 v16, v16, v60
    v_mul_f32 v17, v17, v61
    v_mul_f32 v18, v18, v62
    v_mul_f32 v19, v19, v63
    v_cvt_pk_bf16_f32 v56, v12, v13
    v_cvt_pk_bf16_f32 v57, v14, v15
    v_cvt_pk_bf16_f32 v58, v16, v17
    v_cvt_pk_bf16_f32 v59, v18, v19
    buffer_store_dwordx4 v[56:59], v244, s[12:15], s21 offen offset:1024 sc1
    v_mul_f32 v12, v96, v96
    v_mul_f32 v13, v97, v97
    v_mul_f32 v14, v98, v98
    v_mul_f32 v15, v99, v99
    v_mul_f32 v16, v100, v100
    v_mul_f32 v17, v101, v101
    v_mul_f32 v18, v102, v102
    v_mul_f32 v19, v103, v103
    v_fma_f32 v12, v12, s58, v252
    v_fma_f32 v13, v13, s59, v253
    v_fma_f32 v14, v14, s58, v252
    v_fma_f32 v15, v15, s59, v253
    v_fma_f32 v16, v16, s58, v252
    v_fma_f32 v17, v17, s59, v253
    v_fma_f32 v18, v18, s58, v252
    v_fma_f32 v19, v19, s59, v253
    v_mul_f32 v12, v12, v96
    v_mul_f32 v13, v13, v97
    v_mul_f32 v14, v14, v98
    v_mul_f32 v15, v15, v99
    v_mul_f32 v16, v16, v100
    v_mul_f32 v17, v17, v101
    v_mul_f32 v18, v18, v102
    v_mul_f32 v19, v19, v103
    buffer_load_dwordx4 v251, s[24:27], s50 offen offset:1024 lds
    v_exp_f32 v12, v12
    v_exp_f32 v13, v13
    v_exp_f32 v14, v14
    v_exp_f32 v15, v15
    v_exp_f32 v16, v16
    v_exp_f32 v17, v17
    v_exp_f32 v18, v18
    v_exp_f32 v19, v19
    v_add_f32 v12, 1.0, v12
    v_add_f32 v13, 1.0, v13
    v_add_f32 v14, 1.0, v14
    v_add_f32 v15, 1.0, v15
    v_add_f32 v16, 1.0, v16
    v_add_f32 v17, 1.0, v17
    v_add_f32 v18, 1.0, v18
    v_add_f32 v19, 1.0, v19
    v_rcp_f32 v12, v12
    v_rcp_f32 v13, v13
    v_rcp_f32 v14, v14
    v_rcp_f32 v15, v15
    v_rcp_f32 v16, v16
    v_rcp_f32 v17, v17
    v_rcp_f32 v18, v18
    v_rcp_f32 v19, v19
    s_add_u32 m0, s61, 0x8800
    s_add_u32 s50, s50, 14336
    buffer_load_dwordx4 v243, s[24:27], s50 offen lds
    buffer_load_dwordx4 v251, s[24:27], s50 offen offset:1024 lds
    v_mul_f32 v12, v12, v96
    v_mul_f32 v13, v13, v97
    v_mul_f32 v14, v14, v98
    v_mul_f32 v15, v15, v99
    v_mul_f32 v16, v16, v100
    v_mul_f32 v17, v17, v101
    v_mul_f32 v18, v18, v102
    v_mul_f32 v19, v19, v103
    v_cvt_pk_bf16_f32 v96, v12, v13
    v_cvt_pk_bf16_f32 v97, v14, v15
    v_cvt_pk_bf16_f32 v98, v16, v17
    v_cvt_pk_bf16_f32 v99, v18, v19
    buffer_store_dwordx4 v[96:99], v244, s[12:15], s22 offen sc1
    v_mul_f32 v12, v104, v104
    v_mul_f32 v13, v105, v105
    v_mul_f32 v14, v106, v106
    v_mul_f32 v15, v107, v107
    v_mul_f32 v16, v108, v108
    v_mul_f32 v17, v109, v109
    v_mul_f32 v18, v110, v110
    v_mul_f32 v19, v111, v111
    v_fma_f32 v12, v12, s58, v252
    v_fma_f32 v13, v13, s59, v253
    v_fma_f32 v14, v14, s58, v252
    v_fma_f32 v15, v15, s59, v253
    v_fma_f32 v16, v16, s58, v252
    v_fma_f32 v17, v17, s59, v253
    v_fma_f32 v18, v18, s58, v252
    v_fma_f32 v19, v19, s59, v253
    v_mul_f32 v12, v12, v104
    v_mul_f32 v13, v13, v105
    v_mul_f32 v14, v14, v106
    v_mul_f32 v15, v15, v107
    v_mul_f32 v16, v16, v108
    v_mul_f32 v17, v17, v109
    v_mul_f32 v18, v18, v110
    v_mul_f32 v19, v19, v111
    s_add_u32 m0, s61, 0xc000
    s_bfe_u32 s50, s46, 0x40008
    s_mul_i32 s50, s50, 28672
    s_add_u32 s50, s50, s0
    buffer_load_dwordx4 v243, s[24:27], s50 offen lds
    v_exp_f32 v12, v12
    v_exp_f32 v13, v13
    v_exp_f32 v14, v14
    v_exp_f32 v15, v15
    v_exp_f32 v16, v16
    v_exp_f32 v17, v17
    v_exp_f32 v18, v18
    v_exp_f32 v19, v19
    v_add_f32 v12, 1.0, v12
    v_add_f32 v13, 1.0, v13
    v_add_f32 v14, 1.0, v14
    v_add_f32 v15, 1.0, v15
    v_add_f32 v16, 1.0, v16
    v_add_f32 v17, 1.0, v17
    v_add_f32 v18, 1.0, v18
    v_add_f32 v19, 1.0, v19
    v_rcp_f32 v12, v12
    v_rcp_f32 v13, v13
    v_rcp_f32 v14, v14
    v_rcp_f32 v15, v15
    v_rcp_f32 v16, v16
    v_rcp_f32 v17, v17
    v_rcp_f32 v18, v18
    v_rcp_f32 v19, v19
    buffer_load_dwordx4 v251, s[24:27], s50 offen offset:1024 lds
    v_mul_f32 v12, v12, v104
    v_mul_f32 v13, v13, v105
    v_mul_f32 v14, v14, v106
    v_mul_f32 v15, v15, v107
    v_mul_f32 v16, v16, v108
    v_mul_f32 v17, v17, v109
    v_mul_f32 v18, v18, v110
    v_mul_f32 v19, v19, v111
    v_cvt_pk_bf16_f32 v104, v12, v13
    v_cvt_pk_bf16_f32 v105, v14, v15
    v_cvt_pk_bf16_f32 v106, v16, v17
    v_cvt_pk_bf16_f32 v107, v18, v19
    buffer_store_dwordx4 v[104:107], v244, s[12:15], s22 offen offset:1024 sc1
    v_mul_f32 v12, v112, v112
    v_mul_f32 v13, v113, v113
    v_mul_f32 v14, v114, v114
    v_mul_f32 v15, v115, v115
    v_mul_f32 v16, v116, v116
    v_mul_f32 v17, v117, v117
    v_mul_f32 v18, v118, v118
    v_mul_f32 v19, v119, v119
    v_fma_f32 v12, v12, s58, v252
    v_fma_f32 v13, v13, s59, v253
    v_fma_f32 v14, v14, s58, v252
    v_fma_f32 v15, v15, s59, v253
    v_fma_f32 v16, v16, s58, v252
    v_fma_f32 v17, v17, s59, v253
    v_fma_f32 v18, v18, s58, v252
    v_fma_f32 v19, v19, s59, v253
    v_mul_f32 v12, v12, v112
    v_mul_f32 v13, v13, v113
    v_mul_f32 v14, v14, v114
    v_mul_f32 v15, v15, v115
    v_mul_f32 v16, v16, v116
    v_mul_f32 v17, v17, v117
    v_mul_f32 v18, v18, v118
    v_mul_f32 v19, v19, v119
    s_add_u32 m0, s61, 0xc800
    s_add_u32 s50, s50, 14336
    buffer_load_dwordx4 v243, s[24:27], s50 offen lds
    buffer_load_dwordx4 v251, s[24:27], s50 offen offset:1024 lds
    v_exp_f32 v12, v12
    v_exp_f32 v13, v13
    v_exp_f32 v14, v14
    v_exp_f32 v15, v15
    v_exp_f32 v16, v16
    v_exp_f32 v17, v17
    v_exp_f32 v18, v18
    v_exp_f32 v19, v19
    v_add_f32 v12, 1.0, v12
    v_add_f32 v13, 1.0, v13
    v_add_f32 v14, 1.0, v14
    v_add_f32 v15, 1.0, v15
    v_add_f32 v16, 1.0, v16
    v_add_f32 v17, 1.0, v17
    v_add_f32 v18, 1.0, v18
    v_add_f32 v19, 1.0, v19
    v_rcp_f32 v12, v12
    v_rcp_f32 v13, v13
    v_rcp_f32 v14, v14
    v_rcp_f32 v15, v15
    v_rcp_f32 v16, v16
    v_rcp_f32 v17, v17
    v_rcp_f32 v18, v18
    v_rcp_f32 v19, v19
    v_mul_f32 v12, v12, v112
    v_mul_f32 v13, v13, v113
    v_mul_f32 v14, v14, v114
    v_mul_f32 v15, v15, v115
    v_mul_f32 v16, v16, v116
    v_mul_f32 v17, v17, v117
    v_mul_f32 v18, v18, v118
    v_mul_f32 v19, v19, v119
    v_cvt_pk_bf16_f32 v112, v12, v13
    v_cvt_pk_bf16_f32 v113, v14, v15
    v_cvt_pk_bf16_f32 v114, v16, v17
    v_cvt_pk_bf16_f32 v115, v18, v19
    buffer_store_dwordx4 v[112:115], v244, s[12:15], s23 offen sc1
    v_mul_f32 v12, v120, v120
    v_mul_f32 v13, v121, v121
    v_mul_f32 v14, v122, v122
    v_mul_f32 v15, v123, v123
    v_mul_f32 v16, v124, v124
    v_mul_f32 v17, v125, v125
    v_mul_f32 v18, v126, v126
    v_mul_f32 v19, v127, v127
    v_fma_f32 v12, v12, s58, v252
    v_fma_f32 v13, v13, s59, v253
    v_fma_f32 v14, v14, s58, v252
    v_fma_f32 v15, v15, s59, v253
    v_fma_f32 v16, v16, s58, v252
    v_fma_f32 v17, v17, s59, v253
    v_fma_f32 v18, v18, s58, v252
    v_fma_f32 v19, v19, s59, v253
    v_mul_f32 v12, v12, v120
    v_mul_f32 v13, v13, v121
    v_mul_f32 v14, v14, v122
    v_mul_f32 v15, v15, v123
    v_mul_f32 v16, v16, v124
    v_mul_f32 v17, v17, v125
    v_mul_f32 v18, v18, v126
    v_mul_f32 v19, v19, v127
    v_exp_f32 v12, v12
    v_exp_f32 v13, v13
    v_exp_f32 v14, v14
    v_exp_f32 v15, v15
    v_exp_f32 v16, v16
    v_exp_f32 v17, v17
    v_exp_f32 v18, v18
    v_exp_f32 v19, v19
    v_add_f32 v12, 1.0, v12
    v_add_f32 v13, 1.0, v13
    v_add_f32 v14, 1.0, v14
    v_add_f32 v15, 1.0, v15
    v_add_f32 v16, 1.0, v16
    v_add_f32 v17, 1.0, v17
    v_add_f32 v18, 1.0, v18
    v_add_f32 v19, 1.0, v19
    v_rcp_f32 v12, v12
    v_rcp_f32 v13, v13
    v_rcp_f32 v14, v14
    v_rcp_f32 v15, v15
    v_rcp_f32 v16, v16
    v_rcp_f32 v17, v17
    v_rcp_f32 v18, v18
    v_rcp_f32 v19, v19
    v_mul_f32 v12, v12, v120
    v_mul_f32 v13, v13, v121
    v_mul_f32 v14, v14, v122
    v_mul_f32 v15, v15, v123
    v_mul_f32 v16, v16, v124
    v_mul_f32 v17, v17, v125
    v_mul_f32 v18, v18, v126
    v_mul_f32 v19, v19, v127
    v_cvt_pk_bf16_f32 v120, v12, v13
    v_cvt_pk_bf16_f32 v121, v14, v15
    v_cvt_pk_bf16_f32 v122, v16, v17
    v_cvt_pk_bf16_f32 v123, v18, v19
    buffer_store_dwordx4 v[120:123], v244, s[12:15], s23 offen offset:1024 sc1
    s_setprio 0
    s_waitcnt vmcnt(20)
    v_cmp_eq_u32 vcc, v248, v255
    s_nop 3
    s_cmp_eq_u64 vcc, exec
    s_cselect_b32 s66, 1, 0
    s_barrier
    s_add_u32 m0, s61, 0x10000
    s_bfe_u32 s50, s46, 0x4000c
    s_mul_i32 s50, s50, 28672
    s_add_u32 s50, s50, s0
    buffer_load_dwordx4 v243, s[24:27], s50 offen lds
    buffer_load_dwordx4 v251, s[24:27], s50 offen offset:1024 lds
    s_add_u32 m0, s61, 0x10800
    s_add_u32 s50, s50, 14336
    buffer_load_dwordx4 v243, s[24:27], s50 offen lds
    buffer_load_dwordx4 v251, s[24:27], s50 offen offset:1024 lds
    s_waitcnt vmcnt(4)
    s_mov_b64 exec, 1
    s_cmp_eq_u32 s66, 1
    s_cbranch_scc1 hs_7
    buffer_store_dword v11, off, s[12:15], s57 sc1
    s_branch hs_8
hs_7:
    buffer_store_dword v11, off, s[12:15], s57
hs_8:
    s_mov_b64 exec, -1
    s_add_u32 m0, s61, 0x14000
    s_bfe_u32 s50, s46, 0x40010
    s_mul_i32 s50, s50, 28672
    s_add_u32 s50, s50, s0
    buffer_load_dwordx4 v243, s[24:27], s50 offen lds
    buffer_load_dwordx4 v251, s[24:27], s50 offen offset:1024 lds
    s_add_u32 m0, s61, 0x14800
    s_add_u32 s50, s50, 14336
    buffer_load_dwordx4 v243, s[24:27], s50 offen lds
    buffer_load_dwordx4 v251, s[24:27], s50 offen offset:1024 lds
    s_add_u32 m0, s61, 0x18000
    s_bfe_u32 s50, s46, 0x40014
    s_mul_i32 s50, s50, 28672
    s_add_u32 s50, s50, s0
    buffer_load_dwordx4 v243, s[24:27], s50 offen lds
    buffer_load_dwordx4 v251, s[24:27], s50 offen offset:1024 lds
    s_add_u32 m0, s61, 0x18800
    s_add_u32 s50, s50, 14336
    buffer_load_dwordx4 v243, s[24:27], s50 offen lds
    buffer_load_dwordx4 v251, s[24:27], s50 offen offset:1024 lds
    s_add_u32 m0, s61, 0x1c000
    s_bfe_u32 s50, s46, 0x40018
    s_mul_i32 s50, s50, 28672
    s_add_u32 s50, s50, s0
    buffer_load_dwordx4 v243, s[24:27], s50 offen lds
    buffer_load_dwordx4 v251, s[24:27], s50 offen offset:1024 lds
    s_add_u32 m0, s61, 0x1c800
    s_add_u32 s50, s50, 14336
    buffer_load_dwordx4 v243, s[24:27], s50 offen lds
    buffer_load_dwordx4 v251, s[24:27], s50 offen offset:1024 lds
    s_add_u32 m0, s61, 0x20000
    s_and_b32 s50, s2, 1
    s_lshl_b32 s50, s50, 2
    s_and_b32 s49, s47, 3
    s_add_u32 s50, s50, s49
    s_mul_i32 s50, s50, 150528
    s_sub_u32 s50, s0, s50
    buffer_load_dwordx4 v243, s[28:31], s50 offen lds
    buffer_load_dwordx4 v251, s[28:31], s50 offen offset:1024 lds
    s_add_u32 m0, s61, 0x20800
    s_add_u32 s50, s50, 14336
    buffer_load_dwordx4 v243, s[28:31], s50 offen lds
    buffer_load_dwordx4 v251, s[28:31], s50 offen offset:1024 lds
    s_add_u32 m0, s61, 0x24000
    s_and_b32 s50, s2, 1
    s_lshl_b32 s50, s50, 2
    s_and_b32 s49, s47, 3
    s_add_u32 s50, s50, s49
    s_mul_i32 s50, s50, 150528
    s_sub_u32 s50, s0, s50
    s_add_u32 s50, s50, 25088
    buffer_load_dwordx4 v243, s[28:31], s50 offen lds
    buffer_load_dwordx4 v251, s[28:31], s50 offen offset:1024 lds
    s_add_u32 m0, s61, 0x24800
    s_add_u32 s50, s50, 14336
    buffer_load_dwordx4 v243, s[28:31], s50 offen lds
    buffer_load_dwordx4 v251, s[28:31], s50 offen offset:1024 lds
    s_and_b32 s64, s2, 1
    s_lshl_b32 s64, s64, 2
    s_and_b32 s62, s47, 3
    s_add_u32 s64, s64, s62
    s_lshl_b32 s64, s64, 7
    s_add_u32 s7, s64, 0x1500000
    s_bfe_u32 s62, s53, 0x60002
    s_lshl_b32 s62, s62, 10
    s_bfe_u32 s63, s53, 0x20000
    s_lshl_b32 s63, s63, 2
    s_add_u32 s62, s62, s63
    v_mov_b32 v2, s62
    s_bfe_u32 s62, s53, 0x6000a
    s_lshl_b32 s62, s62, 10
    s_bfe_u32 s63, s53, 0x20008
    s_lshl_b32 s63, s63, 2
    s_add_u32 s62, s62, s63
    s_mov_b32 exec_lo, 0xaaaaaaaa
    s_mov_b32 exec_hi, 0xaaaaaaaa
    v_mov_b32 v2, s62
    s_mov_b32 exec_lo, 0
    s_mov_b32 exec_hi, -1
    v_add_u32 v2, 16, v2
    s_mov_b32 exec_lo, -1
    buffer_load_dword v10, v2, s[12:15], s7 offen sc1
    s_branch phase2
ffn_ch1:
    v_subrev_u32 v2, 57344, v2
    v_subrev_u32 v3, 57344, v3
    v_subrev_u32 v4, 114688, v4
    s_waitcnt vmcnt(5) lgkmcnt(0)
    s_barrier
    ds_read_b128 v[128:131], v5
    ds_read_b128 v[132:135], v6
    ds_read_b128 v[136:139], v7
    ds_read_b128 v[140:143], v8
    s_lshl_b32 s3, s55, 1
    s_lshl_b32 s49, s48, 7
    s_add_u32 s49, s49, s51
    s_mul_i32 s50, s48, 229376
    s_add_u32 s50, s50, s52
    s_add_u32 m0, s3, 0xffffe000
    s_nop 0
    buffer_load_dwordx4 v2, s[4:7], s49 offen lds
    s_add_u32 m0, s55, 0x3000
    s_nop 0
    buffer_load_dwordx4 v4, s[8:11], s50 offen lds
    s_add_u32 m0, s3, 0xffffe400
    s_nop 0
    buffer_load_dwordx4 v3, s[4:7], s49 offen lds
    s_add_u32 m0, s55, 0x5000
    s_add_u32 s50, s50, 128
    buffer_load_dwordx4 v4, s[8:11], s50 offen lds
    s_add_u32 s49, s49, 57344
    s_add_u32 s50, s50, 114560
    s_add_u32 m0, s3, 0x0
    s_nop 0
    buffer_load_dwordx4 v2, s[4:7], s49 offen lds
    s_add_u32 m0, s55, 0x4000
    s_nop 0
    buffer_load_dwordx4 v4, s[8:11], s50 offen lds
    s_add_u32 m0, s3, 0x400
    s_nop 0
    buffer_load_dwordx4 v3, s[4:7], s49 offen lds
    s_add_u32 m0, s55, 0x6000
    s_add_u32 s50, s50, 128
    buffer_load_dwordx4 v4, s[8:11], s50 offen lds
    s_add_u32 s48, s48, 1
    s_cmp_eq_u32 s48, 7
    s_cselect_b32 s48, 0, s48
    s_waitcnt vmcnt(9) lgkmcnt(0)
    s_barrier
    v_add_u32 v5, 0x8000, v5
    v_add_u32 v6, 0x8000, v6
    v_add_u32 v7, 0x8000, v7
    v_add_u32 v8, 0x8000, v8
    ds_read_b128 v[144:147], v5
    ds_read_b128 v[148:151], v6
    ds_read_b128 v[152:155], v7
    ds_read_b128 v[156:159], v8
    s_lshl_b32 s3, s55, 1
    s_lshl_b32 s49, s48, 7
    s_add_u32 s49, s49, s51
    s_mul_i32 s50, s48, 229376
    s_add_u32 s50, s50, s52
    s_add_u32 m0, s3, 0x6000
    s_nop 0
    buffer_load_dwordx4 v2, s[4:7], s49 offen lds
    s_add_u32 m0, s55, 0xb000
    s_nop 0
    buffer_load_dwordx4 v4, s[8:11], s50 offen lds
    s_add_u32 m0, s3, 0x6400
    s_nop 0
    buffer_load_dwordx4 v3, s[4:7], s49 offen lds
    s_add_u32 m0, s55, 0xd000
    s_add_u32 s50, s50, 128
    buffer_load_dwordx4 v4, s[8:11], s50 offen lds
    s_add_u32 s49, s49, 57344
    s_add_u32 s50, s50, 114560
    s_add_u32 m0, s3, 0x8000
    s_nop 0
    buffer_load_dwordx4 v2, s[4:7], s49 offen lds
    s_add_u32 m0, s55, 0xc000
    s_nop 0
    buffer_load_dwordx4 v4, s[8:11], s50 offen lds
    s_add_u32 m0, s3, 0x8400
    s_nop 0
    buffer_load_dwordx4 v3, s[4:7], s49 offen lds
    s_add_u32 m0, s55, 0xe000
    s_add_u32 s50, s50, 128
    buffer_load_dwordx4 v4, s[8:11], s50 offen lds
    s_add_u32 s48, s48, 1
    s_cmp_eq_u32 s48, 7
    s_cselect_b32 s48, 0, s48
    buffer_load_dword v11, off, s[40:43], 0 sc1
    s_waitcnt vmcnt(9) lgkmcnt(0)
    s_barrier
    v_add_u32 v5, 0xffff0000, v5
    v_add_u32 v6, 0xffff0000, v6
    v_add_u32 v7, 0xffff0000, v7
    v_add_u32 v8, 0xffff0000, v8
    ds_read_b128 v[160:163], v5
    ds_read_b128 v[164:167], v6
    ds_read_b128 v[168:171], v7
    ds_read_b128 v[172:175], v8
    s_lshl_b32 s3, s55, 1
    s_lshl_b32 s49, s48, 7
    s_add_u32 s49, s49, s51
    s_mul_i32 s50, s48, 229376
    s_add_u32 s50, s50, s52
    s_add_u32 m0, s3, 0xe000
    s_nop 0
    buffer_load_dwordx4 v2, s[4:7], s49 offen lds
    s_add_u32 m0, s55, 0x13000
    s_nop 0
    buffer_load_dwordx4 v4, s[8:11], s50 offen lds
    s_add_u32 m0, s3, 0xe400
    s_nop 0
    buffer_load_dwordx4 v3, s[4:7], s49 offen lds
    s_add_u32 m0, s55, 0x15000
    s_add_u32 s50, s50, 128
    buffer_load_dwordx4 v4, s[8:11], s50 offen lds
    s_add_u32 s49, s49, 57344
    s_add_u32 s50, s50, 114560
    s_add_u32 m0, s3, 0x10000
    s_nop 0
    buffer_load_dwordx4 v2, s[4:7], s49 offen lds
    s_add_u32 m0, s55, 0x14000
    s_nop 0
    buffer_load_dwordx4 v4, s[8:11], s50 offen lds
    s_add_u32 m0, s3, 0x10400
    s_nop 0
    buffer_load_dwordx4 v3, s[4:7], s49 offen lds
    s_add_u32 m0, s55, 0x16000
    s_add_u32 s50, s50, 128
    buffer_load_dwordx4 v4, s[8:11], s50 offen lds
    s_add_u32 s48, s48, 1
    s_cmp_eq_u32 s48, 7
    s_cselect_b32 s48, 0, s48
    s_waitcnt vmcnt(9) lgkmcnt(0)
    s_barrier
    v_add_u32 v5, 0x8000, v5
    v_add_u32 v6, 0x8000, v6
    v_add_u32 v7, 0x8000, v7
    v_add_u32 v8, 0x8000, v8
    ds_read_b128 v[176:179], v5
    ds_read_b128 v[180:183], v6
    ds_read_b128 v[184:187], v7
    ds_read_b128 v[188:191], v8
    s_lshl_b32 s3, s55, 1
    s_lshl_b32 s49, s48, 7
    s_add_u32 s49, s49, s51
    s_mul_i32 s50, s48, 229376
    s_add_u32 s50, s50, s52
    s_add_u32 m0, s3, 0xffffe000
    s_nop 0
    buffer_load_dwordx4 v2, s[4:7], s49 offen lds
    s_add_u32 m0, s55, 0x3000
    s_nop 0
    buffer_load_dwordx4 v4, s[8:11], s50 offen lds
    s_add_u32 m0, s3, 0xffffe400
    s_nop 0
    buffer_load_dwordx4 v3, s[4:7], s49 offen lds
    s_add_u32 m0, s55, 0x5000
    s_add_u32 s50, s50, 128
    buffer_load_dwordx4 v4, s[8:11], s50 offen lds
    s_add_u32 s49, s49, 57344
    s_add_u32 s50, s50, 114560
    s_add_u32 m0, s3, 0x0
    s_nop 0
    buffer_load_dwordx4 v2, s[4:7], s49 offen lds
    s_add_u32 m0, s55, 0x4000
    s_nop 0
    buffer_load_dwordx4 v4, s[8:11], s50 offen lds
    s_add_u32 m0, s3, 0x400
    s_nop 0
    buffer_load_dwordx4 v3, s[4:7], s49 offen lds
    s_add_u32 m0, s55, 0x6000
    s_add_u32 s50, s50, 128
    buffer_load_dwordx4 v4, s[8:11], s50 offen lds
    s_add_u32 s48, s48, 1
    s_cmp_eq_u32 s48, 7
    s_cselect_b32 s48, 0, s48
    s_waitcnt vmcnt(16)
    v_cmp_ne_u32 vcc, 0, v11
    s_nop 3
    s_cmp_eq_u64 vcc, exec
    s_cbranch_scc1 pd_9
    s_mov_b32 s3, 200000
pl_10:
    s_sleep 1
    buffer_load_dword v11, off, s[40:43], 0 sc1
    s_waitcnt vmcnt(0)
    v_cmp_ne_u32 vcc, 0, v11
    s_nop 3
    s_cmp_eq_u64 vcc, exec
    s_cbranch_scc1 pd_9
    s_sub_u32 s3, s3, 1
    s_cbranch_scc0 pl_10
pd_9:
    s_getreg_b32 s62, hwreg(HW_REG_XCC_ID, 0, 4)
    s_lshl_b32 s62, s62, 1
    s_add_u32 s62, s62, 2
    v_add_u32 v255, s62, v11
    s_and_b32 s66, s2, 7
    s_lshl_b32 s66, s66, 7
    s_add_u32 s66, s66, 0x1520000
    s_cmp_lg_u32 s47, 0
    s_cbranch_scc1 xp_11
    s_lshr_b32 s63, s2, 3
    s_lshl_b32 s63, s63, 2
    s_add_u32 s63, s63, s66
    s_mov_b64 exec, 1
    buffer_store_dword v255, off, s[12:15], s63
    s_mov_b64 exec, -1
xp_11:
    s_waitcnt vmcnt(8) lgkmcnt(0)
    s_barrier
    v_add_u32 v5, 0x8000, v5
    v_add_u32 v6, 0x8000, v6
    v_add_u32 v7, 0x8000, v7
    v_add_u32 v8, 0x8000, v8
    ds_read_b128 v[192:195], v5
    ds_read_b128 v[196:199], v6
    ds_read_b128 v[200:203], v7
    ds_read_b128 v[204:207], v8
    s_lshl_b32 s3, s55, 1
    s_lshl_b32 s49, s48, 7
    s_add_u32 s49, s49, s51
    s_mul_i32 s50, s48, 229376
    s_add_u32 s50, s50, s52
    s_add_u32 m0, s3, 0x6000
    s_nop 0
    buffer_load_dwordx4 v2, s[4:7], s49 offen lds
    s_add_u32 m0, s55, 0xb000
    s_nop 0
    buffer_load_dwordx4 v4, s[8:11], s50 offen lds
    s_add_u32 m0, s3, 0x6400
    s_nop 0
    buffer_load_dwordx4 v3, s[4:7], s49 offen lds
    s_add_u32 m0, s55, 0xd000
    s_add_u32 s50, s50, 128
    buffer_load_dwordx4 v4, s[8:11], s50 offen lds
    s_add_u32 s49, s49, 57344
    s_add_u32 s50, s50, 114560
    s_add_u32 m0, s3, 0x8000
    s_nop 0
    buffer_load_dwordx4 v2, s[4:7], s49 offen lds
    s_add_u32 m0, s55, 0xc000
    s_nop 0
    buffer_load_dwordx4 v4, s[8:11], s50 offen lds
    s_add_u32 m0, s3, 0x8400
    s_nop 0
    buffer_load_dwordx4 v3, s[4:7], s49 offen lds
    s_add_u32 m0, s55, 0xe000
    s_add_u32 s50, s50, 128
    buffer_load_dwordx4 v4, s[8:11], s50 offen lds
    s_add_u32 s48, s48, 1
    s_cmp_eq_u32 s48, 7
    s_cselect_b32 s48, 0, s48
    s_mov_b32 s60, s48
    s_waitcnt vmcnt(8) lgkmcnt(0)
    s_barrier
    v_add_u32 v5, 0xffff0000, v5
    v_add_u32 v6, 0xffff0000, v6
    v_add_u32 v7, 0xffff0000, v7
    v_add_u32 v8, 0xffff0000, v8
    ds_read_b128 v[208:211], v5
    ds_read_b128 v[212:215], v6
    ds_read_b128 v[216:219], v7
    ds_read_b128 v[220:223], v8
    s_mul_i32 s50, s48, 229376
    s_add_u32 s50, s50, s52
    s_add_u32 s50, s50, 256
    s_add_u32 m0, s55, 0x17000
    s_nop 0
    buffer_load_dwordx4 v4, s[8:11], s50 offen lds
    s_add_u32 m0, s55, 0x18000
    s_add_u32 s50, s50, 114688
    buffer_load_dwordx4 v4, s[8:11], s50 offen lds
    s_add_u32 s48, s48, 1
    s_cmp_eq_u32 s48, 7
    s_cselect_b32 s48, 0, s48
    s_mul_i32 s50, s60, 229376
    s_add_u32 s50, s50, s52
    s_add_u32 s50, s50, s56
    s_add_u32 m0, s55, 0xf000
    s_add_u32 s50, s50, 256
    buffer_load_dwordx4 v242, s[8:11], s50 offen lds
    s_add_u32 s60, s60, 1
    s_cmp_eq_u32 s60, 7
    s_cselect_b32 s60, 0, s60
    s_mul_i32 s50, s48, 229376
    s_add_u32 s50, s50, s52
    s_add_u32 s50, s50, 256
    s_add_u32 m0, s55, 0x19000
    s_nop 0
    buffer_load_dwordx4 v4, s[8:11], s50 offen lds
    s_add_u32 m0, s55, 0x1a000
    s_add_u32 s50, s50, 114688
    buffer_load_dwordx4 v4, s[8:11], s50 offen lds
    s_add_u32 s48, s48, 1
    s_cmp_eq_u32 s48, 7
    s_cselect_b32 s48, 0, s48
    s_mul_i32 s50, s60, 229376
    s_add_u32 s50, s50, s52
    s_add_u32 s50, s50, s56
    s_add_u32 m0, s55, 0x10000
    s_add_u32 s50, s50, 256
    buffer_load_dwordx4 v242, s[8:11], s50 offen lds
    s_add_u32 s60, s60, 1
    s_cmp_eq_u32 s60, 7
    s_cselect_b32 s60, 0, s60
    s_mul_i32 s50, s48, 229376
    s_add_u32 s50, s50, s52
    s_add_u32 s50, s50, 256
    s_add_u32 m0, s55, 0x1b000
    s_nop 0
    buffer_load_dwordx4 v4, s[8:11], s50 offen lds
    s_add_u32 m0, s55, 0x1c000
    s_add_u32 s50, s50, 114688
    buffer_load_dwordx4 v4, s[8:11], s50 offen lds
    s_add_u32 s48, s48, 1
    s_cmp_eq_u32 s48, 7
    s_cselect_b32 s48, 0, s48
    s_mul_i32 s50, s60, 229376
    s_add_u32 s50, s50, s52
    s_add_u32 s50, s50, s56
    s_add_u32 m0, s55, 0x11000
    s_add_u32 s50, s50, 256
    buffer_load_dwordx4 v242, s[8:11], s50 offen lds
    s_add_u32 s60, s60, 1
    s_cmp_eq_u32 s60, 7
    s_cselect_b32 s60, 0, s60
    s_waitcnt vmcnt(9) lgkmcnt(0)
    s_barrier
    v_add_u32 v5, 0x8000, v5
    v_add_u32 v6, 0x8000, v6
    v_add_u32 v7, 0x8000, v7
    v_add_u32 v8, 0x8000, v8
    ds_read_b128 v[224:227], v5
    ds_read_b128 v[228:231], v6
    ds_read_b128 v[232:235], v7
    ds_read_b128 v[236:239], v8
    s_mul_i32 s50, s48, 229376
    s_add_u32 s50, s50, s52
    s_add_u32 s50, s50, 256
    s_add_u32 m0, s55, 0x1d000
    s_nop 0
    buffer_load_dwordx4 v4, s[8:11], s50 offen lds
    s_add_u32 m0, s55, 0x1e000
    s_add_u32 s50, s50, 114688
    buffer_load_dwordx4 v4, s[8:11], s50 offen lds
    s_add_u32 s48, s48, 1
    s_cmp_eq_u32 s48, 7
    s_cselect_b32 s48, 0, s48
    s_mul_i32 s50, s60, 229376
    s_add_u32 s50, s50, s52
    s_add_u32 s50, s50, s56
    s_add_u32 m0, s55, 0x12000
    s_add_u32 s50, s50, 256
    buffer_load_dwordx4 v242, s[8:11], s50 offen lds
    s_add_u32 s60, s60, 1
    s_cmp_eq_u32 s60, 7
    s_cselect_b32 s60, 0, s60
    s_mul_i32 s50, s48, 229376
    s_add_u32 s50, s50, s52
    s_add_u32 s50, s50, 256
    s_add_u32 m0, s55, 0x1f000
    s_nop 0
    buffer_load_dwordx4 v4, s[8:11], s50 offen lds
    s_add_u32 m0, s55, 0x20000
    s_add_u32 s50, s50, 114688
    buffer_load_dwordx4 v4, s[8:11], s50 offen lds
    s_add_u32 s48, s48, 1
    s_cmp_eq_u32 s48, 7
    s_cselect_b32 s48, 0, s48
    s_mul_i32 s50, s60, 229376
    s_add_u32 s50, s50, s52
    s_add_u32 s50, s50, s56
    s_add_u32 m0, s55, 0x13000
    s_add_u32 s50, s50, 256
    buffer_load_dwordx4 v242, s[8:11], s50 offen lds
    s_add_u32 s60, s60, 1
    s_cmp_eq_u32 s60, 7
    s_cselect_b32 s60, 0, s60
    v_mfma_f32_32x32x16_bf16 v[32:47], v[20:23], v[28:31], 0
    v_mfma_f32_32x32x16_bf16 v[48:63], v[22:25], v[28:31], 0
    v_mfma_f32_32x32x16_bf16 v[96:111], v[24:27], v[28:31], 0
    v_and_b32 v250, 3, v1
    v_lshlrev_b32 v250, 2, v250
    v_add_u32 v250, 155648, v250
    s_waitcnt vmcnt(6) lgkmcnt(0)
    s_barrier
    s_mul_i32 s50, s48, 229376
    s_add_u32 s50, s50, s52
    s_add_u32 s50, s50, 256
    s_add_u32 m0, s55, 0x21000
    s_nop 0
    buffer_load_dwordx4 v4, s[8:11], s50 offen lds
    s_add_u32 m0, s55, 0x22000
    s_add_u32 s50, s50, 114688
    buffer_load_dwordx4 v4, s[8:11], s50 offen lds
    s_add_u32 s48, s48, 1
    s_cmp_eq_u32 s48, 7
    s_cselect_b32 s48, 0, s48
    s_mul_i32 s50, s60, 229376
    s_add_u32 s50, s50, s52
    s_add_u32 s50, s50, s56
    s_add_u32 m0, s55, 0x14000
    s_add_u32 s50, s50, 256
    buffer_load_dwordx4 v242, s[8:11], s50 offen lds
    s_add_u32 s60, s60, 1
    s_cmp_eq_u32 s60, 7
    s_cselect_b32 s60, 0, s60
    s_mul_i32 s50, s48, 229376
    s_add_u32 s50, s50, s52
    s_add_u32 s50, s50, 256
    s_add_u32 m0, s55, 0x23000
    s_nop 0
    buffer_load_dwordx4 v4, s[8:11], s50 offen lds
    s_add_u32 m0, s55, 0x24000
    s_add_u32 s50, s50, 114688
    buffer_load_dwordx4 v4, s[8:11], s50 offen lds
    s_add_u32 s48, s48, 1
    s_cmp_eq_u32 s48, 7
    s_cselect_b32 s48, 0, s48
    s_mul_i32 s50, s60, 229376
    s_add_u32 s50, s50, s52
    s_add_u32 s50, s50, s56
    s_add_u32 m0, s55, 0x15000
    s_add_u32 s50, s50, 256
    buffer_load_dwordx4 v242, s[8:11], s50 offen lds
    s_add_u32 s60, s60, 1
    s_cmp_eq_u32 s60, 7
    s_cselect_b32 s60, 0, s60
    v_and_b32 v248, 31, v1
    v_lshlrev_b32 v248, 2, v248
    buffer_load_dword v248, v248, s[12:15], s66 offen sc1
    s_setprio 2
    ds_read_b64_tr_b16 v[64:65], v9 offset:0
    ds_read_b64_tr_b16 v[66:67], v9 offset:512
    ds_read_b64_tr_b16 v[68:69], v10 offset:0
    ds_read_b64_tr_b16 v[70:71], v10 offset:512
    ds_read_b64_tr_b16 v[72:73], v241 offset:0
    ds_read_b64_tr_b16 v[74:75], v241 offset:256
    ds_read_b64_tr_b16 v[76:77], v9 offset:2048
    ds_read_b64_tr_b16 v[78:79], v9 offset:2560
    ds_read_b64_tr_b16 v[80:81], v10 offset:2048
    ds_read_b64_tr_b16 v[82:83], v10 offset:2560
    ds_read_b64_tr_b16 v[84:85], v241 offset:1024
    ds_read_b64_tr_b16 v[86:87], v241 offset:1280
    s_waitcnt lgkmcnt(6)
    v_mfma_f32_32x32x16_bf16 v[32:47], v[64:67], v[128:131], v[32:47]
    ds_read_b64_tr_b16 v[88:89], v9 offset:4096
    ds_read_b64_tr_b16 v[90:91], v9 offset:4608
    ds_read_b64_tr_b16 v[92:93], v10 offset:4096
    ds_read_b64_tr_b16 v[94:95], v10 offset:4608
    ds_read_b64_tr_b16 v[112:113], v241 offset:2048
    ds_read_b64_tr_b16 v[114:115], v241 offset:2304
    v_mfma_f32_32x32x16_bf16 v[48:63], v[68:71], v[128:131], v[48:63]
    v_mfma_f32_32x32x16_bf16 v[96:111], v[72:75], v[128:131], v[96:111]
    s_waitcnt lgkmcnt(6)
    v_mfma_f32_32x32x16_bf16 v[32:47], v[76:79], v[132:135], v[32:47]
    ds_read_b64_tr_b16 v[116:117], v9 offset:6144
    ds_read_b64_tr_b16 v[118:119], v9 offset:6656
    ds_read_b64_tr_b16 v[120:121], v10 offset:6144
    ds_read_b64_tr_b16 v[122:123], v10 offset:6656
    ds_read_b64_tr_b16 v[124:125], v241 offset:3072
    ds_read_b64_tr_b16 v[126:127], v241 offset:3328
    v_mfma_f32_32x32x16_bf16 v[48:63], v[80:83], v[132:135], v[48:63]
    v_mfma_f32_32x32x16_bf16 v[96:111], v[84:87], v[132:135], v[96:111]
    s_waitcnt lgkmcnt(6)
    v_mfma_f32_32x32x16_bf16 v[32:47], v[88:91], v[136:139], v[32:47]
    ds_read_b64_tr_b16 v[64:65], v9 offset:8192
    ds_read_b64_tr_b16 v[66:67], v9 offset:8704
    ds_read_b64_tr_b16 v[68:69], v10 offset:8192
    ds_read_b64_tr_b16 v[70:71], v10 offset:8704
    ds_read_b64_tr_b16 v[72:73], v241 offset:4096
    ds_read_b64_tr_b16 v[74:75], v241 offset:4352
    v_mfma_f32_32x32x16_bf16 v[48:63], v[92:95], v[136:139], v[48:63]
    v_mfma_f32_32x32x16_bf16 v[96:111], v[112:115], v[136:139], v[96:111]
    s_waitcnt lgkmcnt(6)
    v_mfma_f32_32x32x16_bf16 v[32:47], v[116:119], v[140:143], v[32:47]
    ds_read_b64_tr_b16 v[76:77], v9 offset:10240
    ds_read_b64_tr_b16 v[78:79], v9 offset:10752
    ds_read_b64_tr_b16 v[80:81], v10 offset:10240
    ds_read_b64_tr_b16 v[82:83], v10 offset:10752
    ds_read_b64_tr_b16 v[84:85], v241 offset:5120
    ds_read_b64_tr_b16 v[86:87], v241 offset:5376
    v_mfma_f32_32x32x16_bf16 v[48:63], v[120:123], v[140:143], v[48:63]
    v_mfma_f32_32x32x16_bf16 v[96:111], v[124:127], v[140:143], v[96:111]
    s_waitcnt lgkmcnt(6)
    v_mfma_f32_32x32x16_bf16 v[32:47], v[64:67], v[144:147], v[32:47]
    ds_read_b64_tr_b16 v[88:89], v9 offset:12288
    ds_read_b64_tr_b16 v[90:91], v9 offset:12800
    ds_read_b64_tr_b16 v[92:93], v10 offset:12288
    ds_read_b64_tr_b16 v[94:95], v10 offset:12800
    ds_read_b64_tr_b16 v[112:113], v241 offset:6144
    ds_read_b64_tr_b16 v[114:115], v241 offset:6400
    v_mfma_f32_32x32x16_bf16 v[48:63], v[68:71], v[144:147], v[48:63]
    v_mfma_f32_32x32x16_bf16 v[96:111], v[72:75], v[144:147], v[96:111]
    s_waitcnt lgkmcnt(6)
    v_mfma_f32_32x32x16_bf16 v[32:47], v[76:79], v[148:151], v[32:47]
    ds_read_b64_tr_b16 v[116:117], v9 offset:14336
    ds_read_b64_tr_b16 v[118:119], v9 offset:14848
    ds_read_b64_tr_b16 v[120:121], v10 offset:14336
    ds_read_b64_tr_b16 v[122:123], v10 offset:14848
    ds_read_b64_tr_b16 v[124:125], v241 offset:7168
    ds_read_b64_tr_b16 v[126:127], v241 offset:7424
    v_mfma_f32_32x32x16_bf16 v[48:63], v[80:83], v[148:151], v[48:63]
    v_mfma_f32_32x32x16_bf16 v[96:111], v[84:87], v[148:151], v[96:111]
    s_waitcnt lgkmcnt(6)
    v_mfma_f32_32x32x16_bf16 v[32:47], v[88:91], v[152:155], v[32:47]
    ds_read_b64_tr_b16 v[64:65], v9 offset:16384
    ds_read_b64_tr_b16 v[66:67], v9 offset:16896
    ds_read_b64_tr_b16 v[68:69], v10 offset:16384
    ds_read_b64_tr_b16 v[70:71], v10 offset:16896
    ds_read_b64_tr_b16 v[72:73], v241 offset:8192
    ds_read_b64_tr_b16 v[74:75], v241 offset:8448
    v_mfma_f32_32x32x16_bf16 v[48:63], v[92:95], v[152:155], v[48:63]
    v_mfma_f32_32x32x16_bf16 v[96:111], v[112:115], v[152:155], v[96:111]
    s_waitcnt lgkmcnt(6)
    v_mfma_f32_32x32x16_bf16 v[32:47], v[116:119], v[156:159], v[32:47]
    ds_read_b64_tr_b16 v[76:77], v9 offset:18432
    ds_read_b64_tr_b16 v[78:79], v9 offset:18944
    ds_read_b64_tr_b16 v[80:81], v10 offset:18432
    ds_read_b64_tr_b16 v[82:83], v10 offset:18944
    ds_read_b64_tr_b16 v[84:85], v241 offset:9216
    ds_read_b64_tr_b16 v[86:87], v241 offset:9472
    v_mfma_f32_32x32x16_bf16 v[48:63], v[120:123], v[156:159], v[48:63]
    v_mfma_f32_32x32x16_bf16 v[96:111], v[124:127], v[156:159], v[96:111]
    s_waitcnt lgkmcnt(6)
    v_mfma_f32_32x32x16_bf16 v[32:47], v[64:67], v[160:163], v[32:47]
    ds_read_b64_tr_b16 v[88:89], v9 offset:20480
    ds_read_b64_tr_b16 v[90:91], v9 offset:20992
    ds_read_b64_tr_b16 v[92:93], v10 offset:20480
    ds_read_b64_tr_b16 v[94:95], v10 offset:20992
    ds_read_b64_tr_b16 v[112:113], v241 offset:10240
    ds_read_b64_tr_b16 v[114:115], v241 offset:10496
    v_mfma_f32_32x32x16_bf16 v[48:63], v[68:71], v[160:163], v[48:63]
    v_mfma_f32_32x32x16_bf16 v[96:111], v[72:75], v[160:163], v[96:111]
    s_waitcnt lgkmcnt(6)
    v_mfma_f32_32x32x16_bf16 v[32:47], v[76:79], v[164:167], v[32:47]
    ds_read_b64_tr_b16 v[116:117], v9 offset:22528
    ds_read_b64_tr_b16 v[118:119], v9 offset:23040
    ds_read_b64_tr_b16 v[120:121], v10 offset:22528
    ds_read_b64_tr_b16 v[122:123], v10 offset:23040
    ds_read_b64_tr_b16 v[124:125], v241 offset:11264
    ds_read_b64_tr_b16 v[126:127], v241 offset:11520
    v_mfma_f32_32x32x16_bf16 v[48:63], v[80:83], v[164:167], v[48:63]
    v_mfma_f32_32x32x16_bf16 v[96:111], v[84:87], v[164:167], v[96:111]
    s_waitcnt lgkmcnt(6)
    v_mfma_f32_32x32x16_bf16 v[32:47], v[88:91], v[168:171], v[32:47]
    s_waitcnt vmcnt(1)
    s_lshl_b64 exec, 1, s47
    ds_write_b32 v250, v11
    s_mov_b64 exec, -1
    s_mov_b32 s3, 2000000
gs_12:
    ds_read_b32 v249, v250
    s_waitcnt lgkmcnt(0)
    v_cmp_eq_u32 vcc, v11, v249
    s_nop 3
    s_cmp_eq_u64 vcc, exec
    s_cbranch_scc1 gs_13
    s_sub_u32 s3, s3, 1
    s_cbranch_scc0 gs_12
gs_13:
    ds_read_b64_tr_b16 v[64:65], v9 offset:24576
    ds_read_b64_tr_b16 v[66:67], v9 offset:25088
    ds_read_b64_tr_b16 v[68:69], v10 offset:24576
    ds_read_b64_tr_b16 v[70:71], v10 offset:25088
    ds_read_b64_tr_b16 v[72:73], v241 offset:12288
    ds_read_b64_tr_b16 v[74:75], v241 offset:12544
    v_mfma_f32_32x32x16_bf16 v[48:63], v[92:95], v[168:171], v[48:63]
    v_mfma_f32_32x32x16_bf16 v[96:111], v[112:115], v[168:171], v[96:111]
    s_waitcnt lgkmcnt(6)
    v_mfma_f32_32x32x16_bf16 v[32:47], v[116:119], v[172:175], v[32:47]
    ds_read_b64_tr_b16 v[76:77], v9 offset:26624
    ds_read_b64_tr_b16 v[78:79], v9 offset:27136
    ds_read_b64_tr_b16 v[80:81], v10 offset:26624
    ds_read_b64_tr_b16 v[82:83], v10 offset:27136
    ds_read_b64_tr_b16 v[84:85], v241 offset:13312
    ds_read_b64_tr_b16 v[86:87], v241 offset:13568
    v_mfma_f32_32x32x16_bf16 v[48:63], v[120:123], v[172:175], v[48:63]
    v_mfma_f32_32x32x16_bf16 v[96:111], v[124:127], v[172:175], v[96:111]
    s_waitcnt lgkmcnt(6)
    v_mfma_f32_32x32x16_bf16 v[32:47], v[64:67], v[176:179], v[32:47]
    ds_read_b64_tr_b16 v[88:89], v9 offset:28672
    ds_read_b64_tr_b16 v[90:91], v9 offset:29184
    ds_read_b64_tr_b16 v[92:93], v10 offset:28672
    ds_read_b64_tr_b16 v[94:95], v10 offset:29184
    ds_read_b64_tr_b16 v[112:113], v241 offset:14336
    ds_read_b64_tr_b16 v[114:115], v241 offset:14592
    v_mfma_f32_32x32x16_bf16 v[48:63], v[68:71], v[176:179], v[48:63]
    v_mfma_f32_32x32x16_bf16 v[96:111], v[72:75], v[176:179], v[96:111]
    s_waitcnt lgkmcnt(6)
    v_mfma_f32_32x32x16_bf16 v[32:47], v[76:79], v[180:183], v[32:47]
    ds_read_b64_tr_b16 v[116:117], v9 offset:30720
    ds_read_b64_tr_b16 v[118:119], v9 offset:31232
    ds_read_b64_tr_b16 v[120:121], v10 offset:30720
    ds_read_b64_tr_b16 v[122:123], v10 offset:31232
    ds_read_b64_tr_b16 v[124:125], v241 offset:15360
    ds_read_b64_tr_b16 v[126:127], v241 offset:15616
    v_mfma_f32_32x32x16_bf16 v[48:63], v[80:83], v[180:183], v[48:63]
    v_mfma_f32_32x32x16_bf16 v[96:111], v[84:87], v[180:183], v[96:111]
    s_waitcnt lgkmcnt(6)
    v_mfma_f32_32x32x16_bf16 v[32:47], v[88:91], v[184:187], v[32:47]
    ds_read_b64_tr_b16 v[64:65], v9 offset:32768
    ds_read_b64_tr_b16 v[66:67], v9 offset:33280
    ds_read_b64_tr_b16 v[68:69], v10 offset:32768
    ds_read_b64_tr_b16 v[70:71], v10 offset:33280
    ds_read_b64_tr_b16 v[72:73], v241 offset:16384
    ds_read_b64_tr_b16 v[74:75], v241 offset:16640
    v_mfma_f32_32x32x16_bf16 v[48:63], v[92:95], v[184:187], v[48:63]
    v_mfma_f32_32x32x16_bf16 v[96:111], v[112:115], v[184:187], v[96:111]
    s_waitcnt lgkmcnt(6)
    v_mfma_f32_32x32x16_bf16 v[32:47], v[116:119], v[188:191], v[32:47]
    ds_read_b64_tr_b16 v[76:77], v9 offset:34816
    ds_read_b64_tr_b16 v[78:79], v9 offset:35328
    ds_read_b64_tr_b16 v[80:81], v10 offset:34816
    ds_read_b64_tr_b16 v[82:83], v10 offset:35328
    ds_read_b64_tr_b16 v[84:85], v241 offset:17408
    ds_read_b64_tr_b16 v[86:87], v241 offset:17664
    v_mfma_f32_32x32x16_bf16 v[48:63], v[120:123], v[188:191], v[48:63]
    v_mfma_f32_32x32x16_bf16 v[96:111], v[124:127], v[188:191], v[96:111]
    s_waitcnt lgkmcnt(6)
    v_mfma_f32_32x32x16_bf16 v[32:47], v[64:67], v[192:195], v[32:47]
    ds_read_b64_tr_b16 v[88:89], v9 offset:36864
    ds_read_b64_tr_b16 v[90:91], v9 offset:37376
    ds_read_b64_tr_b16 v[92:93], v10 offset:36864
    ds_read_b64_tr_b16 v[94:95], v10 offset:37376
    ds_read_b64_tr_b16 v[112:113], v241 offset:18432
    ds_read_b64_tr_b16 v[114:115], v241 offset:18688
    v_mfma_f32_32x32x16_bf16 v[48:63], v[68:71], v[192:195], v[48:63]
    v_mfma_f32_32x32x16_bf16 v[96:111], v[72:75], v[192:195], v[96:111]
    s_waitcnt lgkmcnt(6)
    v_mfma_f32_32x32x16_bf16 v[32:47], v[76:79], v[196:199], v[32:47]
    ds_read_b64_tr_b16 v[116:117], v9 offset:38912
    ds_read_b64_tr_b16 v[118:119], v9 offset:39424
    ds_read_b64_tr_b16 v[120:121], v10 offset:38912
    ds_read_b64_tr_b16 v[122:123], v10 offset:39424
    ds_read_b64_tr_b16 v[124:125], v241 offset:19456
    ds_read_b64_tr_b16 v[126:127], v241 offset:19712
    v_mfma_f32_32x32x16_bf16 v[48:63], v[80:83], v[196:199], v[48:63]
    v_mfma_f32_32x32x16_bf16 v[96:111], v[84:87], v[196:199], v[96:111]
    s_waitcnt lgkmcnt(6)
    v_mfma_f32_32x32x16_bf16 v[32:47], v[88:91], v[200:203], v[32:47]
    ds_read_b64_tr_b16 v[64:65], v9 offset:40960
    ds_read_b64_tr_b16 v[66:67], v9 offset:41472
    ds_read_b64_tr_b16 v[68:69], v10 offset:40960
    ds_read_b64_tr_b16 v[70:71], v10 offset:41472
    ds_read_b64_tr_b16 v[72:73], v241 offset:20480
    ds_read_b64_tr_b16 v[74:75], v241 offset:20736
    v_mfma_f32_32x32x16_bf16 v[48:63], v[92:95], v[200:203], v[48:63]
    v_mfma_f32_32x32x16_bf16 v[96:111], v[112:115], v[200:203], v[96:111]
    s_waitcnt lgkmcnt(6)
    v_mfma_f32_32x32x16_bf16 v[32:47], v[116:119], v[204:207], v[32:47]
    ds_read_b64_tr_b16 v[76:77], v9 offset:43008
    ds_read_b64_tr_b16 v[78:79], v9 offset:43520
    ds_read_b64_tr_b16 v[80:81], v10 offset:43008
    ds_read_b64_tr_b16 v[82:83], v10 offset:43520
    ds_read_b64_tr_b16 v[84:85], v241 offset:21504
    ds_read_b64_tr_b16 v[86:87], v241 offset:21760
    v_mfma_f32_32x32x16_bf16 v[48:63], v[120:123], v[204:207], v[48:63]
    v_mfma_f32_32x32x16_bf16 v[96:111], v[124:127], v[204:207], v[96:111]
    s_waitcnt lgkmcnt(6)
    v_mfma_f32_32x32x16_bf16 v[32:47], v[64:67], v[208:211], v[32:47]
    ds_read_b64_tr_b16 v[88:89], v9 offset:45056
    ds_read_b64_tr_b16 v[90:91], v9 offset:45568
    ds_read_b64_tr_b16 v[92:93], v10 offset:45056
    ds_read_b64_tr_b16 v[94:95], v10 offset:45568
    ds_read_b64_tr_b16 v[112:113], v241 offset:22528
    ds_read_b64_tr_b16 v[114:115], v241 offset:22784
    v_mfma_f32_32x32x16_bf16 v[48:63], v[68:71], v[208:211], v[48:63]
    v_mfma_f32_32x32x16_bf16 v[96:111], v[72:75], v[208:211], v[96:111]
    s_waitcnt lgkmcnt(6)
    v_mfma_f32_32x32x16_bf16 v[32:47], v[76:79], v[212:215], v[32:47]
    ds_read_b64_tr_b16 v[116:117], v9 offset:47104
    ds_read_b64_tr_b16 v[118:119], v9 offset:47616
    ds_read_b64_tr_b16 v[120:121], v10 offset:47104
    ds_read_b64_tr_b16 v[122:123], v10 offset:47616
    ds_read_b64_tr_b16 v[124:125], v241 offset:23552
    ds_read_b64_tr_b16 v[126:127], v241 offset:23808
    v_mfma_f32_32x32x16_bf16 v[48:63], v[80:83], v[212:215], v[48:63]
    v_mfma_f32_32x32x16_bf16 v[96:111], v[84:87], v[212:215], v[96:111]
    s_waitcnt lgkmcnt(6)
    v_mfma_f32_32x32x16_bf16 v[32:47], v[88:91], v[216:219], v[32:47]
    ds_read_b64_tr_b16 v[64:65], v9 offset:49152
    ds_read_b64_tr_b16 v[66:67], v9 offset:49664
    ds_read_b64_tr_b16 v[68:69], v10 offset:49152
    ds_read_b64_tr_b16 v[70:71], v10 offset:49664
    ds_read_b64_tr_b16 v[72:73], v241 offset:24576
    ds_read_b64_tr_b16 v[74:75], v241 offset:24832
    v_mfma_f32_32x32x16_bf16 v[48:63], v[92:95], v[216:219], v[48:63]
    v_mfma_f32_32x32x16_bf16 v[96:111], v[112:115], v[216:219], v[96:111]
    s_waitcnt lgkmcnt(6)
    v_mfma_f32_32x32x16_bf16 v[32:47], v[116:119], v[220:223], v[32:47]
    ds_read_b64_tr_b16 v[76:77], v9 offset:51200
    ds_read_b64_tr_b16 v[78:79], v9 offset:51712
    ds_read_b64_tr_b16 v[80:81], v10 offset:51200
    ds_read_b64_tr_b16 v[82:83], v10 offset:51712
    ds_read_b64_tr_b16 v[84:85], v241 offset:25600
    ds_read_b64_tr_b16 v[86:87], v241 offset:25856
    v_mfma_f32_32x32x16_bf16 v[48:63], v[120:123], v[220:223], v[48:63]
    v_mfma_f32_32x32x16_bf16 v[96:111], v[124:127], v[220:223], v[96:111]
    s_waitcnt lgkmcnt(6)
    v_mfma_f32_32x32x16_bf16 v[32:47], v[64:67], v[224:227], v[32:47]
    ds_read_b64_tr_b16 v[88:89], v9 offset:53248
    ds_read_b64_tr_b16 v[90:91], v9 offset:53760
    ds_read_b64_tr_b16 v[92:93], v10 offset:53248
    ds_read_b64_tr_b16 v[94:95], v10 offset:53760
    ds_read_b64_tr_b16 v[112:113], v241 offset:26624
    ds_read_b64_tr_b16 v[114:115], v241 offset:26880
    v_mfma_f32_32x32x16_bf16 v[48:63], v[68:71], v[224:227], v[48:63]
    v_mfma_f32_32x32x16_bf16 v[96:111], v[72:75], v[224:227], v[96:111]
    s_waitcnt lgkmcnt(6)
    v_mfma_f32_32x32x16_bf16 v[32:47], v[76:79], v[228:231], v[32:47]
    ds_read_b64_tr_b16 v[116:117], v9 offset:55296
    ds_read_b64_tr_b16 v[118:119], v9 offset:55808
    ds_read_b64_tr_b16 v[120:121], v10 offset:55296
    ds_read_b64_tr_b16 v[122:123], v10 offset:55808
    ds_read_b64_tr_b16 v[124:125], v241 offset:27648
    ds_read_b64_tr_b16 v[126:127], v241 offset:27904
    v_mfma_f32_32x32x16_bf16 v[48:63], v[80:83], v[228:231], v[48:63]
    v_mfma_f32_32x32x16_bf16 v[96:111], v[84:87], v[228:231], v[96:111]
    s_waitcnt lgkmcnt(6)
    v_mfma_f32_32x32x16_bf16 v[32:47], v[88:91], v[232:235], v[32:47]
    v_mfma_f32_32x32x16_bf16 v[48:63], v[92:95], v[232:235], v[48:63]
    v_mfma_f32_32x32x16_bf16 v[96:111], v[112:115], v[232:235], v[96:111]
    s_waitcnt lgkmcnt(0)
    v_mfma_f32_32x32x16_bf16 v[32:47], v[116:119], v[236:239], v[32:47]
    v_mfma_f32_32x32x16_bf16 v[48:63], v[120:123], v[236:239], v[48:63]
    v_mfma_f32_32x32x16_bf16 v[96:111], v[124:127], v[236:239], v[96:111]
    s_setprio 1
    s_waitcnt vmcnt(0)
    v_cmp_eq_u32 vcc, v248, v255
    s_nop 3
    s_cmp_eq_u64 vcc, exec
    s_cselect_b32 s66, 1, 0
    s_and_b32 s64, s2, 1
    s_lshl_b32 s64, s64, 2
    s_and_b32 s62, s47, 3
    s_add_u32 s64, s64, s62
    s_lshl_b32 s64, s64, 7
    s_add_u32 s7, s64, 0x1500000
    s_bfe_u32 s62, s53, 0x60002
    s_lshl_b32 s62, s62, 10
    s_bfe_u32 s63, s53, 0x20000
    s_lshl_b32 s63, s63, 2
    s_add_u32 s62, s62, s63
    v_mov_b32 v2, s62
    s_bfe_u32 s62, s53, 0x6000a
    s_lshl_b32 s62, s62, 10
    s_bfe_u32 s63, s53, 0x20008
    s_lshl_b32 s63, s63, 2
    s_add_u32 s62, s62, s63
    s_mov_b32 exec_lo, 0xaaaaaaaa
    s_mov_b32 exec_hi, 0xaaaaaaaa
    v_mov_b32 v2, s62
    s_mov_b32 exec_lo, 0
    s_mov_b32 exec_hi, -1
    v_add_u32 v2, 16, v2
    s_mov_b32 exec_lo, -1
    v_pk_mul_f32 v[12:13], v[32:33], v[32:33]
    v_pk_mul_f32 v[14:15], v[34:35], v[34:35]
    v_pk_mul_f32 v[16:17], v[36:37], v[36:37]
    v_pk_mul_f32 v[18:19], v[38:39], v[38:39]
    v_pk_fma_f32 v[12:13], v[12:13], s[58:59], v[252:253]
    v_pk_fma_f32 v[14:15], v[14:15], s[58:59], v[252:253]
    v_pk_fma_f32 v[16:17], v[16:17], s[58:59], v[252:253]
    v_pk_fma_f32 v[18:19], v[18:19], s[58:59], v[252:253]
    v_pk_mul_f32 v[12:13], v[12:13], v[32:33]
    v_pk_mul_f32 v[14:15], v[14:15], v[34:35]
    v_pk_mul_f32 v[16:17], v[16:17], v[36:37]
    v_pk_mul_f32 v[18:19], v[18:19], v[38:39]
    v_exp_f32 v12, v12
    v_exp_f32 v13, v13
    v_exp_f32 v14, v14
    v_exp_f32 v15, v15
    v_exp_f32 v16, v16
    v_exp_f32 v17, v17
    v_exp_f32 v18, v18
    v_exp_f32 v19, v19
    v_pk_add_f32 v[12:13], v[12:13], 1.0 op_sel_hi:[1,0]
    v_pk_add_f32 v[14:15], v[14:15], 1.0 op_sel_hi:[1,0]
    v_pk_add_f32 v[16:17], v[16:17], 1.0 op_sel_hi:[1,0]
    v_pk_add_f32 v[18:19], v[18:19], 1.0 op_sel_hi:[1,0]
    v_rcp_f32 v12, v12
    v_rcp_f32 v13, v13
    v_rcp_f32 v14, v14
    v_rcp_f32 v15, v15
    v_rcp_f32 v16, v16
    v_rcp_f32 v17, v17
    v_rcp_f32 v18, v18
    v_rcp_f32 v19, v19
    s_barrier
    v_pk_mul_f32 v[12:13], v[12:13], v[32:33]
    v_pk_mul_f32 v[14:15], v[14:15], v[34:35]
    v_pk_mul_f32 v[16:17], v[16:17], v[36:37]
    v_pk_mul_f32 v[18:19], v[18:19], v[38:39]
    v_cvt_pk_bf16_f32 v32, v12, v13
    v_cvt_pk_bf16_f32 v33, v14, v15
    v_cvt_pk_bf16_f32 v34, v16, v17
    v_cvt_pk_bf16_f32 v35, v18, v19
    buffer_store_dwordx4 v[32:35], v244, s[12:15], s20 offen sc1
    v_pk_mul_f32 v[12:13], v[40:41], v[40:41]
    v_pk_mul_f32 v[14:15], v[42:43], v[42:43]
    v_pk_mul_f32 v[16:17], v[44:45], v[44:45]
    v_pk_mul_f32 v[18:19], v[46:47], v[46:47]
    v_pk_fma_f32 v[12:13], v[12:13], s[58:59], v[252:253]
    v_pk_fma_f32 v[14:15], v[14:15], s[58:59], v[252:253]
    v_pk_fma_f32 v[16:17], v[16:17], s[58:59], v[252:253]
    v_pk_fma_f32 v[18:19], v[18:19], s[58:59], v[252:253]
    v_pk_mul_f32 v[12:13], v[12:13], v[40:41]
    v_pk_mul_f32 v[14:15], v[14:15], v[42:43]
    v_pk_mul_f32 v[16:17], v[16:17], v[44:45]
    v_pk_mul_f32 v[18:19], v[18:19], v[46:47]
    v_exp_f32 v12, v12
    v_exp_f32 v13, v13
    v_exp_f32 v14, v14
    v_exp_f32 v15, v15
    v_exp_f32 v16, v16
    v_exp_f32 v17, v17
    v_exp_f32 v18, v18
    v_exp_f32 v19, v19
    v_pk_add_f32 v[12:13], v[12:13], 1.0 op_sel_hi:[1,0]
    v_pk_add_f32 v[14:15], v[14:15], 1.0 op_sel_hi:[1,0]
    v_pk_add_f32 v[16:17], v[16:17], 1.0 op_sel_hi:[1,0]
    v_pk_add_f32 v[18:19], v[18:19], 1.0 op_sel_hi:[1,0]
    v_rcp_f32 v12, v12
    v_rcp_f32 v13, v13
    v_rcp_f32 v14, v14
    v_rcp_f32 v15, v15
    v_rcp_f32 v16, v16
    v_rcp_f32 v17, v17
    v_rcp_f32 v18, v18
    v_rcp_f32 v19, v19
    v_pk_mul_f32 v[12:13], v[12:13], v[40:41]
    v_pk_mul_f32 v[14:15], v[14:15], v[42:43]
    v_pk_mul_f32 v[16:17], v[16:17], v[44:45]
    v_pk_mul_f32 v[18:19], v[18:19], v[46:47]
    v_cvt_pk_bf16_f32 v40, v12, v13
    v_cvt_pk_bf16_f32 v41, v14, v15
    v_cvt_pk_bf16_f32 v42, v16, v17
    v_cvt_pk_bf16_f32 v43, v18, v19
    buffer_store_dwordx4 v[40:43], v244, s[12:15], s20 offen offset:1024 sc1
    v_pk_mul_f32 v[12:13], v[48:49], v[48:49]
    v_pk_mul_f32 v[14:15], v[50:51], v[50:51]
    v_pk_mul_f32 v[16:17], v[52:53], v[52:53]
    v_pk_mul_f32 v[18:19], v[54:55], v[54:55]
    v_pk_fma_f32 v[12:13], v[12:13], s[58:59], v[252:253]
    v_pk_fma_f32 v[14:15], v[14:15], s[58:59], v[252:253]
    v_pk_fma_f32 v[16:17], v[16:17], s[58:59], v[252:253]
    v_pk_fma_f32 v[18:19], v[18:19], s[58:59], v[252:253]
    v_pk_mul_f32 v[12:13], v[12:13], v[48:49]
    v_pk_mul_f32 v[14:15], v[14:15], v[50:51]
    v_pk_mul_f32 v[16:17], v[16:17], v[52:53]
    v_pk_mul_f32 v[18:19], v[18:19], v[54:55]
    v_exp_f32 v12, v12
    v_exp_f32 v13, v13
    v_exp_f32 v14, v14
    v_exp_f32 v15, v15
    v_exp_f32 v16, v16
    v_exp_f32 v17, v17
    v_exp_f32 v18, v18
    v_exp_f32 v19, v19
    v_pk_add_f32 v[12:13], v[12:13], 1.0 op_sel_hi:[1,0]
    v_pk_add_f32 v[14:15], v[14:15], 1.0 op_sel_hi:[1,0]
    v_pk_add_f32 v[16:17], v[16:17], 1.0 op_sel_hi:[1,0]
    v_pk_add_f32 v[18:19], v[18:19], 1.0 op_sel_hi:[1,0]
    v_rcp_f32 v12, v12
    v_rcp_f32 v13, v13
    v_rcp_f32 v14, v14
    v_rcp_f32 v15, v15
    v_rcp_f32 v16, v16
    v_rcp_f32 v17, v17
    v_rcp_f32 v18, v18
    v_rcp_f32 v19, v19
    v_pk_mul_f32 v[12:13], v[12:13], v[48:49]
    v_pk_mul_f32 v[14:15], v[14:15], v[50:51]
    v_pk_mul_f32 v[16:17], v[16:17], v[52:53]
    v_pk_mul_f32 v[18:19], v[18:19], v[54:55]
    v_cvt_pk_bf16_f32 v48, v12, v13
    v_cvt_pk_bf16_f32 v49, v14, v15
    v_cvt_pk_bf16_f32 v50, v16, v17
    v_cvt_pk_bf16_f32 v51, v18, v19
    buffer_store_dwordx4 v[48:51], v244, s[12:15], s21 offen sc1
    v_pk_mul_f32 v[12:13], v[56:57], v[56:57]
    v_pk_mul_f32 v[14:15], v[58:59], v[58:59]
    v_pk_mul_f32 v[16:17], v[60:61], v[60:61]
    v_pk_mul_f32 v[18:19], v[62:63], v[62:63]
    v_pk_fma_f32 v[12:13], v[12:13], s[58:59], v[252:253]
    v_pk_fma_f32 v[14:15], v[14:15], s[58:59], v[252:253]
    v_pk_fma_f32 v[16:17], v[16:17], s[58:59], v[252:253]
    v_pk_fma_f32 v[18:19], v[18:19], s[58:59], v[252:253]
    v_pk_mul_f32 v[12:13], v[12:13], v[56:57]
    v_pk_mul_f32 v[14:15], v[14:15], v[58:59]
    v_pk_mul_f32 v[16:17], v[16:17], v[60:61]
    v_pk_mul_f32 v[18:19], v[18:19], v[62:63]
    v_exp_f32 v12, v12
    v_exp_f32 v13, v13
    v_exp_f32 v14, v14
    v_exp_f32 v15, v15
    v_exp_f32 v16, v16
    v_exp_f32 v17, v17
    v_exp_f32 v18, v18
    v_exp_f32 v19, v19
    v_pk_add_f32 v[12:13], v[12:13], 1.0 op_sel_hi:[1,0]
    v_pk_add_f32 v[14:15], v[14:15], 1.0 op_sel_hi:[1,0]
    v_pk_add_f32 v[16:17], v[16:17], 1.0 op_sel_hi:[1,0]
    v_pk_add_f32 v[18:19], v[18:19], 1.0 op_sel_hi:[1,0]
    v_rcp_f32 v12, v12
    v_rcp_f32 v13, v13
    v_rcp_f32 v14, v14
    v_rcp_f32 v15, v15
    v_rcp_f32 v16, v16
    v_rcp_f32 v17, v17
    v_rcp_f32 v18, v18
    v_rcp_f32 v19, v19
    v_pk_mul_f32 v[12:13], v[12:13], v[56:57]
    v_pk_mul_f32 v[14:15], v[14:15], v[58:59]
    v_pk_mul_f32 v[16:17], v[16:17], v[60:61]
    v_pk_mul_f32 v[18:19], v[18:19], v[62:63]
    v_cvt_pk_bf16_f32 v56, v12, v13
    v_cvt_pk_bf16_f32 v57, v14, v15
    v_cvt_pk_bf16_f32 v58, v16, v17
    v_cvt_pk_bf16_f32 v59, v18, v19
    buffer_store_dwordx4 v[56:59], v244, s[12:15], s21 offen offset:1024 sc1
    v_pk_mul_f32 v[12:13], v[96:97], v[96:97]
    v_pk_mul_f32 v[14:15], v[98:99], v[98:99]
    v_pk_mul_f32 v[16:17], v[100:101], v[100:101]
    v_pk_mul_f32 v[18:19], v[102:103], v[102:103]
    v_pk_fma_f32 v[12:13], v[12:13], s[58:59], v[252:253]
    v_pk_fma_f32 v[14:15], v[14:15], s[58:59], v[252:253]
    v_pk_fma_f32 v[16:17], v[16:17], s[58:59], v[252:253]
    v_pk_fma_f32 v[18:19], v[18:19], s[58:59], v[252:253]
    v_pk_mul_f32 v[12:13], v[12:13], v[96:97]
    v_pk_mul_f32 v[14:15], v[14:15], v[98:99]
    v_pk_mul_f32 v[16:17], v[16:17], v[100:101]
    v_pk_mul_f32 v[18:19], v[18:19], v[102:103]
    v_exp_f32 v12, v12
    v_exp_f32 v13, v13
    v_exp_f32 v14, v14
    v_exp_f32 v15, v15
    v_exp_f32 v16, v16
    v_exp_f32 v17, v17
    v_exp_f32 v18, v18
    v_exp_f32 v19, v19
    v_pk_add_f32 v[12:13], v[12:13], 1.0 op_sel_hi:[1,0]
    v_pk_add_f32 v[14:15], v[14:15], 1.0 op_sel_hi:[1,0]
    v_pk_add_f32 v[16:17], v[16:17], 1.0 op_sel_hi:[1,0]
    v_pk_add_f32 v[18:19], v[18:19], 1.0 op_sel_hi:[1,0]
    v_rcp_f32 v12, v12
    v_rcp_f32 v13, v13
    v_rcp_f32 v14, v14
    v_rcp_f32 v15, v15
    v_rcp_f32 v16, v16
    v_rcp_f32 v17, v17
    v_rcp_f32 v18, v18
    v_rcp_f32 v19, v19
    v_pk_mul_f32 v[12:13], v[12:13], v[96:97]
    v_pk_mul_f32 v[14:15], v[14:15], v[98:99]
    v_pk_mul_f32 v[16:17], v[16:17], v[100:101]
    v_pk_mul_f32 v[18:19], v[18:19], v[102:103]
    v_cvt_pk_bf16_f32 v96, v12, v13
    v_cvt_pk_bf16_f32 v97, v14, v15
    v_cvt_pk_bf16_f32 v98, v16, v17
    v_cvt_pk_bf16_f32 v99, v18, v19
    buffer_store_dwordx4 v[96:99], v244, s[12:15], s22 offen sc1
    v_pk_mul_f32 v[12:13], v[104:105], v[104:105]
    v_pk_mul_f32 v[14:15], v[106:107], v[106:107]
    v_pk_mul_f32 v[16:17], v[108:109], v[108:109]
    v_pk_mul_f32 v[18:19], v[110:111], v[110:111]
    v_pk_fma_f32 v[12:13], v[12:13], s[58:59], v[252:253]
    v_pk_fma_f32 v[14:15], v[14:15], s[58:59], v[252:253]
    v_pk_fma_f32 v[16:17], v[16:17], s[58:59], v[252:253]
    v_pk_fma_f32 v[18:19], v[18:19], s[58:59], v[252:253]
    v_pk_mul_f32 v[12:13], v[12:13], v[104:105]
    v_pk_mul_f32 v[14:15], v[14:15], v[106:107]
    v_pk_mul_f32 v[16:17], v[16:17], v[108:109]
    v_pk_mul_f32 v[18:19], v[18:19], v[110:111]
    v_exp_f32 v12, v12
    v_exp_f32 v13, v13
    v_exp_f32 v14, v14
    v_exp_f32 v15, v15
    v_exp_f32 v16, v16
    v_exp_f32 v17, v17
    v_exp_f32 v18, v18
    v_exp_f32 v19, v19
    v_pk_add_f32 v[12:13], v[12:13], 1.0 op_sel_hi:[1,0]
    v_pk_add_f32 v[14:15], v[14:15], 1.0 op_sel_hi:[1,0]
    v_pk_add_f32 v[16:17], v[16:17], 1.0 op_sel_hi:[1,0]
    v_pk_add_f32 v[18:19], v[18:19], 1.0 op_sel_hi:[1,0]
    v_rcp_f32 v12, v12
    v_rcp_f32 v13, v13
    v_rcp_f32 v14, v14
    v_rcp_f32 v15, v15
    v_rcp_f32 v16, v16
    v_rcp_f32 v17, v17
    v_rcp_f32 v18, v18
    v_rcp_f32 v19, v19
    v_pk_mul_f32 v[12:13], v[12:13], v[104:105]
    v_pk_mul_f32 v[14:15], v[14:15], v[106:107]
    v_pk_mul_f32 v[16:17], v[16:17], v[108:109]
    v_pk_mul_f32 v[18:19], v[18:19], v[110:111]
    v_cvt_pk_bf16_f32 v104, v12, v13
    v_cvt_pk_bf16_f32 v105, v14, v15
    v_cvt_pk_bf16_f32 v106, v16, v17
    v_cvt_pk_bf16_f32 v107, v18, v19
    buffer_store_dwordx4 v[104:107], v244, s[12:15], s22 offen offset:1024 sc1
    s_setprio 0
    s_waitcnt vmcnt(0)
    s_mov_b64 exec, 1
    s_cmp_eq_u32 s66, 1
    s_cbranch_scc1 hs_14
    buffer_store_dword v11, off, s[12:15], s57 sc1
    s_branch hs_15
hs_14:
    buffer_store_dword v11, off, s[12:15], s57
hs_15:
    s_mov_b64 exec, -1
    buffer_load_dword v10, v2, s[12:15], s7 offen sc1
    s_branch phase2
role_attn:
    s_load_dwordx2 s[8:9], s[0:1], 8
    s_load_dwordx2 s[16:17], s[0:1], 16
    s_load_dwordx2 s[20:21], s[0:1], 72
    s_load_dwordx2 s[12:13], s[0:1], 96
    s_load_dwordx2 s[40:41], s[0:1], 88
    s_load_dwordx2 s[24:25], s[0:1], 56
    s_load_dwordx2 s[28:29], s[0:1], 24
    s_load_dwordx2 s[32:33], s[0:1], 64
    s_load_dwordx2 s[36:37], s[0:1], 80
    v_and_b32 v1, 63, v0
    v_lshrrev_b32 v12, 6, v0
    s_nop 0
    v_readfirstlane_b32 s47, v12
    s_and_b32 s62, s2, 7
    s_bfe_u32 s65, s2, 0x20003
    s_and_b32 s64, s62, 6
    s_lshl_b32 s64, s64, 1
    s_add_u32 s44, s64, s65
    s_bfe_u32 s65, s2, 0x20005
    s_and_b32 s64, s62, 1
    s_lshl_b32 s64, s64, 2
    s_add_u32 s45, s64, s65
    s_and_b32 s64, s44, 3
    s_lshl_b32 s64, s64, 1
    s_add_u32 s48, s62, s64
    s_cmp_ge_u32 s48, 7
    s_cselect_b32 s64, 7, 0
    s_sub_u32 s48, s48, s64
    s_mul_i32 s51, s44, 114688
    s_lshl_b32 s55, s47, 10
    s_mov_b32 s6, 0x1c0000
    s_mov_b32 s7, 0x20000
    s_mov_b32 s10, 0x126000
    s_mov_b32 s11, 0x20000
    s_mov_b32 s18, 0x6200
    s_mov_b32 s19, 0x20000
    s_mov_b32 s22, 0x380
    s_mov_b32 s23, 0x20000
    v_lshrrev_b32 v12, 3, v1
    s_lshl_b32 s62, s47, 4
    v_add_u32 v13, s62, v12
    v_mul_u32_u24 v13, 896, v13
    v_and_b32 v14, 7, v1
    v_lshrrev_b32 v15, 4, v1
    v_xor_b32 v15, v14, v15
    v_lshl_add_u32 v2, v15, 4, v13
    v_xor_b32 v3, 64, v2
    v_add_u32 v3, 7168, v3
    s_lshl_b32 s62, s47, 3
    v_add_u32 v13, s62, v12
    v_mul_u32_u24 v13, 2688, v13
    v_lshrrev_b32 v15, 2, v1
    v_and_b32 v15, 4, v15
    v_xor_b32 v15, v14, v15
    v_lshl_add_u32 v4, v15, 4, v13
    v_mul_u32_u24 v243, 896, v12
    v_lshl_add_u32 v243, v15, 4, v243
    v_cmp_eq_u32 vcc, 7, v15
    v_mov_b32 v14, 0x7ffffff0
    s_nop 0
    v_cndmask_b32 v4, v4, v14, vcc
    s_mul_i32 s56, s45, 112
    s_add_u32 s52, s56, 896
    s_mov_b32 s58, 0xf7f77f7f
    s_mov_b32 s59, 0xf7f77f7f
    s_add_u32 s62, s47, s48
    s_cmp_ge_u32 s62, 7
    s_cselect_b32 s63, 7, 0
    s_sub_u32 s62, s62, s63
    s_lshl_b32 s62, s62, 7
    v_lshlrev_b32 v12, 1, v1
    s_waitcnt lgkmcnt(0)
    s_lshl_b32 s3, s55, 1
    s_add_u32 m0, s3, 0x0
    s_lshl_b32 s49, s48, 7
    s_add_u32 s49, s49, s51
    buffer_load_dwordx4 v2, s[4:7], s49 offen lds
    s_add_u32 m0, s55, 0x4000
    s_mul_i32 s50, s48, 172032
    s_add_u32 s50, s50, s52
    buffer_load_dwordx4 v4, s[8:11], s50 offen lds
    s_lshl_b32 s3, s55, 1
    s_add_u32 m0, s3, 0x400
    s_nop 0
    buffer_load_dwordx4 v3, s[4:7], s49 offen lds
    s_add_u32 s48, s48, 1
    s_cmp_eq_u32 s48, 7
    s_cselect_b32 s48, 0, s48
    buffer_load_ushort v28, v12, s[20:23], s62 offen
    v_lshlrev_b32 v12, 4, v1
    s_and_b32 s62, s55, 3072
    s_add_u32 m0, s62, 0x19000
    s_mul_i32 s63, s45, 3136
    s_add_u32 s63, s63, s62
    buffer_load_dwordx4 v12, s[16:19], s63 offen lds
    s_mov_b32 s14, 0x10000000
    s_mov_b32 s15, 0x20000
    s_mov_b32 s42, 0x100
    s_mov_b32 s43, 0x20000
    s_mov_b32 s26, 0x188000
    s_mov_b32 s27, 0x20000
    s_mov_b32 s30, 0x62000
    s_mov_b32 s31, 0x20000
    s_mov_b32 s34, 0x380
    s_mov_b32 s35, 0x20000
    s_mov_b32 s38, 0x1c0000
    s_mov_b32 s39, 0x20000
    s_or_b32 s62, s2, s47
    s_cmp_lg_u32 s62, 0
    s_cbranch_scc1 no_epoch
    s_memrealtime s[64:65]
    s_waitcnt lgkmcnt(0)
    s_or_b32 s64, s64, 1
    v_mov_b32 v12, s64
    s_mov_b64 exec, 1
    buffer_store_dword v12, off, s[40:43], 0 sc1
    s_mov_b64 exec, -1
no_epoch:
    s_lshr_b32 s57, s47, 2
    s_and_b32 s62, s47, 3
    s_lshl_b32 s62, s62, 5
    v_and_b32 v12, 31, v1
    v_add_u32 v12, s62, v12
    v_bfe_u32 v13, v12, 1, 3
    v_lshrrev_b32 v14, 5, v1
    v_xor_b32 v13, v13, v14
    v_lshlrev_b32 v13, 4, v13
    v_lshl_add_u32 v5, v12, 7, v13
    v_add_u32 v5, 0, v5
    v_xor_b32 v6, 32, v5
    v_xor_b32 v7, 64, v5
    v_xor_b32 v8, 96, v5
    v_bfe_u32 v12, v1, 2, 2
    v_lshrrev_b32 v13, 5, v1
    v_lshl_add_u32 v12, v13, 3, v12
    v_and_b32 v13, 3, v1
    v_lshlrev_b32 v13, 3, v13
    v_and_b32 v14, 16, v1
    v_lshl_add_u32 v13, v14, 1, v13
    v_and_b32 v14, 8, v1
    v_lshlrev_b32 v14, 3, v14
    v_cmp_eq_u32 vcc, 56, v13
    v_mov_b32 v16, 112
    s_cmp_lt_u32 s47, 4
    s_cselect_b32 s62, 0, 106496
    v_xor_b32 v15, v13, v14
    v_lshl_add_u32 v242, v12, 7, v15
    v_add_u32 v242, s62, v242
    v_add_u32 v13, 56, v13
    v_cndmask_b32 v16, v13, v16, vcc
    v_xor_b32 v16, v16, v14
    v_lshl_add_u32 v248, v12, 7, v16
    v_add_u32 v248, s62, v248
    s_bfe_u32 s65, s2, 0x20003
    s_bfe_u32 s54, s2, 0x20005
    s_and_b32 s62, s2, 6
    s_lshl_b32 s62, s62, 3
    s_lshr_b32 s63, s47, 2
    s_xor_b32 s63, s63, s2
    s_andn2_b32 s63, 1, s63
    s_mul_i32 s64, s65, 3
    s_add_u32 s62, s62, s64
    s_mul_i32 s62, s62, 65793
    s_add_u32 s53, s62, s63
    s_and_b32 s63, s2, 1
    s_lshl_b32 s64, s63, 16
    s_add_u32 s64, s64, 512
    s_lshl_b32 s63, s63, 8
    s_add_u32 s63, s63, 131072
    s_cmp_lt_u32 s47, 4
    s_cselect_b32 s63, s64, s63
    s_add_u32 s53, s53, s63
    s_lshl_b32 s64, s65, 1
    s_add_u32 s64, s54, s64
    s_and_b32 s62, s64, 3
    s_lshl_b32 s62, s62, 2
    s_and_b32 s65, s47, 1
    s_lshr_b32 s63, 0x2103210, s62
    s_and_b32 s63, s63, 65535
    s_mul_i32 s62, s64, 86
    s_lshr_b32 s62, s62, 8
    s_mul_i32 s62, s62, 3
    s_sub_u32 s62, s64, s62
    s_lshl_b32 s62, s62, 2
    s_mov_b32 s64, 0x54654
    s_cmp_eq_u32 s65, 1
    s_cselect_b32 s64, 0x65065, s64
    s_lshr_b32 s64, s64, s62
    s_and_b32 s64, s64, 4095
    s_lshl_b32 s64, s64, 16
    s_mul_i32 s65, s65, 4369
    s_add_u32 s63, s63, s65
    s_or_b32 s46, s63, s64
    v_lshlrev_b32 v244, 4, v1
    s_and_b32 s63, s2, 1
    s_lshl_b32 s63, s63, 2
    s_and_b32 s62, s47, 3
    s_add_u32 s63, s63, s62
    s_mul_i32 s0, s63, 200704
    s_lshl_b32 s62, s54, 7
    s_add_u32 s0, s0, s62
    s_lshr_b32 s62, s47, 2
    s_mul_i32 s62, s62, 14336
    s_add_u32 s0, s0, s62
    v_bfe_u32 v249, v1, 2, 2
    v_lshrrev_b32 v250, 5, v1
    v_lshl_add_u32 v249, v250, 2, v249
    v_and_b32 v250, 3, v1
    v_lshlrev_b32 v250, 3, v250
    v_and_b32 v251, 16, v1
    v_lshl_add_u32 v250, v251, 1, v250
    v_and_b32 v251, 8, v1
    v_lshlrev_b32 v251, 3, v251
    v_xor_b32 v250, v250, v251
    v_lshl_add_u32 v249, v249, 7, v250
    s_and_b32 s62, s47, 3
    s_lshl_b32 s62, s62, 12
    v_add_u32 v245, s62, v249
    s_and_b32 s63, s47, 4
    s_lshl_b32 s63, s63, 9
    s_add_u32 s61, s62, s63
    v_add_u32 v251, 6144, v243
    s_lshl_b32 s3, s55, 1
    s_add_u32 m0, s3, 0x6000
    s_lshl_b32 s49, s48, 7
    s_add_u32 s49, s49, s51
    buffer_load_dwordx4 v2, s[4:7], s49 offen lds
    s_add_u32 m0, s55, 0xa000
    s_mul_i32 s50, s48, 172032
    s_add_u32 s50, s50, s52
    buffer_load_dwordx4 v4, s[8:11], s50 offen lds
    s_lshl_b32 s3, s55, 1
    s_add_u32 m0, s3, 0x6400
    s_nop 0
    buffer_load_dwordx4 v3, s[4:7], s49 offen lds
    s_add_u32 s48, s48, 1
    s_cmp_eq_u32 s48, 7
    s_cselect_b32 s48, 0, s48
    s_getpc_b64 s[64:65]
pc_16:
    s_sub_u32 s64, s64, pc_16-gated_mix__linear_kernel_hedgehog__dense_activation_gelu__prompt_kernel
    s_subb_u32 s65, s65, 0
    s_and_b32 s62, s2, -8
    s_add_u32 s62, s62, s47
    s_lshl_b32 s62, s62, 7
    v_lshlrev_b32 v250, 15, v1
    v_add_u32 v250, s62, v250
    s_mov_b32 s62, code_end-gated_mix__linear_kernel_hedgehog__dense_activation_gelu__prompt_kernel-4
    v_min_u32 v250, s62, v250
    s_mov_b64 exec, 3
    global_load_dword v249, v250, s[64:65]
    s_mov_b64 exec, -1
    s_cmp_ge_u32 s47, 4
    s_cbranch_scc1 attn_ld
    s_waitcnt vmcnt(5)
    s_barrier
    ds_read_b128 v[128:131], v5
    ds_read_b64_tr_b16 v[64:65], v242 offset:16384
    ds_read_b64_tr_b16 v[66:67], v242 offset:16896
    ds_read_b64_tr_b16 v[68:69], v248 offset:16384
    ds_read_b64_tr_b16 v[70:71], v248 offset:16896
    ds_read_b128 v[132:135], v6
    ds_read_b64_tr_b16 v[72:73], v242 offset:18432
    ds_read_b64_tr_b16 v[74:75], v242 offset:18944
    ds_read_b64_tr_b16 v[76:77], v248 offset:18432
    ds_read_b64_tr_b16 v[78:79], v248 offset:18944
    s_waitcnt lgkmcnt(5)
    v_mfma_f32_32x32x16_bf16 v[32:47], v[64:67], v[128:131], 0
    ds_read_b128 v[136:139], v7
    ds_read_b64_tr_b16 v[80:81], v242 offset:20480
    ds_read_b64_tr_b16 v[82:83], v242 offset:20992
    v_mfma_f32_32x32x16_bf16 v[48:63], v[68:71], v[128:131], 0
    ds_read_b64_tr_b16 v[84:85], v248 offset:20480
    ds_read_b64_tr_b16 v[86:87], v248 offset:20992
    s_waitcnt lgkmcnt(5)
    v_mfma_f32_32x32x16_bf16 v[32:47], v[72:75], v[132:135], v[32:47]
    ds_read_b128 v[140:143], v8
    ds_read_b64_tr_b16 v[64:65], v242 offset:22528
    ds_read_b64_tr_b16 v[66:67], v242 offset:23040
    v_mfma_f32_32x32x16_bf16 v[48:63], v[76:79], v[132:135], v[48:63]
    ds_read_b64_tr_b16 v[68:69], v248 offset:22528
    ds_read_b64_tr_b16 v[70:71], v248 offset:23040
    s_waitcnt vmcnt(1) lgkmcnt(0)
    s_barrier
    v_mfma_f32_32x32x16_bf16 v[32:47], v[80:83], v[136:139], v[32:47]
    v_add_u32 v5, 0x6000, v5
    v_add_u32 v6, 0x6000, v6
    v_add_u32 v7, 0x6000, v7
    v_add_u32 v8, 0x6000, v8
    v_add_u32 v242, 0x6000, v242
    v_add_u32 v248, 0x6000, v248
    ds_read_b128 v[144:147], v5
    ds_read_b64_tr_b16 v[72:73], v242 offset:16384
    ds_read_b64_tr_b16 v[74:75], v242 offset:16896
    buffer_load_dword v11, off, s[40:43], 0 sc1
    v_mov_b32 v29, 0
    v_and_b32 v12, 2, v0
    v_lshlrev_b32 v12, 5, v12
    v_xor_b32 v12, 112, v12
    v_lshl_add_u32 v12, v0, 7, v12
    v_add_u32 v12, 106496, v12
    s_cmp_eq_u32 s47, 7
    s_cbranch_scc1 gw_17
    ds_write_b64 v12, v[28:29]
gw_17:
    v_mfma_f32_32x32x16_bf16 v[48:63], v[84:87], v[136:139], v[48:63]
    ds_read_b64_tr_b16 v[76:77], v248 offset:16384
    ds_read_b64_tr_b16 v[78:79], v248 offset:16896
    v_lshlrev_b32 v250, 7, v1
    s_lshl_b32 s62, s2, 2
    s_add_u32 s62, s62, s47
    s_mul_i32 s62, s62, 2688
    s_mov_b64 exec, 2080895
    buffer_load_dword v249, v250, s[8:11], s62 offen
    s_mov_b64 exec, -1
    s_waitcnt lgkmcnt(5)
    v_mfma_f32_32x32x16_bf16 v[32:47], v[64:67], v[140:143], v[32:47]
    ds_read_b128 v[148:151], v6
    ds_read_b64_tr_b16 v[80:81], v242 offset:18432
    ds_read_b64_tr_b16 v[82:83], v242 offset:18944
    v_bfe_u32 v12, v1, 2, 2
    v_lshrrev_b32 v13, 5, v1
    v_lshl_add_u32 v12, v13, 2, v12
    v_and_b32 v13, 3, v1
    v_lshlrev_b32 v13, 3, v13
    v_and_b32 v14, 16, v1
    v_lshl_add_u32 v13, v14, 1, v13
    v_and_b32 v14, 8, v1
    v_lshlrev_b32 v14, 3, v14
    v_mfma_f32_32x32x16_bf16 v[48:63], v[68:71], v[140:143], v[48:63]
    ds_read_b64_tr_b16 v[84:85], v248 offset:18432
    ds_read_b64_tr_b16 v[86:87], v248 offset:18944
    s_waitcnt lgkmcnt(5)
    v_mfma_f32_32x32x16_bf16 v[32:47], v[72:75], v[144:147], v[32:47]
    ds_read_b128 v[152:155], v7
    ds_read_b64_tr_b16 v[64:65], v242 offset:20480
    ds_read_b64_tr_b16 v[66:67], v242 offset:20992
    v_mul_u32_u24 v12, 56, v12
    v_add_u32 v13, v12, v13
    v_add_u32 v12, 103968, v13
    v_add_u32 v13, 102400, v13
    ds_read_b64_tr_b16 v[20:21], v12 offset:0
    ds_read_b64_tr_b16 v[112:113], v13 offset:0
    ds_read_b64_tr_b16 v[22:23], v12 offset:448
    ds_read_b64_tr_b16 v[114:115], v13 offset:448
    ds_read_b64_tr_b16 v[24:25], v12 offset:896
    ds_read_b64_tr_b16 v[116:117], v13 offset:896
    ds_read_b64_tr_b16 v[26:27], v12 offset:1344
    ds_read_b64_tr_b16 v[118:119], v13 offset:1344
    v_mfma_f32_32x32x16_bf16 v[48:63], v[76:79], v[144:147], v[48:63]
    ds_read_b64_tr_b16 v[68:69], v248 offset:20480
    ds_read_b64_tr_b16 v[70:71], v248 offset:20992
    s_waitcnt lgkmcnt(13)
    v_mfma_f32_32x32x16_bf16 v[32:47], v[80:83], v[148:151], v[32:47]
    ds_read_b128 v[156:159], v8
    ds_read_b64_tr_b16 v[72:73], v242 offset:22528
    ds_read_b64_tr_b16 v[74:75], v242 offset:23040
    v_mfma_f32_32x32x16_bf16 v[48:63], v[84:87], v[148:151], v[48:63]
    ds_read_b64_tr_b16 v[76:77], v248 offset:22528
    ds_read_b64_tr_b16 v[78:79], v248 offset:23040
    s_waitcnt lgkmcnt(0)
    s_barrier
    v_mfma_f32_32x32x16_bf16 v[32:47], v[64:67], v[152:155], v[32:47]
    v_add_u32 v5, 0x6000, v5
    v_add_u32 v6, 0x6000, v6
    v_add_u32 v7, 0x6000, v7
    v_add_u32 v8, 0x6000, v8
    v_add_u32 v242, 0x6000, v242
    v_add_u32 v248, 0x6000, v248
    ds_read_b128 v[160:163], v5
    ds_read_b64_tr_b16 v[80:81], v242 offset:16384
    ds_read_b64_tr_b16 v[82:83], v242 offset:16896
    s_mov_b32 exec_lo, 0xf0000000
    s_mov_b32 exec_hi, 0xf0000000
    v_mov_b32 v20, 0
    v_mov_b32 v112, 0
    v_mov_b32 v21, 0
    v_mov_b32 v113, 0
    v_mov_b32 v22, 0
    v_mov_b32 v114, 0
    v_mov_b32 v23, 0
    v_mov_b32 v115, 0
    v_mov_b32 v24, 0
    v_mov_b32 v116, 0
    v_mov_b32 v25, 0
    v_mov_b32 v117, 0
    s_mov_b32 exec_hi, -1
    v_mov_b32 v26, 0
    v_mov_b32 v118, 0
    v_mov_b32 v27, 0
    v_mov_b32 v119, 0
    s_mov_b32 exec_lo, -1
    v_mfma_f32_32x32x16_bf16 v[48:63], v[68:71], v[152:155], v[48:63]
    ds_read_b64_tr_b16 v[84:85], v248 offset:16384
    ds_read_b64_tr_b16 v[86:87], v248 offset:16896
    s_waitcnt lgkmcnt(5)
    v_mfma_f32_32x32x16_bf16 v[32:47], v[72:75], v[156:159], v[32:47]
    ds_read_b128 v[164:167], v6
    ds_read_b64_tr_b16 v[64:65], v242 offset:18432
    ds_read_b64_tr_b16 v[66:67], v242 offset:18944
    s_mul_i32 s62, s57, 25600
    s_add_u32 s62, s62, 0
    s_and_b32 s64, s47, 3
    s_mul_i32 s64, s64, 6400
    s_add_u32 s64, s64, 0
    v_and_b32 v12, 31, v1
    v_mul_u32_u24 v12, 200, v12
    v_lshrrev_b32 v13, 5, v1
    v_lshl_add_u32 v12, v13, 3, v12
    v_add_u32 v252, s64, v12
    v_bfe_u32 v12, v1, 2, 3
    v_lshlrev_b32 v12, 1, v12
    v_add_u32 v12, v12, v13
    v_mul_u32_u24 v12, 400, v12
    v_and_b32 v13, 3, v1
    v_lshl_add_u32 v12, v13, 3, v12
    v_add_u32 v253, s62, v12
    s_and_b32 s63, s47, 3
    s_lshl_b32 s63, s63, 5
    v_add_u32 v254, s63, v253
    v_mfma_f32_32x32x16_bf16 v[48:63], v[76:79], v[156:159], v[48:63]
    ds_read_b64_tr_b16 v[68:69], v248 offset:18432
    ds_read_b64_tr_b16 v[70:71], v248 offset:18944
    s_waitcnt lgkmcnt(5)
    v_mfma_f32_32x32x16_bf16 v[32:47], v[80:83], v[160:163], v[32:47]
    ds_read_b128 v[168:171], v7
    ds_read_b64_tr_b16 v[72:73], v242 offset:20480
    ds_read_b64_tr_b16 v[74:75], v242 offset:20992
    v_lshrrev_b32 v12, 5, v1
    v_lshlrev_b32 v12, 14, v12
    v_and_b32 v13, 16, v1
    v_lshl_add_u32 v12, v13, 5, v12
    v_and_b32 v13, 15, v1
    v_lshl_add_u32 v255, v13, 4, v12
    s_lshl_b32 s62, s45, 4
    s_lshl_b32 s63, s47, 1
    s_add_u32 s63, s63, s62
    s_lshl_b32 s63, s63, 4
    s_add_u32 s63, s63, s44
    s_lshl_b32 s63, s63, 10
    s_add_u32 s60, s63, 0xc00000
    v_lshrrev_b32 v12, 4, v1
    v_lshlrev_b32 v12, 10, v12
    v_lshl_add_u32 v241, v13, 4, v12
    s_add_u32 s62, s62, s44
    s_lshl_b32 s62, s62, 14
    s_lshl_b32 s63, s47, 8
    s_add_u32 s62, s62, s63
    s_add_u32 s22, s62, 0xc00000
    s_lshl_b32 s62, s45, 2
    s_and_b32 s63, s47, 3
    s_add_u32 s62, s62, s63
    s_lshl_b32 s62, s62, 12
    s_add_u32 s23, s62, 0xf00000
    s_mov_b32 s20, 0x0c0c0400
    s_mov_b32 s21, 0x04000c0c
    v_mfma_f32_32x32x16_bf16 v[48:63], v[84:87], v[160:163], v[48:63]
    ds_read_b64_tr_b16 v[76:77], v248 offset:20480
    ds_read_b64_tr_b16 v[78:79], v248 offset:20992
    s_waitcnt lgkmcnt(5)
    v_mfma_f32_32x32x16_bf16 v[32:47], v[64:67], v[164:167], v[32:47]
    ds_read_b128 v[172:175], v8
    ds_read_b64_tr_b16 v[80:81], v242 offset:22528
    ds_read_b64_tr_b16 v[82:83], v242 offset:23040
    v_mfma_f32_32x32x16_bf16 v[48:63], v[68:71], v[164:167], v[48:63]
    ds_read_b64_tr_b16 v[84:85], v248 offset:22528
    ds_read_b64_tr_b16 v[86:87], v248 offset:23040
    s_waitcnt lgkmcnt(0)
    s_barrier
    v_mfma_f32_32x32x16_bf16 v[32:47], v[72:75], v[168:171], v[32:47]
    v_add_u32 v5, 0xffff4000, v5
    v_add_u32 v6, 0xffff4000, v6
    v_add_u32 v7, 0xffff4000, v7
    v_add_u32 v8, 0xffff4000, v8
    v_add_u32 v242, 0xffff4000, v242
    v_add_u32 v248, 0xffff4000, v248
    ds_read_b128 v[176:179], v5
    ds_read_b64_tr_b16 v[64:65], v242 offset:16384
    ds_read_b64_tr_b16 v[66:67], v242 offset:16896
    v_mfma_f32_32x32x16_bf16 v[48:63], v[76:79], v[168:171], v[48:63]
    ds_read_b64_tr_b16 v[68:69], v248 offset:16384
    ds_read_b64_tr_b16 v[70:71], v248 offset:16896
    s_waitcnt lgkmcnt(5)
    v_mfma_f32_32x32x16_bf16 v[32:47], v[80:83], v[172:175], v[32:47]
    ds_read_b128 v[180:183], v6
    ds_read_b64_tr_b16 v[72:73], v242 offset:18432
    ds_read_b64_tr_b16 v[74:75], v242 offset:18944
    v_mfma_f32_32x32x16_bf16 v[48:63], v[84:87], v[172:175], v[48:63]
    ds_read_b64_tr_b16 v[76:77], v248 offset:18432
    ds_read_b64_tr_b16 v[78:79], v248 offset:18944
    s_waitcnt lgkmcnt(5)
    v_mfma_f32_32x32x16_bf16 v[32:47], v[64:67], v[176:179], v[32:47]
    ds_read_b128 v[184:187], v7
    ds_read_b64_tr_b16 v[80:81], v242 offset:20480
    ds_read_b64_tr_b16 v[82:83], v242 offset:20992
    v_mfma_f32_32x32x16_bf16 v[48:63], v[68:71], v[176:179], v[48:63]
    ds_read_b64_tr_b16 v[84:85], v248 offset:20480
    ds_read_b64_tr_b16 v[86:87], v248 offset:20992
    s_waitcnt lgkmcnt(5)
    v_mfma_f32_32x32x16_bf16 v[32:47], v[72:75], v[180:183], v[32:47]
    ds_read_b128 v[188:191], v8
    ds_read_b64_tr_b16 v[64:65], v242 offset:22528
    ds_read_b64_tr_b16 v[66:67], v242 offset:23040
    v_mfma_f32_32x32x16_bf16 v[48:63], v[76:79], v[180:183], v[48:63]
    ds_read_b64_tr_b16 v[68:69], v248 offset:22528
    ds_read_b64_tr_b16 v[70:71], v248 offset:23040
    s_waitcnt lgkmcnt(0)
    s_barrier
    v_mfma_f32_32x32x16_bf16 v[32:47], v[80:83], v[184:187], v[32:47]
    v_add_u32 v5, 0x6000, v5
    v_add_u32 v6, 0x6000, v6
    v_add_u32 v7, 0x6000, v7
    v_add_u32 v8, 0x6000, v8
    v_add_u32 v242, 0x6000, v242
    v_add_u32 v248, 0x6000, v248
    ds_read_b128 v[192:195], v5
    ds_read_b64_tr_b16 v[72:73], v242 offset:16384
    ds_read_b64_tr_b16 v[74:75], v242 offset:16896
    s_waitcnt vmcnt(1)
    v_cmp_ne_u32 vcc, 0, v11
    s_nop 3
    s_cmp_eq_u64 vcc, exec
    s_cbranch_scc1 pd_18
    s_mov_b32 s3, 200000
pl_19:
    s_sleep 1
    buffer_load_dword v11, off, s[40:43], 0 sc1
    s_waitcnt vmcnt(0)
    v_cmp_ne_u32 vcc, 0, v11
    s_nop 3
    s_cmp_eq_u64 vcc, exec
    s_cbranch_scc1 pd_18
    s_sub_u32 s3, s3, 1
    s_cbranch_scc0 pl_19
pd_18:
    s_getreg_b32 s62, hwreg(HW_REG_XCC_ID, 0, 4)
    s_lshl_b32 s62, s62, 1
    s_add_u32 s62, s62, 2
    v_add_u32 v10, s62, v11
    s_and_b32 s66, s2, 7
    s_lshl_b32 s66, s66, 7
    s_add_u32 s66, s66, 0x1520000
    s_cmp_lg_u32 s47, 0
    s_cbranch_scc1 xp_20
    s_lshr_b32 s63, s2, 3
    s_lshl_b32 s63, s63, 2
    s_add_u32 s63, s63, s66
    s_mov_b64 exec, 1
    buffer_store_dword v10, off, s[12:15], s63
    s_mov_b64 exec, -1
xp_20:
    v_mfma_f32_32x32x16_bf16 v[48:63], v[84:87], v[184:187], v[48:63]
    ds_read_b64_tr_b16 v[76:77], v248 offset:16384
    ds_read_b64_tr_b16 v[78:79], v248 offset:16896
    s_waitcnt lgkmcnt(5)
    v_mfma_f32_32x32x16_bf16 v[32:47], v[64:67], v[188:191], v[32:47]
    ds_read_b128 v[196:199], v6
    ds_read_b64_tr_b16 v[80:81], v242 offset:18432
    ds_read_b64_tr_b16 v[82:83], v242 offset:18944
    v_mfma_f32_32x32x16_bf16 v[48:63], v[68:71], v[188:191], v[48:63]
    ds_read_b64_tr_b16 v[84:85], v248 offset:18432
    ds_read_b64_tr_b16 v[86:87], v248 offset:18944
    s_waitcnt lgkmcnt(5)
    v_mfma_f32_32x32x16_bf16 v[32:47], v[72:75], v[192:195], v[32:47]
    ds_read_b128 v[200:203], v7
    ds_read_b64_tr_b16 v[64:65], v242 offset:20480
    ds_read_b64_tr_b16 v[66:67], v242 offset:20992
    v_mfma_f32_32x32x16_bf16 v[48:63], v[76:79], v[192:195], v[48:63]
    ds_read_b64_tr_b16 v[68:69], v248 offset:20480
    ds_read_b64_tr_b16 v[70:71], v248 offset:20992
    s_waitcnt lgkmcnt(5)
    v_mfma_f32_32x32x16_bf16 v[32:47], v[80:83], v[196:199], v[32:47]
    ds_read_b128 v[204:207], v8
    ds_read_b64_tr_b16 v[72:73], v242 offset:22528
    ds_read_b64_tr_b16 v[74:75], v242 offset:23040
    v_mfma_f32_32x32x16_bf16 v[48:63], v[84:87], v[196:199], v[48:63]
    ds_read_b64_tr_b16 v[76:77], v248 offset:22528
    ds_read_b64_tr_b16 v[78:79], v248 offset:23040
    s_waitcnt lgkmcnt(0)
    s_barrier
    v_mfma_f32_32x32x16_bf16 v[32:47], v[64:67], v[200:203], v[32:47]
    v_add_u32 v5, 0x6000, v5
    v_add_u32 v6, 0x6000, v6
    v_add_u32 v7, 0x6000, v7
    v_add_u32 v8, 0x6000, v8
    v_add_u32 v242, 0x6000, v242
    v_add_u32 v248, 0x6000, v248
    ds_read_b128 v[208:211], v5
    ds_read_b64_tr_b16 v[80:81], v242 offset:16384
    ds_read_b64_tr_b16 v[82:83], v242 offset:16896
    v_mfma_f32_32x32x16_bf16 v[48:63], v[68:71], v[200:203], v[48:63]
    ds_read_b64_tr_b16 v[84:85], v248 offset:16384
    ds_read_b64_tr_b16 v[86:87], v248 offset:16896
    s_waitcnt lgkmcnt(5)
    v_mfma_f32_32x32x16_bf16 v[32:47], v[72:75], v[204:207], v[32:47]
    ds_read_b128 v[212:215], v6
    ds_read_b64_tr_b16 v[64:65], v242 offset:18432
    ds_read_b64_tr_b16 v[66:67], v242 offset:18944
    v_mfma_f32_32x32x16_bf16 v[48:63], v[76:79], v[204:207], v[48:63]
    ds_read_b64_tr_b16 v[68:69], v248 offset:18432
    ds_read_b64_tr_b16 v[70:71], v248 offset:18944
    s_waitcnt lgkmcnt(5)
    v_mfma_f32_32x32x16_bf16 v[32:47], v[80:83], v[208:211], v[32:47]
    ds_read_b128 v[216:219], v7
    ds_read_b64_tr_b16 v[72:73], v242 offset:20480
    ds_read_b64_tr_b16 v[74:75], v242 offset:20992
    v_mfma_f32_32x32x16_bf16 v[48:63], v[84:87], v[208:211], v[48:63]
    ds_read_b64_tr_b16 v[76:77], v248 offset:20480
    ds_read_b64_tr_b16 v[78:79], v248 offset:20992
    s_waitcnt lgkmcnt(5)
    v_mfma_f32_32x32x16_bf16 v[32:47], v[64:67], v[212:215], v[32:47]
    ds_read_b128 v[220:223], v8
    ds_read_b64_tr_b16 v[80:81], v242 offset:22528
    ds_read_b64_tr_b16 v[82:83], v242 offset:23040
    v_mfma_f32_32x32x16_bf16 v[48:63], v[68:71], v[212:215], v[48:63]
    ds_read_b64_tr_b16 v[84:85], v248 offset:22528
    ds_read_b64_tr_b16 v[86:87], v248 offset:23040
    s_waitcnt lgkmcnt(0)
    s_barrier
    v_mfma_f32_32x32x16_bf16 v[32:47], v[72:75], v[216:219], v[32:47]
    v_add_u32 v5, 0xffff4000, v5
    v_add_u32 v6, 0xffff4000, v6
    v_add_u32 v7, 0xffff4000, v7
    v_add_u32 v8, 0xffff4000, v8
    v_add_u32 v242, 0xffff4000, v242
    v_add_u32 v248, 0xffff4000, v248
    ds_read_b128 v[224:227], v5
    ds_read_b64_tr_b16 v[64:65], v242 offset:16384
    ds_read_b64_tr_b16 v[66:67], v242 offset:16896
    v_mfma_f32_32x32x16_bf16 v[48:63], v[76:79], v[216:219], v[48:63]
    ds_read_b64_tr_b16 v[68:69], v248 offset:16384
    ds_read_b64_tr_b16 v[70:71], v248 offset:16896
    s_waitcnt lgkmcnt(5)
    v_mfma_f32_32x32x16_bf16 v[32:47], v[80:83], v[220:223], v[32:47]
    ds_read_b128 v[228:231], v6
    ds_read_b64_tr_b16 v[72:73], v242 offset:18432
    ds_read_b64_tr_b16 v[74:75], v242 offset:18944
    v_mfma_f32_32x32x16_bf16 v[48:63], v[84:87], v[220:223], v[48:63]
    ds_read_b64_tr_b16 v[76:77], v248 offset:18432
    ds_read_b64_tr_b16 v[78:79], v248 offset:18944
    s_waitcnt lgkmcnt(5)
    v_mfma_f32_32x32x16_bf16 v[32:47], v[64:67], v[224:227], v[32:47]
    ds_read_b128 v[232:235], v7
    ds_read_b64_tr_b16 v[80:81], v242 offset:20480
    ds_read_b64_tr_b16 v[82:83], v242 offset:20992
    v_mfma_f32_32x32x16_bf16 v[48:63], v[68:71], v[224:227], v[48:63]
    ds_read_b64_tr_b16 v[84:85], v248 offset:20480
    ds_read_b64_tr_b16 v[86:87], v248 offset:20992
    s_waitcnt lgkmcnt(5)
    v_mfma_f32_32x32x16_bf16 v[32:47], v[72:75], v[228:231], v[32:47]
    ds_read_b128 v[236:239], v8
    ds_read_b64_tr_b16 v[64:65], v242 offset:22528
    ds_read_b64_tr_b16 v[66:67], v242 offset:23040
    v_mfma_f32_32x32x16_bf16 v[48:63], v[76:79], v[228:231], v[48:63]
    ds_read_b64_tr_b16 v[68:69], v248 offset:22528
    ds_read_b64_tr_b16 v[70:71], v248 offset:23040
    s_waitcnt lgkmcnt(0)
    s_barrier
    v_mfma_f32_32x32x16_bf16 v[32:47], v[80:83], v[232:235], v[32:47]
    v_mfma_f32_32x32x16_bf16 v[48:63], v[84:87], v[232:235], v[48:63]
    s_waitcnt lgkmcnt(0)
    v_mfma_f32_32x32x16_bf16 v[32:47], v[64:67], v[236:239], v[32:47]
    v_mfma_f32_32x32x16_bf16 v[48:63], v[68:71], v[236:239], v[48:63]
    s_mov_b32 s42, 0x3fb8aa3b
    s_mov_b32 s43, 0x3fb8aa3b
    s_nop 8
    v_cvt_pk_bf16_f32 v32, v32, v33
    v_cvt_pk_bf16_f32 v33, v34, v35
    v_cvt_pk_bf16_f32 v34, v36, v37
    v_cvt_pk_bf16_f32 v35, v38, v39
    v_cvt_pk_bf16_f32 v36, v40, v41
    v_cvt_pk_bf16_f32 v37, v42, v43
    v_cvt_pk_bf16_f32 v38, v44, v45
    v_cvt_pk_bf16_f32 v39, v46, v47
    v_mfma_f32_32x32x16_bf16 v[64:79], v[112:115], v[32:35], 0
    s_nop 0
    v_mfma_f32_32x32x16_bf16 v[64:79], v[116:119], v[36:39], v[64:79]
    v_cvt_pk_bf16_f32 v48, v48, v49
    v_cvt_pk_bf16_f32 v49, v50, v51
    v_cvt_pk_bf16_f32 v50, v52, v53
    v_cvt_pk_bf16_f32 v51, v54, v55
    v_cvt_pk_bf16_f32 v52, v56, v57
    v_cvt_pk_bf16_f32 v53, v58, v59
    v_cvt_pk_bf16_f32 v54, v60, v61
    v_cvt_pk_bf16_f32 v55, v62, v63
    v_mfma_f32_32x32x16_bf16 v[128:143], v[20:23], v[48:51], 0
    s_nop 0
    v_mfma_f32_32x32x16_bf16 v[128:143], v[24:27], v[52:55], v[128:143]
    s_nop 0
    v_max3_f32 v12, v64, v65, v66
    s_nop 9
    v_max3_f32 v96, v128, v129, v130
    v_min3_f32 v14, v64, v65, v66
    v_min3_f32 v98, v128, v129, v130
    v_max3_f32 v13, v67, v68, v69
    v_max3_f32 v97, v131, v132, v133
    v_min3_f32 v15, v67, v68, v69
    v_min3_f32 v99, v131, v132, v133
    v_max3_f32 v12, v12, v70, v71
    v_max3_f32 v96, v96, v134, v135
    v_min3_f32 v14, v14, v70, v71
    v_min3_f32 v98, v98, v134, v135
    v_max3_f32 v13, v13, v72, v73
    v_max3_f32 v97, v97, v136, v137
    v_min3_f32 v15, v15, v72, v73
    v_min3_f32 v99, v99, v136, v137
    v_max3_f32 v12, v12, v74, v75
    v_max3_f32 v96, v96, v138, v139
    v_min3_f32 v14, v14, v74, v75
    v_min3_f32 v98, v98, v138, v139
    v_mov_b32 v92, 0
    v_mov_b32 v156, 0
    v_mov_b32 v93, 0
    v_mov_b32 v157, 0
    v_mov_b32 v94, 0
    v_mov_b32 v158, 0
    v_mov_b32 v95, 0
    v_mov_b32 v159, 0
    s_mov_b32 exec_hi, 0
    v_max3_f32 v13, v13, v76, v77
    v_max3_f32 v97, v97, v140, v141
    v_min3_f32 v15, v15, v76, v77
    v_min3_f32 v99, v99, v140, v141
    v_max3_f32 v12, v12, v78, v79
    v_max3_f32 v96, v96, v142, v143
    v_min3_f32 v14, v14, v78, v79
    v_min3_f32 v98, v98, v142, v143
    s_mov_b32 exec_hi, -1
    v_max_f32 v12, v12, v13
    v_max_f32 v96, v96, v97
    v_min_f32 v14, v14, v15
    v_min_f32 v98, v98, v99
    v_mov_b32 v13, v12
    v_mov_b32 v97, v96
    v_mov_b32 v15, v14
    v_mov_b32 v99, v98
    v_permlane32_swap_b32 v12, v13
    v_permlane32_swap_b32 v96, v97
    v_permlane32_swap_b32 v14, v15
    v_permlane32_swap_b32 v98, v99
    v_max_f32 v12, v12, v13
    v_max_f32 v96, v96, v97
    v_min_f32 v14, v14, v15
    v_min_f32 v98, v98, v99
    v_mul_f32 v12, s42, v12
    v_mul_f32 v96, s42, v96
    v_mul_f32 v14, s42, v14
    v_mul_f32 v98, s42, v98
    v_fma_f32 v80, -v64, s42, v14
    v_fma_f32 v144, -v128, s42, v98
    v_fma_f32 v81, -v65, s43, v14
    v_fma_f32 v145, -v129, s43, v98
    v_fma_f32 v82, -v66, s42, v14
    v_fma_f32 v146, -v130, s42, v98
    v_fma_f32 v83, -v67, s43, v14
    v_fma_f32 v147, -v131, s43, v98
    v_fma_f32 v84, -v68, s42, v14
    v_fma_f32 v148, -v132, s42, v98
    v_fma_f32 v85, -v69, s43, v14
    v_fma_f32 v149, -v133, s43, v98
    v_fma_f32 v64, v64, s42, -v12
    v_fma_f32 v128, v128, s42, -v96
    v_fma_f32 v65, v65, s43, -v12
    v_fma_f32 v129, v129, s43, -v96
    v_fma_f32 v66, v66, s42, -v12
    v_fma_f32 v130, v130, s42, -v96
    v_fma_f32 v67, v67, s43, -v12
    v_fma_f32 v131, v131, s43, -v96
    v_fma_f32 v68, v68, s42, -v12
    v_fma_f32 v132, v132, s42, -v96
    v_fma_f32 v69, v69, s43, -v12
    v_fma_f32 v133, v133, s43, -v96
    v_exp_f32 v80, v80
    v_exp_f32 v144, v144
    v_exp_f32 v81, v81
    v_exp_f32 v145, v145
    v_exp_f32 v82, v82
    v_exp_f32 v146, v146
    v_exp_f32 v83, v83
    v_exp_f32 v147, v147
    v_exp_f32 v84, v84
    v_exp_f32 v148, v148
    v_exp_f32 v85, v85
    v_exp_f32 v149, v149
    v_exp_f32 v64, v64
    v_exp_f32 v128, v128
    v_exp_f32 v65, v65
    v_exp_f32 v129, v129
    v_exp_f32 v66, v66
    v_exp_f32 v130, v130
    v_exp_f32 v67, v67
    v_exp_f32 v131, v131
    v_exp_f32 v68, v68
    v_exp_f32 v132, v132
    v_exp_f32 v69, v69
    v_exp_f32 v133, v133
    v_fma_f32 v86, -v70, s42, v14
    v_fma_f32 v150, -v134, s42, v98
    v_fma_f32 v87, -v71, s43, v14
    v_fma_f32 v151, -v135, s43, v98
    v_fma_f32 v88, -v72, s42, v14
    v_fma_f32 v152, -v136, s42, v98
    v_fma_f32 v89, -v73, s43, v14
    v_fma_f32 v153, -v137, s43, v98
    v_fma_f32 v90, -v74, s42, v14
    v_fma_f32 v154, -v138, s42, v98
    v_fma_f32 v91, -v75, s43, v14
    v_fma_f32 v155, -v139, s43, v98
    v_fma_f32 v70, v70, s42, -v12
    v_fma_f32 v134, v134, s42, -v96
    v_fma_f32 v71, v71, s43, -v12
    v_fma_f32 v135, v135, s43, -v96
    v_fma_f32 v72, v72, s42, -v12
    v_fma_f32 v136, v136, s42, -v96
    v_fma_f32 v73, v73, s43, -v12
    v_fma_f32 v137, v137, s43, -v96
    v_fma_f32 v74, v74, s42, -v12
    v_fma_f32 v138, v138, s42, -v96
    v_fma_f32 v75, v75, s43, -v12
    v_fma_f32 v139, v139, s43, -v96
    v_exp_f32 v86, v86
    v_exp_f32 v150, v150
    v_exp_f32 v87, v87
    v_exp_f32 v151, v151
    v_exp_f32 v88, v88
    v_exp_f32 v152, v152
    v_exp_f32 v89, v89
    v_exp_f32 v153, v153
    v_exp_f32 v90, v90
    v_exp_f32 v154, v154
    v_exp_f32 v91, v91
    v_exp_f32 v155, v155
    v_exp_f32 v70, v70
    v_exp_f32 v134, v134
    v_exp_f32 v71, v71
    v_exp_f32 v135, v135
    v_exp_f32 v72, v72
    v_exp_f32 v136, v136
    v_exp_f32 v73, v73
    v_exp_f32 v137, v137
    v_exp_f32 v74, v74
    v_exp_f32 v138, v138
    v_exp_f32 v75, v75
    v_exp_f32 v139, v139
    s_mov_b32 exec_hi, 0
    v_fma_f32 v92, -v76, s42, v14
    v_fma_f32 v156, -v140, s42, v98
    v_fma_f32 v93, -v77, s43, v14
    v_fma_f32 v157, -v141, s43, v98
    v_fma_f32 v94, -v78, s42, v14
    v_fma_f32 v158, -v142, s42, v98
    v_fma_f32 v95, -v79, s43, v14
    v_fma_f32 v159, -v143, s43, v98
    v_fma_f32 v76, v76, s42, -v12
    v_fma_f32 v140, v140, s42, -v96
    v_fma_f32 v77, v77, s43, -v12
    v_fma_f32 v141, v141, s43, -v96
    v_fma_f32 v78, v78, s42, -v12
    v_fma_f32 v142, v142, s42, -v96
    v_fma_f32 v79, v79, s43, -v12
    v_fma_f32 v143, v143, s43, -v96
    v_exp_f32 v92, v92
    v_exp_f32 v156, v156
    v_exp_f32 v93, v93
    v_exp_f32 v157, v157
    v_exp_f32 v94, v94
    v_exp_f32 v158, v158
    v_exp_f32 v95, v95
    v_exp_f32 v159, v159
    v_exp_f32 v76, v76
    v_exp_f32 v140, v140
    v_exp_f32 v77, v77
    v_exp_f32 v141, v141
    v_exp_f32 v78, v78
    v_exp_f32 v142, v142
    v_exp_f32 v79, v79
    v_exp_f32 v143, v143
    s_mov_b32 exec_hi, -1
    v_add_f32 v16, v64, v66
    v_add_f32 v100, v128, v130
    v_add_f32 v17, v65, v67
    v_add_f32 v101, v129, v131
    v_add_f32 v18, v80, v82
    v_add_f32 v102, v144, v146
    v_add_f32 v19, v81, v83
    v_add_f32 v103, v145, v147
    v_add_f32 v16, v16, v68
    v_add_f32 v100, v100, v132
    v_add_f32 v17, v17, v69
    v_add_f32 v101, v101, v133
    v_add_f32 v18, v18, v84
    v_add_f32 v102, v102, v148
    v_add_f32 v19, v19, v85
    v_add_f32 v103, v103, v149
    v_add_f32 v16, v16, v70
    v_add_f32 v100, v100, v134
    v_add_f32 v17, v17, v71
    v_add_f32 v101, v101, v135
    v_add_f32 v18, v18, v86
    v_add_f32 v102, v102, v150
    v_add_f32 v19, v19, v87
    v_add_f32 v103, v103, v151
    v_add_f32 v16, v16, v72
    v_add_f32 v100, v100, v136
    v_add_f32 v17, v17, v73
    v_add_f32 v101, v101, v137
    v_add_f32 v18, v18, v88
    v_add_f32 v102, v102, v152
    v_add_f32 v19, v19, v89
    v_add_f32 v103, v103, v153
    v_add_f32 v16, v16, v74
    v_add_f32 v100, v100, v138
    v_add_f32 v17, v17, v75
    v_add_f32 v101, v101, v139
    v_add_f32 v18, v18, v90
    v_add_f32 v102, v102, v154
    v_add_f32 v19, v19, v91
    v_add_f32 v103, v103, v155
    v_add_f32 v16, v16, v76
    v_add_f32 v100, v100, v140
    v_add_f32 v17, v17, v77
    v_add_f32 v101, v101, v141
    v_add_f32 v18, v18, v92
    v_add_f32 v102, v102, v156
    v_add_f32 v19, v19, v93
    v_add_f32 v103, v103, v157
    v_add_f32 v16, v16, v78
    v_add_f32 v100, v100, v142
    v_add_f32 v17, v17, v79
    v_add_f32 v101, v101, v143
    v_add_f32 v18, v18, v94
    v_add_f32 v102, v102, v158
    v_add_f32 v19, v19, v95
    v_add_f32 v103, v103, v159
    v_add_f32 v16, v16, v17
    v_add_f32 v100, v100, v101
    v_add_f32 v18, v18, v19
    v_add_f32 v102, v102, v103
    v_mov_b32 v13, v16
    v_mov_b32 v97, v100
    v_mov_b32 v15, v18
    v_mov_b32 v99, v102
    v_permlane32_swap_b32 v16, v13
    v_permlane32_swap_b32 v100, v97
    v_permlane32_swap_b32 v18, v15
    v_permlane32_swap_b32 v102, v99
    v_add_f32 v16, v16, v13
    v_add_f32 v100, v100, v97
    v_add_f32 v18, v18, v15
    v_add_f32 v102, v102, v99
    v_rcp_f32 v16, v16
    v_rcp_f32 v100, v100
    v_rcp_f32 v18, v18
    v_rcp_f32 v102, v102
    v_mul_f32 v64, v64, v16
    v_mul_f32 v128, v128, v100
    v_mul_f32 v65, v65, v16
    v_mul_f32 v129, v129, v100
    v_mul_f32 v80, v80, v18
    v_mul_f32 v144, v144, v102
    v_mul_f32 v81, v81, v18
    v_mul_f32 v145, v145, v102
    v_mul_f32 v66, v66, v16
    v_mul_f32 v130, v130, v100
    v_mul_f32 v67, v67, v16
    v_mul_f32 v131, v131, v100
    v_mul_f32 v82, v82, v18
    v_mul_f32 v146, v146, v102
    v_mul_f32 v83, v83, v18
    v_mul_f32 v147, v147, v102
    v_mul_f32 v68, v68, v16
    v_mul_f32 v132, v132, v100
    v_mul_f32 v69, v69, v16
    v_mul_f32 v133, v133, v100
    v_mul_f32 v84, v84, v18
    v_mul_f32 v148, v148, v102
    v_mul_f32 v85, v85, v18
    v_mul_f32 v149, v149, v102
    v_mul_f32 v70, v70, v16
    v_mul_f32 v134, v134, v100
    v_mul_f32 v71, v71, v16
    v_mul_f32 v135, v135, v100
    v_mul_f32 v86, v86, v18
    v_mul_f32 v150, v150, v102
    v_mul_f32 v87, v87, v18
    v_mul_f32 v151, v151, v102
    v_mul_f32 v72, v72, v16
    v_mul_f32 v136, v136, v100
    v_mul_f32 v73, v73, v16
    v_mul_f32 v137, v137, v100
    v_mul_f32 v88, v88, v18
    v_mul_f32 v152, v152, v102
    v_mul_f32 v89, v89, v18
    v_mul_f32 v153, v153, v102
    v_mul_f32 v74, v74, v16
    v_mul_f32 v138, v138, v100
    v_mul_f32 v75, v75, v16
    v_mul_f32 v139, v139, v100
    v_mul_f32 v90, v90, v18
    v_mul_f32 v154, v154, v102
    v_mul_f32 v91, v91, v18
    v_mul_f32 v155, v155, v102
    v_mul_f32 v76, v76, v16
    v_mul_f32 v140, v140, v100
    v_mul_f32 v77, v77, v16
    v_mul_f32 v141, v141, v100
    v_mul_f32 v92, v92, v18
    v_mul_f32 v156, v156, v102
    v_mul_f32 v93, v93, v18
    v_mul_f32 v157, v157, v102
    v_mul_f32 v78, v78, v16
    v_mul_f32 v142, v142, v100
    v_mul_f32 v79, v79, v16
    v_mul_f32 v143, v143, v100
    v_mul_f32 v94, v94, v18
    v_mul_f32 v158, v158, v102
    v_mul_f32 v95, v95, v18
    v_mul_f32 v159, v159, v102
    v_cvt_pk_bf16_f32 v64, v64, v65
    v_cvt_pk_bf16_f32 v128, v128, v129
    v_cvt_pk_bf16_f32 v80, v80, v81
    v_cvt_pk_bf16_f32 v144, v144, v145
    v_cvt_pk_bf16_f32 v65, v66, v67
    v_cvt_pk_bf16_f32 v129, v130, v131
    v_cvt_pk_bf16_f32 v81, v82, v83
    v_cvt_pk_bf16_f32 v145, v146, v147
    v_cvt_pk_bf16_f32 v66, v68, v69
    v_cvt_pk_bf16_f32 v130, v132, v133
    v_cvt_pk_bf16_f32 v82, v84, v85
    v_cvt_pk_bf16_f32 v146, v148, v149
    v_cvt_pk_bf16_f32 v67, v70, v71
    v_cvt_pk_bf16_f32 v131, v134, v135
    v_cvt_pk_bf16_f32 v83, v86, v87
    v_cvt_pk_bf16_f32 v147, v150, v151
    v_cvt_pk_bf16_f32 v68, v72, v73
    v_cvt_pk_bf16_f32 v132, v136, v137
    v_cvt_pk_bf16_f32 v84, v88, v89
    v_cvt_pk_bf16_f32 v148, v152, v153
    v_cvt_pk_bf16_f32 v69, v74, v75
    v_cvt_pk_bf16_f32 v133, v138, v139
    v_cvt_pk_bf16_f32 v85, v90, v91
    v_cvt_pk_bf16_f32 v149, v154, v155
    v_cvt_pk_bf16_f32 v70, v76, v77
    v_cvt_pk_bf16_f32 v134, v140, v141
    v_cvt_pk_bf16_f32 v86, v92, v93
    v_cvt_pk_bf16_f32 v150, v156, v157
    v_cvt_pk_bf16_f32 v71, v78, v79
    v_cvt_pk_bf16_f32 v135, v142, v143
    v_cvt_pk_bf16_f32 v87, v94, v95
    v_cvt_pk_bf16_f32 v151, v158, v159
    ds_write_b64 v252, v[64:65] offset:0
    ds_write_b64 v252, v[80:81] offset:64
    ds_write_b64 v252, v[66:67] offset:16
    ds_write_b64 v252, v[82:83] offset:80
    ds_write_b64 v252, v[68:69] offset:32
    ds_write_b64 v252, v[84:85] offset:96
    ds_write_b64 v252, v[70:71] offset:48
    ds_write_b64 v252, v[86:87] offset:112
    ds_write_b64 v252, v[128:129] offset:25600
    ds_write_b64 v252, v[144:145] offset:25664
    ds_write_b64 v252, v[130:131] offset:25616
    ds_write_b64 v252, v[146:147] offset:25680
    ds_write_b64 v252, v[132:133] offset:25632
    ds_write_b64 v252, v[148:149] offset:25696
    ds_write_b64 v252, v[134:135] offset:25648
    ds_write_b64 v252, v[150:151] offset:25712
    s_branch attn_k1
attn_ld:
    v_subrev_u32 v2, 57344, v2
    v_subrev_u32 v3, 57344, v3
    v_subrev_u32 v4, 86016, v4
    s_waitcnt vmcnt(5) lgkmcnt(0)
    s_barrier
    ds_read_b128 v[128:131], v5
    ds_read_b128 v[132:135], v6
    ds_read_b128 v[136:139], v7
    ds_read_b128 v[140:143], v8
    s_lshl_b32 s3, s55, 1
    s_lshl_b32 s49, s48, 7
    s_add_u32 s49, s49, s51
    s_mul_i32 s50, s48, 172032
    s_add_u32 s50, s50, s52
    s_add_u32 m0, s3, 0xa000
    s_nop 0
    buffer_load_dwordx4 v2, s[4:7], s49 offen lds
    s_add_u32 m0, s55, 0xf000
    s_nop 0
    buffer_load_dwordx4 v4, s[8:11], s50 offen lds
    s_add_u32 m0, s3, 0xa400
    s_nop 0
    buffer_load_dwordx4 v3, s[4:7], s49 offen lds
    s_add_u32 s49, s49, 57344
    s_add_u32 s50, s50, 86016
    s_add_u32 m0, s3, 0xc000
    s_nop 0
    buffer_load_dwordx4 v2, s[4:7], s49 offen lds
    s_add_u32 m0, s55, 0x10000
    s_nop 0
    buffer_load_dwordx4 v4, s[8:11], s50 offen lds
    s_add_u32 m0, s3, 0xc400
    s_nop 0
    buffer_load_dwordx4 v3, s[4:7], s49 offen lds
    s_add_u32 s48, s48, 1
    s_cmp_eq_u32 s48, 7
    s_cselect_b32 s48, 0, s48
    s_waitcnt vmcnt(7) lgkmcnt(0)
    s_barrier
    v_add_u32 v5, 0x6000, v5
    v_add_u32 v6, 0x6000, v6
    v_add_u32 v7, 0x6000, v7
    v_add_u32 v8, 0x6000, v8
    ds_read_b128 v[144:147], v5
    ds_read_b128 v[148:151], v6
    ds_read_b128 v[152:155], v7
    ds_read_b128 v[156:159], v8
    s_lshl_b32 s3, s55, 1
    s_lshl_b32 s49, s48, 7
    s_add_u32 s49, s49, s51
    s_mul_i32 s50, s48, 172032
    s_add_u32 s50, s50, s52
    s_add_u32 m0, s3, 0xffffe000
    s_nop 0
    buffer_load_dwordx4 v2, s[4:7], s49 offen lds
    s_add_u32 m0, s55, 0x3000
    s_nop 0
    buffer_load_dwordx4 v4, s[8:11], s50 offen lds
    s_add_u32 m0, s3, 0xffffe400
    s_nop 0
    buffer_load_dwordx4 v3, s[4:7], s49 offen lds
    s_add_u32 s49, s49, 57344
    s_add_u32 s50, s50, 86016
    s_add_u32 m0, s3, 0x0
    s_nop 0
    buffer_load_dwordx4 v2, s[4:7], s49 offen lds
    s_add_u32 m0, s55, 0x4000
    s_nop 0
    buffer_load_dwordx4 v4, s[8:11], s50 offen lds
    s_add_u32 m0, s3, 0x400
    s_nop 0
    buffer_load_dwordx4 v3, s[4:7], s49 offen lds
    s_add_u32 s48, s48, 1
    s_cmp_eq_u32 s48, 7
    s_cselect_b32 s48, 0, s48
    buffer_load_dword v11, off, s[40:43], 0 sc1
    v_mov_b32 v29, 0
    v_and_b32 v12, 2, v0
    v_lshlrev_b32 v12, 5, v12
    v_xor_b32 v12, 112, v12
    v_lshl_add_u32 v12, v0, 7, v12
    v_add_u32 v12, 106496, v12
    s_cmp_eq_u32 s47, 7
    s_cbranch_scc1 gw_21
    ds_write_b64 v12, v[28:29]
gw_21:
    v_bfe_u32 v12, v1, 2, 2
    v_lshrrev_b32 v13, 5, v1
    v_lshl_add_u32 v12, v13, 2, v12
    v_and_b32 v13, 3, v1
    v_lshlrev_b32 v13, 3, v13
    v_and_b32 v14, 16, v1
    v_lshl_add_u32 v13, v14, 1, v13
    v_and_b32 v14, 8, v1
    v_lshlrev_b32 v14, 3, v14
    v_mul_u32_u24 v12, 56, v12
    v_add_u32 v13, v12, v13
    v_add_u32 v12, 103968, v13
    v_add_u32 v13, 102400, v13
    ds_read_b64_tr_b16 v[20:21], v12 offset:0
    ds_read_b64_tr_b16 v[112:113], v13 offset:0
    ds_read_b64_tr_b16 v[22:23], v12 offset:448
    ds_read_b64_tr_b16 v[114:115], v13 offset:448
    ds_read_b64_tr_b16 v[24:25], v12 offset:896
    ds_read_b64_tr_b16 v[116:117], v13 offset:896
    ds_read_b64_tr_b16 v[26:27], v12 offset:1344
    ds_read_b64_tr_b16 v[118:119], v13 offset:1344
    s_waitcnt vmcnt(7) lgkmcnt(0)
    s_barrier
    v_add_u32 v5, 0x6000, v5
    v_add_u32 v6, 0x6000, v6
    v_add_u32 v7, 0x6000, v7
    v_add_u32 v8, 0x6000, v8
    ds_read_b128 v[160:163], v5
    ds_read_b128 v[164:167], v6
    ds_read_b128 v[168:171], v7
    ds_read_b128 v[172:175], v8
    s_lshl_b32 s3, s55, 1
    s_lshl_b32 s49, s48, 7
    s_add_u32 s49, s49, s51
    s_mul_i32 s50, s48, 172032
    s_add_u32 s50, s50, s52
    s_add_u32 m0, s3, 0x4000
    s_nop 0
    buffer_load_dwordx4 v2, s[4:7], s49 offen lds
    s_add_u32 m0, s55, 0x9000
    s_nop 0
    buffer_load_dwordx4 v4, s[8:11], s50 offen lds
    s_add_u32 m0, s3, 0x4400
    s_nop 0
    buffer_load_dwordx4 v3, s[4:7], s49 offen lds
    s_add_u32 s49, s49, 57344
    s_add_u32 s50, s50, 86016
    s_add_u32 m0, s3, 0x6000
    s_nop 0
    buffer_load_dwordx4 v2, s[4:7], s49 offen lds
    s_add_u32 m0, s55, 0xa000
    s_nop 0
    buffer_load_dwordx4 v4, s[8:11], s50 offen lds
    s_add_u32 m0, s3, 0x6400
    s_nop 0
    buffer_load_dwordx4 v3, s[4:7], s49 offen lds
    s_add_u32 s48, s48, 1
    s_cmp_eq_u32 s48, 7
    s_cselect_b32 s48, 0, s48
    s_mov_b32 exec_lo, 0xf0000000
    s_mov_b32 exec_hi, 0xf0000000
    v_mov_b32 v20, 0
    v_mov_b32 v112, 0
    v_mov_b32 v21, 0
    v_mov_b32 v113, 0
    v_mov_b32 v22, 0
    v_mov_b32 v114, 0
    v_mov_b32 v23, 0
    v_mov_b32 v115, 0
    v_mov_b32 v24, 0
    v_mov_b32 v116, 0
    v_mov_b32 v25, 0
    v_mov_b32 v117, 0
    s_mov_b32 exec_hi, -1
    v_mov_b32 v26, 0
    v_mov_b32 v118, 0
    v_mov_b32 v27, 0
    v_mov_b32 v119, 0
    s_mov_b32 exec_lo, -1
    s_mul_i32 s62, s57, 25600
    s_add_u32 s62, s62, 0
    s_and_b32 s64, s47, 3
    s_mul_i32 s64, s64, 6400
    s_add_u32 s64, s64, 0
    v_and_b32 v12, 31, v1
    v_mul_u32_u24 v12, 200, v12
    v_lshrrev_b32 v13, 5, v1
    v_lshl_add_u32 v12, v13, 3, v12
    v_add_u32 v252, s64, v12
    v_bfe_u32 v12, v1, 2, 3
    v_lshlrev_b32 v12, 1, v12
    v_add_u32 v12, v12, v13
    v_mul_u32_u24 v12, 400, v12
    v_and_b32 v13, 3, v1
    v_lshl_add_u32 v12, v13, 3, v12
    v_add_u32 v253, s62, v12
    s_and_b32 s63, s47, 3
    s_lshl_b32 s63, s63, 5
    v_add_u32 v254, s63, v253
    v_lshrrev_b32 v12, 5, v1
    v_lshlrev_b32 v12, 14, v12
    v_and_b32 v13, 16, v1
    v_lshl_add_u32 v12, v13, 5, v12
    v_and_b32 v13, 15, v1
    v_lshl_add_u32 v255, v13, 4, v12
    s_lshl_b32 s62, s45, 4
    s_lshl_b32 s63, s47, 1
    s_add_u32 s63, s63, s62
    s_lshl_b32 s63, s63, 4
    s_add_u32 s63, s63, s44
    s_lshl_b32 s63, s63, 10
    s_add_u32 s60, s63, 0xc00000
    v_lshrrev_b32 v12, 4, v1
    v_lshlrev_b32 v12, 10, v12
    v_lshl_add_u32 v241, v13, 4, v12
    s_add_u32 s62, s62, s44
    s_lshl_b32 s62, s62, 14
    s_lshl_b32 s63, s47, 8
    s_add_u32 s62, s62, s63
    s_add_u32 s22, s62, 0xc00000
    s_lshl_b32 s62, s45, 2
    s_and_b32 s63, s47, 3
    s_add_u32 s62, s62, s63
    s_lshl_b32 s62, s62, 12
    s_add_u32 s23, s62, 0xf00000
    s_mov_b32 s20, 0x0c0c0400
    s_mov_b32 s21, 0x04000c0c
    s_waitcnt vmcnt(7) lgkmcnt(0)
    s_barrier
    v_add_u32 v5, 0xffff4000, v5
    v_add_u32 v6, 0xffff4000, v6
    v_add_u32 v7, 0xffff4000, v7
    v_add_u32 v8, 0xffff4000, v8
    ds_read_b128 v[176:179], v5
    ds_read_b128 v[180:183], v6
    ds_read_b128 v[184:187], v7
    ds_read_b128 v[188:191], v8
    s_lshl_b32 s3, s55, 1
    s_lshl_b32 s49, s48, 7
    s_add_u32 s49, s49, s51
    s_mul_i32 s50, s48, 172032
    s_add_u32 s50, s50, s52
    s_add_u32 m0, s3, 0xa000
    s_nop 0
    buffer_load_dwordx4 v2, s[4:7], s49 offen lds
    s_add_u32 m0, s55, 0xf000
    s_nop 0
    buffer_load_dwordx4 v4, s[8:11], s50 offen lds
    s_add_u32 m0, s3, 0xa400
    s_nop 0
    buffer_load_dwordx4 v3, s[4:7], s49 offen lds
    s_add_u32 s49, s49, 57344
    s_add_u32 s50, s50, 86016
    s_add_u32 m0, s3, 0xc000
    s_nop 0
    buffer_load_dwordx4 v2, s[4:7], s49 offen lds
    s_add_u32 m0, s55, 0x10000
    s_nop 0
    buffer_load_dwordx4 v4, s[8:11], s50 offen lds
    s_add_u32 m0, s3, 0xc400
    s_nop 0
    buffer_load_dwordx4 v3, s[4:7], s49 offen lds
    s_add_u32 s48, s48, 1
    s_cmp_eq_u32 s48, 7
    s_cselect_b32 s48, 0, s48
    s_waitcnt vmcnt(6) lgkmcnt(0)
    s_barrier
    v_add_u32 v5, 0x6000, v5
    v_add_u32 v6, 0x6000, v6
    v_add_u32 v7, 0x6000, v7
    v_add_u32 v8, 0x6000, v8
    ds_read_b128 v[192:195], v5
    ds_read_b128 v[196:199], v6
    ds_read_b128 v[200:203], v7
    ds_read_b128 v[204:207], v8
    s_lshl_b32 s3, s55, 1
    s_lshl_b32 s49, s48, 7
    s_add_u32 s49, s49, s51
    s_mul_i32 s50, s48, 172032
    s_add_u32 s50, s50, s52
    s_add_u32 m0, s3, 0xffffe000
    s_nop 0
    buffer_load_dwordx4 v2, s[4:7], s49 offen lds
    s_add_u32 m0, s55, 0x3000
    s_nop 0
    buffer_load_dwordx4 v4, s[8:11], s50 offen lds
    s_add_u32 m0, s3, 0xffffe400
    s_nop 0
    buffer_load_dwordx4 v3, s[4:7], s49 offen lds
    s_add_u32 s49, s49, 57344
    s_add_u32 s50, s50, 86016
    s_add_u32 m0, s3, 0x0
    s_nop 0
    buffer_load_dwordx4 v2, s[4:7], s49 offen lds
    s_add_u32 m0, s55, 0x4000
    s_nop 0
    buffer_load_dwordx4 v4, s[8:11], s50 offen lds
    s_add_u32 m0, s3, 0x400
    s_nop 0
    buffer_load_dwordx4 v3, s[4:7], s49 offen lds
    s_add_u32 s48, s48, 1
    s_cmp_eq_u32 s48, 7
    s_cselect_b32 s48, 0, s48
    s_waitcnt vmcnt(18)
    v_cmp_ne_u32 vcc, 0, v11
    s_nop 3
    s_cmp_eq_u64 vcc, exec
    s_cbranch_scc1 pd_22
    s_mov_b32 s3, 200000
pl_23:
    s_sleep 1
    buffer_load_dword v11, off, s[40:43], 0 sc1
    s_waitcnt vmcnt(0)
    v_cmp_ne_u32 vcc, 0, v11
    s_nop 3
    s_cmp_eq_u64 vcc, exec
    s_cbranch_scc1 pd_22
    s_sub_u32 s3, s3, 1
    s_cbranch_scc0 pl_23
pd_22:
    s_getreg_b32 s62, hwreg(HW_REG_XCC_ID, 0, 4)
    s_lshl_b32 s62, s62, 1
    s_add_u32 s62, s62, 2
    v_add_u32 v10, s62, v11
    s_and_b32 s66, s2, 7
    s_lshl_b32 s66, s66, 7
    s_add_u32 s66, s66, 0x1520000
    s_cmp_lg_u32 s47, 0
    s_cbranch_scc1 xp_24
    s_lshr_b32 s63, s2, 3
    s_lshl_b32 s63, s63, 2
    s_add_u32 s63, s63, s66
    s_mov_b64 exec, 1
    buffer_store_dword v10, off, s[12:15], s63
    s_mov_b64 exec, -1
xp_24:
    s_waitcnt vmcnt(6) lgkmcnt(0)
    s_barrier
    v_add_u32 v5, 0x6000, v5
    v_add_u32 v6, 0x6000, v6
    v_add_u32 v7, 0x6000, v7
    v_add_u32 v8, 0x6000, v8
    ds_read_b128 v[208:211], v5
    ds_read_b128 v[212:215], v6
    ds_read_b128 v[216:219], v7
    ds_read_b128 v[220:223], v8
    s_mul_i32 s50, s48, 172032
    s_add_u32 s50, s50, s56
    s_add_u32 m0, s55, 0x19000
    s_add_u32 s50, s50, 1792
    s_mov_b64 exec, s[58:59]
    buffer_load_dwordx4 v4, s[8:11], s50 offen lds
    s_mov_b64 exec, -1
    s_add_u32 m0, s55, 0x1a000
    s_add_u32 s50, s50, 86016
    s_mov_b64 exec, s[58:59]
    buffer_load_dwordx4 v4, s[8:11], s50 offen lds
    s_mov_b64 exec, -1
    s_add_u32 s48, s48, 1
    s_cmp_eq_u32 s48, 7
    s_cselect_b32 s48, 0, s48
    s_mul_i32 s50, s48, 172032
    s_add_u32 s50, s50, s56
    s_add_u32 m0, s55, 0x1b000
    s_add_u32 s50, s50, 1792
    s_mov_b64 exec, s[58:59]
    buffer_load_dwordx4 v4, s[8:11], s50 offen lds
    s_mov_b64 exec, -1
    s_add_u32 m0, s55, 0x1c000
    s_add_u32 s50, s50, 86016
    s_mov_b64 exec, s[58:59]
    buffer_load_dwordx4 v4, s[8:11], s50 offen lds
    s_mov_b64 exec, -1
    s_add_u32 s48, s48, 1
    s_cmp_eq_u32 s48, 7
    s_cselect_b32 s48, 0, s48
    s_waitcnt vmcnt(4) lgkmcnt(0)
    s_barrier
    v_add_u32 v5, 0xffff4000, v5
    v_add_u32 v6, 0xffff4000, v6
    v_add_u32 v7, 0xffff4000, v7
    v_add_u32 v8, 0xffff4000, v8
    ds_read_b128 v[224:227], v5
    ds_read_b128 v[228:231], v6
    ds_read_b128 v[232:235], v7
    ds_read_b128 v[236:239], v8
    s_mul_i32 s50, s48, 172032
    s_add_u32 s50, s50, s56
    s_add_u32 m0, s55, 0x1d000
    s_add_u32 s50, s50, 1792
    s_mov_b64 exec, s[58:59]
    buffer_load_dwordx4 v4, s[8:11], s50 offen lds
    s_mov_b64 exec, -1
    s_add_u32 m0, s55, 0x1e000
    s_add_u32 s50, s50, 86016
    s_mov_b64 exec, s[58:59]
    buffer_load_dwordx4 v4, s[8:11], s50 offen lds
    s_mov_b64 exec, -1
    s_add_u32 s48, s48, 1
    s_cmp_eq_u32 s48, 7
    s_cselect_b32 s48, 0, s48
    s_mul_i32 s50, s48, 172032
    s_add_u32 s50, s50, s56
    s_add_u32 m0, s55, 0x1f000
    s_add_u32 s50, s50, 1792
    s_mov_b64 exec, s[58:59]
    buffer_load_dwordx4 v4, s[8:11], s50 offen lds
    s_mov_b64 exec, -1
    s_add_u32 m0, s55, 0x20000
    s_add_u32 s50, s50, 86016
    s_mov_b64 exec, s[58:59]
    buffer_load_dwordx4 v4, s[8:11], s50 offen lds
    s_mov_b64 exec, -1
    s_add_u32 s48, s48, 1
    s_cmp_eq_u32 s48, 7
    s_cselect_b32 s48, 0, s48
    s_and_b32 s62, s47, 3
    s_lshl_b32 s63, s44, 2
    s_add_u32 s62, s62, s63
    s_lshl_b32 s62, s62, 3
    s_add_u32 s62, s62, s45
    s_lshl_b32 s62, s62, 12
    s_add_u32 s4, s62, 0x800000
    s_lshl_b32 s62, s44, 3
    s_add_u32 s62, s62, s45
    s_lshl_b32 s62, s62, 9
    s_and_b32 s63, s47, 3
    s_lshl_b32 s63, s63, 7
    s_add_u32 s62, s62, s63
    s_add_u32 s5, s62, 0x1400000
    s_lshl_b32 s6, s44, 3
    s_add_u32 s6, s6, s45
    s_lshl_b32 s6, s6, 5
    s_add_u32 s6, s6, s47
    s_lshl_b32 s6, s6, 2
    s_add_u32 s6, s6, 0x1510000
    s_mov_b32 s42, 0x3fb8aa3b
    s_mov_b32 s43, 0x3fb8aa3b
    v_and_b32 v9, 3, v1
    v_lshlrev_b32 v9, 2, v9
    s_waitcnt vmcnt(4) lgkmcnt(0)
    s_barrier
    s_mul_i32 s50, s48, 172032
    s_add_u32 s50, s50, s56
    s_add_u32 m0, s55, 0x21000
    s_add_u32 s50, s50, 1792
    s_mov_b64 exec, s[58:59]
    buffer_load_dwordx4 v4, s[8:11], s50 offen lds
    s_mov_b64 exec, -1
    s_add_u32 m0, s55, 0x22000
    s_add_u32 s50, s50, 86016
    s_mov_b64 exec, s[58:59]
    buffer_load_dwordx4 v4, s[8:11], s50 offen lds
    s_mov_b64 exec, -1
    s_add_u32 s48, s48, 1
    s_cmp_eq_u32 s48, 7
    s_cselect_b32 s48, 0, s48
    s_mul_i32 s50, s48, 172032
    s_add_u32 s50, s50, s56
    s_add_u32 m0, s55, 0x23000
    s_add_u32 s50, s50, 1792
    s_mov_b64 exec, s[58:59]
    buffer_load_dwordx4 v4, s[8:11], s50 offen lds
    s_mov_b64 exec, -1
    s_add_u32 m0, s55, 0x24000
    s_add_u32 s50, s50, 86016
    s_mov_b64 exec, s[58:59]
    buffer_load_dwordx4 v4, s[8:11], s50 offen lds
    s_mov_b64 exec, -1
    s_add_u32 s48, s48, 1
    s_cmp_eq_u32 s48, 7
    s_cselect_b32 s48, 0, s48
    s_mul_i32 s50, s48, 172032
    s_add_u32 s50, s50, s56
    s_add_u32 m0, s55, 0x25000
    s_add_u32 s50, s50, 1792
    s_mov_b64 exec, s[58:59]
    buffer_load_dwordx4 v4, s[8:11], s50 offen lds
    s_mov_b64 exec, -1
    s_add_u32 m0, s55, 0x26000
    s_add_u32 s50, s50, 86016
    s_mov_b64 exec, s[58:59]
    buffer_load_dwordx4 v4, s[8:11], s50 offen lds
    s_mov_b64 exec, -1
    s_add_u32 s48, s48, 1
    s_cmp_eq_u32 s48, 7
    s_cselect_b32 s48, 0, s48
    s_setprio 2
    ds_read_b64_tr_b16 v[32:33], v242 offset:0
    ds_read_b64_tr_b16 v[34:35], v242 offset:512
    ds_read_b64_tr_b16 v[36:37], v248 offset:0
    ds_read_b64_tr_b16 v[38:39], v248 offset:512
    ds_read_b64_tr_b16 v[40:41], v242 offset:2048
    ds_read_b64_tr_b16 v[42:43], v242 offset:2560
    ds_read_b64_tr_b16 v[44:45], v248 offset:2048
    ds_read_b64_tr_b16 v[46:47], v248 offset:2560
    ds_read_b64_tr_b16 v[48:49], v242 offset:4096
    ds_read_b64_tr_b16 v[50:51], v242 offset:4608
    ds_read_b64_tr_b16 v[52:53], v248 offset:4096
    ds_read_b64_tr_b16 v[54:55], v248 offset:4608
    s_waitcnt lgkmcnt(8)
    v_mfma_f32_32x32x16_bf16 v[96:111], v[32:35], v[128:131], 0
    v_mfma_f32_32x32x16_bf16 v[64:79], v[36:39], v[128:131], 0
    ds_read_b64_tr_b16 v[56:57], v242 offset:6144
    ds_read_b64_tr_b16 v[58:59], v242 offset:6656
    ds_read_b64_tr_b16 v[60:61], v248 offset:6144
    ds_read_b64_tr_b16 v[62:63], v248 offset:6656
    s_waitcnt lgkmcnt(8)
    v_mfma_f32_32x32x16_bf16 v[96:111], v[40:43], v[132:135], v[96:111]
    v_mfma_f32_32x32x16_bf16 v[64:79], v[44:47], v[132:135], v[64:79]
    ds_read_b64_tr_b16 v[32:33], v242 offset:8192
    ds_read_b64_tr_b16 v[34:35], v242 offset:8704
    ds_read_b64_tr_b16 v[36:37], v248 offset:8192
    ds_read_b64_tr_b16 v[38:39], v248 offset:8704
    s_waitcnt lgkmcnt(8)
    v_mfma_f32_32x32x16_bf16 v[96:111], v[48:51], v[136:139], v[96:111]
    v_mfma_f32_32x32x16_bf16 v[64:79], v[52:55], v[136:139], v[64:79]
    ds_read_b64_tr_b16 v[40:41], v242 offset:10240
    ds_read_b64_tr_b16 v[42:43], v242 offset:10752
    ds_read_b64_tr_b16 v[44:45], v248 offset:10240
    ds_read_b64_tr_b16 v[46:47], v248 offset:10752
    s_waitcnt lgkmcnt(8)
    v_mfma_f32_32x32x16_bf16 v[96:111], v[56:59], v[140:143], v[96:111]
    v_mfma_f32_32x32x16_bf16 v[64:79], v[60:63], v[140:143], v[64:79]
    ds_read_b64_tr_b16 v[48:49], v242 offset:12288
    ds_read_b64_tr_b16 v[50:51], v242 offset:12800
    ds_read_b64_tr_b16 v[52:53], v248 offset:12288
    ds_read_b64_tr_b16 v[54:55], v248 offset:12800
    s_waitcnt lgkmcnt(8)
    v_mfma_f32_32x32x16_bf16 v[96:111], v[32:35], v[144:147], v[96:111]
    v_mfma_f32_32x32x16_bf16 v[64:79], v[36:39], v[144:147], v[64:79]
    ds_read_b64_tr_b16 v[56:57], v242 offset:14336
    ds_read_b64_tr_b16 v[58:59], v242 offset:14848
    ds_read_b64_tr_b16 v[60:61], v248 offset:14336
    ds_read_b64_tr_b16 v[62:63], v248 offset:14848
    s_waitcnt lgkmcnt(8)
    v_mfma_f32_32x32x16_bf16 v[96:111], v[40:43], v[148:151], v[96:111]
    v_mfma_f32_32x32x16_bf16 v[64:79], v[44:47], v[148:151], v[64:79]
    s_waitcnt vmcnt(6)
    s_lshl_b64 exec, 1, s47
    ds_write_b32 v9, v11 offset:51200
    s_mov_b64 exec, -1
    s_mov_b32 s3, 2000000
gs_25:
    ds_read_b32 v249, v9 offset:51200
    s_waitcnt lgkmcnt(0)
    v_cmp_eq_u32 vcc, v11, v249
    s_nop 3
    s_cmp_eq_u64 vcc, exec
    s_cbranch_scc1 gs_26
    s_sub_u32 s3, s3, 1
    s_cbranch_scc0 gs_25
gs_26:
    ds_read_b64_tr_b16 v[32:33], v242 offset:16384
    ds_read_b64_tr_b16 v[34:35], v242 offset:16896
    ds_read_b64_tr_b16 v[36:37], v248 offset:16384
    ds_read_b64_tr_b16 v[38:39], v248 offset:16896
    s_waitcnt lgkmcnt(8)
    v_mfma_f32_32x32x16_bf16 v[96:111], v[48:51], v[152:155], v[96:111]
    v_mfma_f32_32x32x16_bf16 v[64:79], v[52:55], v[152:155], v[64:79]
    ds_read_b64_tr_b16 v[40:41], v242 offset:18432
    ds_read_b64_tr_b16 v[42:43], v242 offset:18944
    ds_read_b64_tr_b16 v[44:45], v248 offset:18432
    ds_read_b64_tr_b16 v[46:47], v248 offset:18944
    s_waitcnt lgkmcnt(8)
    v_mfma_f32_32x32x16_bf16 v[96:111], v[56:59], v[156:159], v[96:111]
    v_mfma_f32_32x32x16_bf16 v[64:79], v[60:63], v[156:159], v[64:79]
    ds_read_b64_tr_b16 v[48:49], v242 offset:20480
    ds_read_b64_tr_b16 v[50:51], v242 offset:20992
    ds_read_b64_tr_b16 v[52:53], v248 offset:20480
    ds_read_b64_tr_b16 v[54:55], v248 offset:20992
    s_waitcnt lgkmcnt(8)
    v_mfma_f32_32x32x16_bf16 v[96:111], v[32:35], v[160:163], v[96:111]
    v_mfma_f32_32x32x16_bf16 v[64:79], v[36:39], v[160:163], v[64:79]
    ds_read_b64_tr_b16 v[56:57], v242 offset:22528
    ds_read_b64_tr_b16 v[58:59], v242 offset:23040
    ds_read_b64_tr_b16 v[60:61], v248 offset:22528
    ds_read_b64_tr_b16 v[62:63], v248 offset:23040
    s_waitcnt lgkmcnt(8)
    v_mfma_f32_32x32x16_bf16 v[96:111], v[40:43], v[164:167], v[96:111]
    v_mfma_f32_32x32x16_bf16 v[64:79], v[44:47], v[164:167], v[64:79]
    ds_read_b64_tr_b16 v[32:33], v242 offset:24576
    ds_read_b64_tr_b16 v[34:35], v242 offset:25088
    ds_read_b64_tr_b16 v[36:37], v248 offset:24576
    ds_read_b64_tr_b16 v[38:39], v248 offset:25088
    s_mul_i32 s50, s48, 172032
    s_add_u32 s50, s50, s56
    s_add_u32 m0, s55, 0xd000
    s_nop 0
    buffer_load_dwordx4 v4, s[8:11], s50 offen lds
    s_waitcnt lgkmcnt(8)
    v_mfma_f32_32x32x16_bf16 v[96:111], v[48:51], v[168:171], v[96:111]
    v_mfma_f32_32x32x16_bf16 v[64:79], v[52:55], v[168:171], v[64:79]
    ds_read_b64_tr_b16 v[40:41], v242 offset:26624
    ds_read_b64_tr_b16 v[42:43], v242 offset:27136
    ds_read_b64_tr_b16 v[44:45], v248 offset:26624
    ds_read_b64_tr_b16 v[46:47], v248 offset:27136
    s_waitcnt lgkmcnt(8)
    v_mfma_f32_32x32x16_bf16 v[96:111], v[56:59], v[172:175], v[96:111]
    v_mfma_f32_32x32x16_bf16 v[64:79], v[60:63], v[172:175], v[64:79]
    ds_read_b64_tr_b16 v[48:49], v242 offset:28672
    ds_read_b64_tr_b16 v[50:51], v242 offset:29184
    ds_read_b64_tr_b16 v[52:53], v248 offset:28672
    ds_read_b64_tr_b16 v[54:55], v248 offset:29184
    s_add_u32 m0, s55, 0xe000
    s_add_u32 s50, s50, 86016
    buffer_load_dwordx4 v4, s[8:11], s50 offen lds
    s_add_u32 s48, s48, 1
    s_cmp_eq_u32 s48, 7
    s_cselect_b32 s48, 0, s48
    s_waitcnt lgkmcnt(8)
    v_mfma_f32_32x32x16_bf16 v[96:111], v[32:35], v[176:179], v[96:111]
    v_mfma_f32_32x32x16_bf16 v[64:79], v[36:39], v[176:179], v[64:79]
    ds_read_b64_tr_b16 v[56:57], v242 offset:30720
    ds_read_b64_tr_b16 v[58:59], v242 offset:31232
    ds_read_b64_tr_b16 v[60:61], v248 offset:30720
    ds_read_b64_tr_b16 v[62:63], v248 offset:31232
    s_waitcnt lgkmcnt(8)
    v_mfma_f32_32x32x16_bf16 v[96:111], v[40:43], v[180:183], v[96:111]
    v_mfma_f32_32x32x16_bf16 v[64:79], v[44:47], v[180:183], v[64:79]
    s_waitcnt vmcnt(2)
    s_lshl_b64 exec, 1, s47
    ds_write_b32 v9, v11 offset:51216
    s_mov_b64 exec, -1
    s_mov_b32 s3, 2000000
gs_27:
    ds_read_b32 v249, v9 offset:51216
    s_waitcnt lgkmcnt(0)
    v_cmp_eq_u32 vcc, v11, v249
    s_nop 3
    s_cmp_eq_u64 vcc, exec
    s_cbranch_scc1 gs_28
    s_sub_u32 s3, s3, 1
    s_cbranch_scc0 gs_27
gs_28:
    ds_read_b64_tr_b16 v[32:33], v242 offset:32768
    ds_read_b64_tr_b16 v[34:35], v242 offset:33280
    ds_read_b64_tr_b16 v[36:37], v248 offset:32768
    ds_read_b64_tr_b16 v[38:39], v248 offset:33280
    s_mul_i32 s50, s48, 172032
    s_add_u32 s50, s50, s56
    s_add_u32 m0, s55, 0xf000
    s_nop 0
    buffer_load_dwordx4 v4, s[8:11], s50 offen lds
    s_waitcnt lgkmcnt(8)
    v_mfma_f32_32x32x16_bf16 v[96:111], v[48:51], v[184:187], v[96:111]
    v_mfma_f32_32x32x16_bf16 v[64:79], v[52:55], v[184:187], v[64:79]
    ds_read_b64_tr_b16 v[40:41], v242 offset:34816
    ds_read_b64_tr_b16 v[42:43], v242 offset:35328
    ds_read_b64_tr_b16 v[44:45], v248 offset:34816
    ds_read_b64_tr_b16 v[46:47], v248 offset:35328
    s_waitcnt lgkmcnt(8)
    v_mfma_f32_32x32x16_bf16 v[96:111], v[56:59], v[188:191], v[96:111]
    v_mfma_f32_32x32x16_bf16 v[64:79], v[60:63], v[188:191], v[64:79]
    ds_read_b64_tr_b16 v[48:49], v242 offset:36864
    ds_read_b64_tr_b16 v[50:51], v242 offset:37376
    ds_read_b64_tr_b16 v[52:53], v248 offset:36864
    ds_read_b64_tr_b16 v[54:55], v248 offset:37376
    s_add_u32 m0, s55, 0x10000
    s_add_u32 s50, s50, 86016
    buffer_load_dwordx4 v4, s[8:11], s50 offen lds
    s_add_u32 s48, s48, 1
    s_cmp_eq_u32 s48, 7
    s_cselect_b32 s48, 0, s48
    s_waitcnt lgkmcnt(8)
    v_mfma_f32_32x32x16_bf16 v[96:111], v[32:35], v[192:195], v[96:111]
    v_mfma_f32_32x32x16_bf16 v[64:79], v[36:39], v[192:195], v[64:79]
    ds_read_b64_tr_b16 v[56:57], v242 offset:38912
    ds_read_b64_tr_b16 v[58:59], v242 offset:39424
    ds_read_b64_tr_b16 v[60:61], v248 offset:38912
    ds_read_b64_tr_b16 v[62:63], v248 offset:39424
    s_waitcnt lgkmcnt(8)
    v_mfma_f32_32x32x16_bf16 v[96:111], v[40:43], v[196:199], v[96:111]
    v_mfma_f32_32x32x16_bf16 v[64:79], v[44:47], v[196:199], v[64:79]
    ds_read_b64_tr_b16 v[32:33], v242 offset:40960
    ds_read_b64_tr_b16 v[34:35], v242 offset:41472
    ds_read_b64_tr_b16 v[36:37], v248 offset:40960
    ds_read_b64_tr_b16 v[38:39], v248 offset:41472
    s_mul_i32 s50, s48, 172032
    s_add_u32 s50, s50, s56
    s_add_u32 m0, s55, 0x11000
    s_nop 0
    buffer_load_dwordx4 v4, s[8:11], s50 offen lds
    s_waitcnt lgkmcnt(8)
    v_mfma_f32_32x32x16_bf16 v[96:111], v[48:51], v[200:203], v[96:111]
    v_mfma_f32_32x32x16_bf16 v[64:79], v[52:55], v[200:203], v[64:79]
    ds_read_b64_tr_b16 v[40:41], v242 offset:43008
    ds_read_b64_tr_b16 v[42:43], v242 offset:43520
    ds_read_b64_tr_b16 v[44:45], v248 offset:43008
    ds_read_b64_tr_b16 v[46:47], v248 offset:43520
    s_waitcnt lgkmcnt(8)
    v_mfma_f32_32x32x16_bf16 v[96:111], v[56:59], v[204:207], v[96:111]
    v_mfma_f32_32x32x16_bf16 v[64:79], v[60:63], v[204:207], v[64:79]
    ds_read_b64_tr_b16 v[48:49], v242 offset:45056
    ds_read_b64_tr_b16 v[50:51], v242 offset:45568
    ds_read_b64_tr_b16 v[52:53], v248 offset:45056
    ds_read_b64_tr_b16 v[54:55], v248 offset:45568
    s_add_u32 m0, s55, 0x12000
    s_add_u32 s50, s50, 86016
    buffer_load_dwordx4 v4, s[8:11], s50 offen lds
    s_add_u32 s48, s48, 1
    s_cmp_eq_u32 s48, 7
    s_cselect_b32 s48, 0, s48
    s_waitcnt lgkmcnt(8)
    v_mfma_f32_32x32x16_bf16 v[96:111], v[32:35], v[208:211], v[96:111]
    v_mfma_f32_32x32x16_bf16 v[64:79], v[36:39], v[208:211], v[64:79]
    ds_read_b64_tr_b16 v[56:57], v242 offset:47104
    ds_read_b64_tr_b16 v[58:59], v242 offset:47616
    ds_read_b64_tr_b16 v[60:61], v248 offset:47104
    ds_read_b64_tr_b16 v[62:63], v248 offset:47616
    s_waitcnt lgkmcnt(8)
    v_mfma_f32_32x32x16_bf16 v[96:111], v[40:43], v[212:215], v[96:111]
    v_mfma_f32_32x32x16_bf16 v[64:79], v[44:47], v[212:215], v[64:79]
    ds_read_b64_tr_b16 v[32:33], v242 offset:49152
    ds_read_b64_tr_b16 v[34:35], v242 offset:49664
    ds_read_b64_tr_b16 v[36:37], v248 offset:49152
    ds_read_b64_tr_b16 v[38:39], v248 offset:49664
    s_mul_i32 s50, s48, 172032
    s_add_u32 s50, s50, s56
    s_add_u32 m0, s55, 0x13000
    s_nop 0
    buffer_load_dwordx4 v4, s[8:11], s50 offen lds
    s_waitcnt lgkmcnt(8)
    v_mfma_f32_32x32x16_bf16 v[96:111], v[48:51], v[216:219], v[96:111]
    v_mfma_f32_32x32x16_bf16 v[64:79], v[52:55], v[216:219], v[64:79]
    ds_read_b64_tr_b16 v[40:41], v242 offset:51200
    ds_read_b64_tr_b16 v[42:43], v242 offset:51712
    ds_read_b64_tr_b16 v[44:45], v248 offset:51200
    ds_read_b64_tr_b16 v[46:47], v248 offset:51712
    s_waitcnt lgkmcnt(8)
    v_mfma_f32_32x32x16_bf16 v[96:111], v[56:59], v[220:223], v[96:111]
    v_mfma_f32_32x32x16_bf16 v[64:79], v[60:63], v[220:223], v[64:79]
    ds_read_b64_tr_b16 v[48:49], v242 offset:53248
    ds_read_b64_tr_b16 v[50:51], v242 offset:53760
    ds_read_b64_tr_b16 v[52:53], v248 offset:53248
    ds_read_b64_tr_b16 v[54:55], v248 offset:53760
    s_add_u32 m0, s55, 0x14000
    s_add_u32 s50, s50, 86016
    buffer_load_dwordx4 v4, s[8:11], s50 offen lds
    s_add_u32 s48, s48, 1
    s_cmp_eq_u32 s48, 7
    s_cselect_b32 s48, 0, s48
    s_waitcnt lgkmcnt(8)
    v_mfma_f32_32x32x16_bf16 v[96:111], v[32:35], v[224:227], v[96:111]
    v_mfma_f32_32x32x16_bf16 v[64:79], v[36:39], v[224:227], v[64:79]
    ds_read_b64_tr_b16 v[56:57], v242 offset:55296
    ds_read_b64_tr_b16 v[58:59], v242 offset:55808
    ds_read_b64_tr_b16 v[60:61], v248 offset:55296
    ds_read_b64_tr_b16 v[62:63], v248 offset:55808
    s_waitcnt lgkmcnt(8)
    v_mfma_f32_32x32x16_bf16 v[96:111], v[40:43], v[228:231], v[96:111]
    v_mfma_f32_32x32x16_bf16 v[64:79], v[44:47], v[228:231], v[64:79]
    s_mul_i32 s50, s48, 172032
    s_add_u32 s50, s50, s56
    s_add_u32 m0, s55, 0x15000
    s_nop 0
    buffer_load_dwordx4 v4, s[8:11], s50 offen lds
    s_waitcnt lgkmcnt(4)
    v_mfma_f32_32x32x16_bf16 v[96:111], v[48:51], v[232:235], v[96:111]
    v_mfma_f32_32x32x16_bf16 v[64:79], v[52:55], v[232:235], v[64:79]
    s_waitcnt lgkmcnt(0)
    v_mfma_f32_32x32x16_bf16 v[96:111], v[56:59], v[236:239], v[96:111]
    v_mfma_f32_32x32x16_bf16 v[64:79], v[60:63], v[236:239], v[64:79]
    s_add_u32 m0, s55, 0x16000
    s_add_u32 s50, s50, 86016
    buffer_load_dwordx4 v4, s[8:11], s50 offen lds
    s_add_u32 s48, s48, 1
    s_cmp_eq_u32 s48, 7
    s_cselect_b32 s48, 0, s48
    v_subrev_u32 v242, 49152, v242
    v_subrev_u32 v248, 49152, v248
    s_nop 3
    v_mov_b32 v30, v76
    v_mov_b32 v31, v76
    v_cvt_pk_bf16_f32 v96, v96, v97
    v_cvt_pk_bf16_f32 v97, v98, v99
    v_cvt_pk_bf16_f32 v98, v100, v101
    v_cvt_pk_bf16_f32 v99, v102, v103
    v_cvt_pk_bf16_f32 v100, v104, v105
    v_cvt_pk_bf16_f32 v101, v106, v107
    v_cvt_pk_bf16_f32 v102, v108, v109
    v_cvt_pk_bf16_f32 v103, v110, v111
    v_cvt_pk_bf16_f32 v64, v64, v65
    v_cvt_pk_bf16_f32 v65, v66, v67
    v_cvt_pk_bf16_f32 v66, v68, v69
    v_cvt_pk_bf16_f32 v67, v70, v71
    v_cvt_pk_bf16_f32 v68, v72, v73
    v_cvt_pk_bf16_f32 v69, v74, v75
    v_cvt_pk_bf16_f32 v70, v76, v77
    v_cvt_pk_bf16_f32 v71, v78, v79
    v_permlane32_swap_b32 v31, v30
    s_mov_b32 exec_lo, 0
    v_mov_b32 v102, 0x3f80
    v_mov_b32 v103, 0
    v_mov_b32 v70, 0x3f80
    v_mov_b32 v71, 0
    s_mov_b32 exec_lo, -1
    ds_write_b64 v252, v[96:97] offset:128
    ds_write_b64 v252, v[98:99] offset:144
    ds_write_b64 v252, v[100:101] offset:160
    ds_write_b64 v252, v[102:103] offset:176
    ds_write_b64 v252, v[64:65] offset:25728
    ds_write_b64 v252, v[66:67] offset:25744
    ds_write_b64 v252, v[68:69] offset:25760
    ds_write_b64 v252, v[70:71] offset:25776
    s_mul_i32 s50, s48, 172032
    s_add_u32 s50, s50, s56
    s_add_u32 m0, s55, 0x17000
    s_nop 0
    buffer_load_dwordx4 v4, s[8:11], s50 offen lds
    s_add_u32 m0, s55, 0x18000
    s_add_u32 s50, s50, 86016
    buffer_load_dwordx4 v4, s[8:11], s50 offen lds
    s_add_u32 s48, s48, 1
    s_cmp_eq_u32 s48, 7
    s_cselect_b32 s48, 0, s48
    s_setprio 0
attn_k1:
    s_waitcnt lgkmcnt(0)
    s_barrier
    ds_read_b64_tr_b16 v[32:33], v254 offset:0
    ds_read_b64_tr_b16 v[34:35], v254 offset:200
    ds_read_b64_tr_b16 v[48:49], v253 offset:128
    ds_read_b64_tr_b16 v[50:51], v253 offset:328
    ds_read_b64_tr_b16 v[52:53], v253 offset:160
    ds_read_b64_tr_b16 v[54:55], v253 offset:360
    ds_read_b64_tr_b16 v[36:37], v254 offset:6400
    ds_read_b64_tr_b16 v[38:39], v254 offset:6600
    ds_read_b64_tr_b16 v[56:57], v253 offset:6528
    ds_read_b64_tr_b16 v[58:59], v253 offset:6728
    ds_read_b64_tr_b16 v[60:61], v253 offset:6560
    ds_read_b64_tr_b16 v[62:63], v253 offset:6760
    ds_read_b64_tr_b16 v[40:41], v254 offset:12800
    ds_read_b64_tr_b16 v[42:43], v254 offset:13000
    ds_read_b64_tr_b16 v[64:65], v253 offset:12928
    ds_read_b64_tr_b16 v[66:67], v253 offset:13128
    ds_read_b64_tr_b16 v[68:69], v253 offset:12960
    ds_read_b64_tr_b16 v[70:71], v253 offset:13160
    ds_read_b64_tr_b16 v[44:45], v254 offset:19200
    ds_read_b64_tr_b16 v[46:47], v254 offset:19400
    ds_read_b64_tr_b16 v[72:73], v253 offset:19328
    ds_read_b64_tr_b16 v[74:75], v253 offset:19528
    ds_read_b64_tr_b16 v[76:77], v253 offset:19360
    ds_read_b64_tr_b16 v[78:79], v253 offset:19560
    s_mov_b32 s62, 0x7060500
    s_mov_b32 s63, 0x7060501
    s_mov_b32 s64, 0x7060502
    s_mov_b32 s65, 0x7060503
    s_waitcnt lgkmcnt(15)
    v_mfma_f32_16x16x32_bf16 v[80:83], v[32:35], v[48:51], 0
    v_mfma_f32_16x16x32_bf16 v[84:87], v[32:35], v[52:55], 0
    s_waitcnt lgkmcnt(12)
    v_mfma_f32_16x16x32_bf16 v[80:83], v[36:39], v[56:59], v[80:83]
    v_mfma_f32_16x16x32_bf16 v[84:87], v[36:39], v[60:63], v[84:87]
    s_waitcnt lgkmcnt(6)
    v_mfma_f32_16x16x32_bf16 v[80:83], v[40:43], v[64:67], v[80:83]
    v_mfma_f32_16x16x32_bf16 v[84:87], v[40:43], v[68:71], v[84:87]
    s_waitcnt lgkmcnt(0)
    v_mfma_f32_16x16x32_bf16 v[80:83], v[44:47], v[72:75], v[80:83]
    v_mfma_f32_16x16x32_bf16 v[84:87], v[44:47], v[76:79], v[84:87]
    s_cmp_ge_u32 s47, 4
    s_cbranch_scc1 attn_q
    s_nop 4
    v_perm_b32 v80, v80, v11, s62
    v_perm_b32 v81, v81, v11, s63
    v_perm_b32 v82, v82, v11, s64
    v_perm_b32 v83, v83, v11, s65
    buffer_store_dwordx4 v[80:83], v255, s[12:15], s60 offen offset:0 sc1
    v_perm_b32 v84, v84, v11, s62
    v_perm_b32 v85, v85, v11, s63
    v_perm_b32 v86, v86, v11, s64
    v_perm_b32 v87, v87, v11, s65
    buffer_store_dwordx4 v[84:87], v255, s[12:15], s60 offen offset:256 sc1
    s_barrier
    s_add_u32 m0, s61, 0x4000
    s_bfe_u32 s50, s46, 0x40000
    s_mul_i32 s50, s50, 28672
    s_add_u32 s50, s50, s0
    buffer_load_dwordx4 v243, s[24:27], s50 offen lds
    buffer_load_dwordx4 v251, s[24:27], s50 offen offset:1024 lds
    s_add_u32 m0, s61, 0x4800
    s_add_u32 s50, s50, 14336
    buffer_load_dwordx4 v243, s[24:27], s50 offen lds
    buffer_load_dwordx4 v251, s[24:27], s50 offen offset:1024 lds
    s_add_u32 m0, s61, 0x8000
    s_bfe_u32 s50, s46, 0x40004
    s_mul_i32 s50, s50, 28672
    s_add_u32 s50, s50, s0
    buffer_load_dwordx4 v243, s[24:27], s50 offen lds
    buffer_load_dwordx4 v251, s[24:27], s50 offen offset:1024 lds
    s_add_u32 m0, s61, 0x8800
    s_add_u32 s50, s50, 14336
    buffer_load_dwordx4 v243, s[24:27], s50 offen lds
    buffer_load_dwordx4 v251, s[24:27], s50 offen offset:1024 lds
    s_add_u32 m0, s61, 0x1c000
    s_bfe_u32 s50, s46, 0x40018
    s_mul_i32 s50, s50, 28672
    s_add_u32 s50, s50, s0
    buffer_load_dwordx4 v243, s[24:27], s50 offen lds
    buffer_load_dwordx4 v251, s[24:27], s50 offen offset:1024 lds
    s_add_u32 m0, s61, 0x1c800
    s_add_u32 s50, s50, 14336
    buffer_load_dwordx4 v243, s[24:27], s50 offen lds
    buffer_load_dwordx4 v251, s[24:27], s50 offen offset:1024 lds
    buffer_load_dwordx4 v[32:35], v241, s[12:15], s22 offen sc1
    s_add_u32 s16, s22, 4096
    buffer_load_dwordx4 v[36:39], v241, s[12:15], s16 offen sc1
    s_add_u32 s16, s22, 8192
    buffer_load_dwordx4 v[40:43], v241, s[12:15], s16 offen sc1
    s_add_u32 s16, s22, 12288
    buffer_load_dwordx4 v[44:47], v241, s[12:15], s16 offen sc1
    s_add_u32 m0, s61, 0x20000
    s_and_b32 s50, s2, 1
    s_lshl_b32 s50, s50, 2
    s_and_b32 s49, s47, 3
    s_add_u32 s50, s50, s49
    s_mul_i32 s50, s50, 150528
    s_sub_u32 s50, s0, s50
    buffer_load_dwordx4 v243, s[28:31], s50 offen lds
    buffer_load_dwordx4 v251, s[28:31], s50 offen offset:1024 lds
    s_add_u32 m0, s61, 0x20800
    s_add_u32 s50, s50, 14336
    buffer_load_dwordx4 v243, s[28:31], s50 offen lds
    buffer_load_dwordx4 v251, s[28:31], s50 offen offset:1024 lds
    s_lshl_b32 s62, s45, 4
    s_add_u32 s63, s62, s44
    s_lshl_b32 s63, s63, 10
    s_lshl_b32 s64, s47, 8
    s_add_u32 s63, s63, s64
    s_add_u32 s63, s63, 0xf00000
    v_lshrrev_b32 v16, 4, v1
    v_lshlrev_b32 v17, 3, v16
    v_lshrrev_b32 v17, v17, v11
    v_and_b32 v18, 15, v1
    v_lshlrev_b32 v18, 4, v18
    v_lshl_add_u32 v18, v16, 2, v18
    s_mov_b32 s62, 255
    s_waitcnt vmcnt(4)
    v_perm_b32 v12, v33, v32, s20
    v_perm_b32 v13, v35, v34, s21
    v_bitop3_b32 v14, v12, v13, v11 bitop3:0x56
    v_perm_b32 v12, v37, v36, s20
    v_perm_b32 v13, v39, v38, s21
    v_bitop3_b32 v12, v12, v13, v11 bitop3:0x56
    v_or_b32 v14, v14, v12
    v_perm_b32 v12, v41, v40, s20
    v_perm_b32 v13, v43, v42, s21
    v_bitop3_b32 v12, v12, v13, v11 bitop3:0x56
    v_or_b32 v14, v14, v12
    v_perm_b32 v12, v45, v44, s20
    v_perm_b32 v13, v47, v46, s21
    v_bitop3_b32 v12, v12, v13, v11 bitop3:0x56
    v_or_b32 v14, v14, v12
    v_cmp_eq_u32 vcc, 0, v14
    s_nop 3
    s_cmp_eq_u64 vcc, exec
    s_cbranch_scc1 pd_29
    s_mov_b32 s3, 200000
pl_30:
    s_sleep 1
    buffer_load_dwordx4 v[32:35], v241, s[12:15], s22 offen sc1
    s_add_u32 s16, s22, 4096
    buffer_load_dwordx4 v[36:39], v241, s[12:15], s16 offen sc1
    s_add_u32 s16, s22, 8192
    buffer_load_dwordx4 v[40:43], v241, s[12:15], s16 offen sc1
    s_add_u32 s16, s22, 12288
    buffer_load_dwordx4 v[44:47], v241, s[12:15], s16 offen sc1
    s_waitcnt vmcnt(0)
    v_perm_b32 v12, v33, v32, s20
    v_perm_b32 v13, v35, v34, s21
    v_bitop3_b32 v14, v12, v13, v11 bitop3:0x56
    v_perm_b32 v12, v37, v36, s20
    v_perm_b32 v13, v39, v38, s21
    v_bitop3_b32 v12, v12, v13, v11 bitop3:0x56
    v_or_b32 v14, v14, v12
    v_perm_b32 v12, v41, v40, s20
    v_perm_b32 v13, v43, v42, s21
    v_bitop3_b32 v12, v12, v13, v11 bitop3:0x56
    v_or_b32 v14, v14, v12
    v_perm_b32 v12, v45, v44, s20
    v_perm_b32 v13, v47, v46, s21
    v_bitop3_b32 v12, v12, v13, v11 bitop3:0x56
    v_or_b32 v14, v14, v12
    v_cmp_eq_u32 vcc, 0, v14
    s_nop 3
    s_cmp_eq_u64 vcc, exec
    s_cbranch_scc1 pd_29
    s_sub_u32 s3, s3, 1
    s_cbranch_scc0 pl_30
pd_29:
    v_add_f32 v32, v32, v36
    v_add_f32 v40, v40, v44
    v_add_f32 v33, v33, v37
    v_add_f32 v41, v41, v45
    v_add_f32 v34, v34, v38
    v_add_f32 v42, v42, v46
    v_add_f32 v35, v35, v39
    v_add_f32 v43, v43, v47
    v_add_f32 v32, v32, v40
    v_add_f32 v33, v33, v41
    v_add_f32 v34, v34, v42
    v_add_f32 v35, v35, v43
    v_permlane16_swap_b32 v32, v33
    s_nop 0
    v_permlane16_swap_b32 v34, v35
    v_add_f32 v32, v32, v33
    v_add_f32 v34, v34, v35
    s_nop 1
    v_permlane32_swap_b32 v32, v34
    v_add_f32 v32, v32, v34
    v_bfi_b32 v32, s62, v17, v32
    buffer_store_dword v32, v18, s[12:15], s63 offen sc1
    s_add_u32 m0, s61, 0x24000
    s_and_b32 s50, s2, 1
    s_lshl_b32 s50, s50, 2
    s_and_b32 s49, s47, 3
    s_add_u32 s50, s50, s49
    s_mul_i32 s50, s50, 150528
    s_sub_u32 s50, s0, s50
    s_add_u32 s50, s50, 25088
    buffer_load_dwordx4 v243, s[28:31], s50 offen lds
    buffer_load_dwordx4 v251, s[28:31], s50 offen offset:1024 lds
    s_add_u32 m0, s61, 0x24800
    s_add_u32 s50, s50, 14336
    buffer_load_dwordx4 v243, s[28:31], s50 offen lds
    buffer_load_dwordx4 v251, s[28:31], s50 offen offset:1024 lds
    s_barrier
    s_add_u32 m0, s61, 0xc000
    s_bfe_u32 s50, s46, 0x40008
    s_mul_i32 s50, s50, 28672
    s_add_u32 s50, s50, s0
    buffer_load_dwordx4 v243, s[24:27], s50 offen lds
    buffer_load_dwordx4 v251, s[24:27], s50 offen offset:1024 lds
    s_add_u32 m0, s61, 0xc800
    s_add_u32 s50, s50, 14336
    buffer_load_dwordx4 v243, s[24:27], s50 offen lds
    buffer_load_dwordx4 v251, s[24:27], s50 offen offset:1024 lds
    s_add_u32 m0, s61, 0x10000
    s_bfe_u32 s50, s46, 0x4000c
    s_mul_i32 s50, s50, 28672
    s_add_u32 s50, s50, s0
    buffer_load_dwordx4 v243, s[24:27], s50 offen lds
    buffer_load_dwordx4 v251, s[24:27], s50 offen offset:1024 lds
    s_add_u32 m0, s61, 0x10800
    s_add_u32 s50, s50, 14336
    buffer_load_dwordx4 v243, s[24:27], s50 offen lds
    buffer_load_dwordx4 v251, s[24:27], s50 offen offset:1024 lds
    s_add_u32 m0, s61, 0x14000
    s_bfe_u32 s50, s46, 0x40010
    s_mul_i32 s50, s50, 28672
    s_add_u32 s50, s50, s0
    buffer_load_dwordx4 v243, s[24:27], s50 offen lds
    buffer_load_dwordx4 v251, s[24:27], s50 offen offset:1024 lds
    s_add_u32 m0, s61, 0x14800
    s_add_u32 s50, s50, 14336
    buffer_load_dwordx4 v243, s[24:27], s50 offen lds
    buffer_load_dwordx4 v251, s[24:27], s50 offen offset:1024 lds
    s_add_u32 m0, s61, 0x18000
    s_bfe_u32 s50, s46, 0x40014
    s_mul_i32 s50, s50, 28672
    s_add_u32 s50, s50, s0
    buffer_load_dwordx4 v243, s[24:27], s50 offen lds
    buffer_load_dwordx4 v251, s[24:27], s50 offen offset:1024 lds
    s_add_u32 m0, s61, 0x18800
    s_add_u32 s50, s50, 14336
    buffer_load_dwordx4 v243, s[24:27], s50 offen lds
    buffer_load_dwordx4 v251, s[24:27], s50 offen offset:1024 lds
    s_and_b32 s64, s2, 1
    s_lshl_b32 s64, s64, 2
    s_and_b32 s62, s47, 3
    s_add_u32 s64, s64, s62
    s_lshl_b32 s64, s64, 7
    s_add_u32 s7, s64, 0x1500000
    s_bfe_u32 s62, s53, 0x60002
    s_lshl_b32 s62, s62, 10
    s_bfe_u32 s63, s53, 0x20000
    s_lshl_b32 s63, s63, 2
    s_add_u32 s62, s62, s63
    v_mov_b32 v2, s62
    s_bfe_u32 s62, s53, 0x6000a
    s_lshl_b32 s62, s62, 10
    s_bfe_u32 s63, s53, 0x20008
    s_lshl_b32 s63, s63, 2
    s_add_u32 s62, s62, s63
    s_mov_b32 exec_lo, 0xaaaaaaaa
    s_mov_b32 exec_hi, 0xaaaaaaaa
    v_mov_b32 v2, s62
    s_mov_b32 exec_lo, 0
    s_mov_b32 exec_hi, -1
    v_add_u32 v2, 16, v2
    s_mov_b32 exec_lo, -1
    buffer_load_dword v10, v2, s[12:15], s7 offen sc1
    s_mov_b32 s67, 2
    s_branch phase2
attn_q:
    s_setprio 2
    s_nop 11
    v_perm_b32 v80, v80, v11, s62
    v_perm_b32 v81, v81, v11, s63
    v_perm_b32 v82, v82, v11, s64
    v_perm_b32 v83, v83, v11, s65
    buffer_store_dwordx4 v[80:83], v255, s[12:15], s60 offen offset:0 sc1
    v_perm_b32 v84, v84, v11, s62
    v_perm_b32 v85, v85, v11, s63
    v_perm_b32 v86, v86, v11, s64
    v_perm_b32 v87, v87, v11, s65
    buffer_store_dwordx4 v[84:87], v255, s[12:15], s60 offen offset:256 sc1
    s_barrier
    s_mul_i32 s50, s48, 172032
    s_add_u32 s50, s50, s56
    s_add_u32 m0, s55, 0x19000
    s_nop 0
    buffer_load_dwordx4 v4, s[8:11], s50 offen lds
    s_add_u32 m0, s55, 0x1a000
    s_add_u32 s50, s50, 86016
    buffer_load_dwordx4 v4, s[8:11], s50 offen lds
    s_add_u32 s48, s48, 1
    s_cmp_eq_u32 s48, 7
    s_cselect_b32 s48, 0, s48
    v_and_b32 v240, 31, v1
    v_lshlrev_b32 v240, 2, v240
    buffer_load_dword v240, v240, s[12:15], s66 offen sc1
    s_waitcnt vmcnt(7)
    s_lshl_b64 exec, 1, s47
    ds_write_b32 v9, v11 offset:51232
    s_mov_b64 exec, -1
    s_mov_b32 s3, 2000000
gs_31:
    ds_read_b32 v249, v9 offset:51232
    s_waitcnt lgkmcnt(0)
    v_cmp_eq_u32 vcc, v11, v249
    s_nop 3
    s_cmp_eq_u64 vcc, exec
    s_cbranch_scc1 gs_32
    s_sub_u32 s3, s3, 1
    s_cbranch_scc0 gs_31
gs_32:
    ds_read_b64_tr_b16 v[32:33], v242 offset:0
    ds_read_b64_tr_b16 v[34:35], v242 offset:512
    ds_read_b64_tr_b16 v[36:37], v248 offset:0
    ds_read_b64_tr_b16 v[38:39], v248 offset:512
    ds_read_b64_tr_b16 v[40:41], v242 offset:2048
    ds_read_b64_tr_b16 v[42:43], v242 offset:2560
    ds_read_b64_tr_b16 v[44:45], v248 offset:2048
    ds_read_b64_tr_b16 v[46:47], v248 offset:2560
    ds_read_b64_tr_b16 v[48:49], v242 offset:4096
    ds_read_b64_tr_b16 v[50:51], v242 offset:4608
    ds_read_b64_tr_b16 v[52:53], v248 offset:4096
    ds_read_b64_tr_b16 v[54:55], v248 offset:4608
    s_waitcnt lgkmcnt(8)
    v_mfma_f32_32x32x16_bf16 v[96:111], v[32:35], v[128:131], 0
    v_mfma_f32_32x32x16_bf16 v[64:79], v[36:39], v[128:131], 0
    ds_read_b64_tr_b16 v[56:57], v242 offset:6144
    ds_read_b64_tr_b16 v[58:59], v242 offset:6656
    ds_read_b64_tr_b16 v[60:61], v248 offset:6144
    ds_read_b64_tr_b16 v[62:63], v248 offset:6656
    s_waitcnt lgkmcnt(8)
    v_mfma_f32_32x32x16_bf16 v[96:111], v[40:43], v[132:135], v[96:111]
    v_mfma_f32_32x32x16_bf16 v[64:79], v[44:47], v[132:135], v[64:79]
    ds_read_b64_tr_b16 v[32:33], v242 offset:8192
    ds_read_b64_tr_b16 v[34:35], v242 offset:8704
    ds_read_b64_tr_b16 v[36:37], v248 offset:8192
    ds_read_b64_tr_b16 v[38:39], v248 offset:8704
    s_waitcnt lgkmcnt(8)
    v_mfma_f32_32x32x16_bf16 v[96:111], v[48:51], v[136:139], v[96:111]
    v_mfma_f32_32x32x16_bf16 v[64:79], v[52:55], v[136:139], v[64:79]
    ds_read_b64_tr_b16 v[40:41], v242 offset:10240
    ds_read_b64_tr_b16 v[42:43], v242 offset:10752
    ds_read_b64_tr_b16 v[44:45], v248 offset:10240
    ds_read_b64_tr_b16 v[46:47], v248 offset:10752
    s_waitcnt lgkmcnt(8)
    v_mfma_f32_32x32x16_bf16 v[96:111], v[56:59], v[140:143], v[96:111]
    v_mfma_f32_32x32x16_bf16 v[64:79], v[60:63], v[140:143], v[64:79]
    ds_read_b64_tr_b16 v[48:49], v242 offset:12288
    ds_read_b64_tr_b16 v[50:51], v242 offset:12800
    ds_read_b64_tr_b16 v[52:53], v248 offset:12288
    ds_read_b64_tr_b16 v[54:55], v248 offset:12800
    s_waitcnt lgkmcnt(8)
    v_mfma_f32_32x32x16_bf16 v[96:111], v[32:35], v[144:147], v[96:111]
    v_mfma_f32_32x32x16_bf16 v[64:79], v[36:39], v[144:147], v[64:79]
    ds_read_b64_tr_b16 v[56:57], v242 offset:14336
    ds_read_b64_tr_b16 v[58:59], v242 offset:14848
    ds_read_b64_tr_b16 v[60:61], v248 offset:14336
    ds_read_b64_tr_b16 v[62:63], v248 offset:14848
    s_waitcnt lgkmcnt(8)
    v_mfma_f32_32x32x16_bf16 v[96:111], v[40:43], v[148:151], v[96:111]
    v_mfma_f32_32x32x16_bf16 v[64:79], v[44:47], v[148:151], v[64:79]
    ds_read_b64_tr_b16 v[32:33], v242 offset:16384
    ds_read_b64_tr_b16 v[34:35], v242 offset:16896
    ds_read_b64_tr_b16 v[36:37], v248 offset:16384
    ds_read_b64_tr_b16 v[38:39], v248 offset:16896
    s_waitcnt lgkmcnt(8)
    v_mfma_f32_32x32x16_bf16 v[96:111], v[48:51], v[152:155], v[96:111]
    v_mfma_f32_32x32x16_bf16 v[64:79], v[52:55], v[152:155], v[64:79]
    ds_read_b64_tr_b16 v[40:41], v242 offset:18432
    ds_read_b64_tr_b16 v[42:43], v242 offset:18944
    ds_read_b64_tr_b16 v[44:45], v248 offset:18432
    ds_read_b64_tr_b16 v[46:47], v248 offset:18944
    s_waitcnt lgkmcnt(8)
    v_mfma_f32_32x32x16_bf16 v[96:111], v[56:59], v[156:159], v[96:111]
    v_mfma_f32_32x32x16_bf16 v[64:79], v[60:63], v[156:159], v[64:79]
    ds_read_b64_tr_b16 v[48:49], v242 offset:20480
    ds_read_b64_tr_b16 v[50:51], v242 offset:20992
    ds_read_b64_tr_b16 v[52:53], v248 offset:20480
    ds_read_b64_tr_b16 v[54:55], v248 offset:20992
    s_waitcnt lgkmcnt(8)
    v_mfma_f32_32x32x16_bf16 v[96:111], v[32:35], v[160:163], v[96:111]
    v_mfma_f32_32x32x16_bf16 v[64:79], v[36:39], v[160:163], v[64:79]
    ds_read_b64_tr_b16 v[56:57], v242 offset:22528
    ds_read_b64_tr_b16 v[58:59], v242 offset:23040
    ds_read_b64_tr_b16 v[60:61], v248 offset:22528
    ds_read_b64_tr_b16 v[62:63], v248 offset:23040
    s_waitcnt lgkmcnt(8)
    v_mfma_f32_32x32x16_bf16 v[96:111], v[40:43], v[164:167], v[96:111]
    v_mfma_f32_32x32x16_bf16 v[64:79], v[44:47], v[164:167], v[64:79]
    ds_read_b64_tr_b16 v[32:33], v242 offset:24576
    ds_read_b64_tr_b16 v[34:35], v242 offset:25088
    ds_read_b64_tr_b16 v[36:37], v248 offset:24576
    ds_read_b64_tr_b16 v[38:39], v248 offset:25088
    s_waitcnt lgkmcnt(8)
    v_mfma_f32_32x32x16_bf16 v[96:111], v[48:51], v[168:171], v[96:111]
    v_mfma_f32_32x32x16_bf16 v[64:79], v[52:55], v[168:171], v[64:79]
    ds_read_b64_tr_b16 v[40:41], v242 offset:26624
    ds_read_b64_tr_b16 v[42:43], v242 offset:27136
    ds_read_b64_tr_b16 v[44:45], v248 offset:26624
    ds_read_b64_tr_b16 v[46:47], v248 offset:27136
    s_waitcnt lgkmcnt(8)
    v_mfma_f32_32x32x16_bf16 v[96:111], v[56:59], v[172:175], v[96:111]
    v_mfma_f32_32x32x16_bf16 v[64:79], v[60:63], v[172:175], v[64:79]
    ds_read_b64_tr_b16 v[48:49], v242 offset:28672
    ds_read_b64_tr_b16 v[50:51], v242 offset:29184
    ds_read_b64_tr_b16 v[52:53], v248 offset:28672
    ds_read_b64_tr_b16 v[54:55], v248 offset:29184
    s_waitcnt lgkmcnt(8)
    v_mfma_f32_32x32x16_bf16 v[96:111], v[32:35], v[176:179], v[96:111]
    v_mfma_f32_32x32x16_bf16 v[64:79], v[36:39], v[176:179], v[64:79]
    ds_read_b64_tr_b16 v[56:57], v242 offset:30720
    ds_read_b64_tr_b16 v[58:59], v242 offset:31232
    ds_read_b64_tr_b16 v[60:61], v248 offset:30720
    ds_read_b64_tr_b16 v[62:63], v248 offset:31232
    s_waitcnt lgkmcnt(8)
    v_mfma_f32_32x32x16_bf16 v[96:111], v[40:43], v[180:183], v[96:111]
    v_mfma_f32_32x32x16_bf16 v[64:79], v[44:47], v[180:183], v[64:79]
    ds_read_b64_tr_b16 v[32:33], v242 offset:32768
    ds_read_b64_tr_b16 v[34:35], v242 offset:33280
    ds_read_b64_tr_b16 v[36:37], v248 offset:32768
    ds_read_b64_tr_b16 v[38:39], v248 offset:33280
    s_waitcnt lgkmcnt(8)
    v_mfma_f32_32x32x16_bf16 v[96:111], v[48:51], v[184:187], v[96:111]
    v_mfma_f32_32x32x16_bf16 v[64:79], v[52:55], v[184:187], v[64:79]
    ds_read_b64_tr_b16 v[40:41], v242 offset:34816
    ds_read_b64_tr_b16 v[42:43], v242 offset:35328
    ds_read_b64_tr_b16 v[44:45], v248 offset:34816
    ds_read_b64_tr_b16 v[46:47], v248 offset:35328
    s_waitcnt lgkmcnt(8)
    v_mfma_f32_32x32x16_bf16 v[96:111], v[56:59], v[188:191], v[96:111]
    v_mfma_f32_32x32x16_bf16 v[64:79], v[60:63], v[188:191], v[64:79]
    ds_read_b64_tr_b16 v[48:49], v242 offset:36864
    ds_read_b64_tr_b16 v[50:51], v242 offset:37376
    ds_read_b64_tr_b16 v[52:53], v248 offset:36864
    ds_read_b64_tr_b16 v[54:55], v248 offset:37376
    s_waitcnt lgkmcnt(8)
    v_mfma_f32_32x32x16_bf16 v[96:111], v[32:35], v[192:195], v[96:111]
    v_mfma_f32_32x32x16_bf16 v[64:79], v[36:39], v[192:195], v[64:79]
    ds_read_b64_tr_b16 v[56:57], v242 offset:38912
    ds_read_b64_tr_b16 v[58:59], v242 offset:39424
    ds_read_b64_tr_b16 v[60:61], v248 offset:38912
    ds_read_b64_tr_b16 v[62:63], v248 offset:39424
    s_waitcnt lgkmcnt(8)
    v_mfma_f32_32x32x16_bf16 v[96:111], v[40:43], v[196:199], v[96:111]
    v_mfma_f32_32x32x16_bf16 v[64:79], v[44:47], v[196:199], v[64:79]
    s_waitcnt vmcnt(1)
    s_lshl_b64 exec, 1, s47
    ds_write_b32 v9, v11 offset:51248
    s_mov_b64 exec, -1
    s_mov_b32 s3, 2000000
gs_33:
    ds_read_b32 v249, v9 offset:51248
    s_waitcnt lgkmcnt(0)
    v_cmp_eq_u32 vcc, v11, v249
    s_nop 3
    s_cmp_eq_u64 vcc, exec
    s_cbranch_scc1 gs_34
    s_sub_u32 s3, s3, 1
    s_cbranch_scc0 gs_33
gs_34:
    ds_read_b64_tr_b16 v[32:33], v242 offset:40960
    ds_read_b64_tr_b16 v[34:35], v242 offset:41472
    ds_read_b64_tr_b16 v[36:37], v248 offset:40960
    ds_read_b64_tr_b16 v[38:39], v248 offset:41472
    s_waitcnt lgkmcnt(8)
    v_mfma_f32_32x32x16_bf16 v[96:111], v[48:51], v[200:203], v[96:111]
    v_mfma_f32_32x32x16_bf16 v[64:79], v[52:55], v[200:203], v[64:79]
    ds_read_b64_tr_b16 v[40:41], v242 offset:43008
    ds_read_b64_tr_b16 v[42:43], v242 offset:43520
    ds_read_b64_tr_b16 v[44:45], v248 offset:43008
    ds_read_b64_tr_b16 v[46:47], v248 offset:43520
    s_waitcnt lgkmcnt(8)
    v_mfma_f32_32x32x16_bf16 v[96:111], v[56:59], v[204:207], v[96:111]
    v_mfma_f32_32x32x16_bf16 v[64:79], v[60:63], v[204:207], v[64:79]
    ds_read_b64_tr_b16 v[48:49], v242 offset:45056
    ds_read_b64_tr_b16 v[50:51], v242 offset:45568
    ds_read_b64_tr_b16 v[52:53], v248 offset:45056
    ds_read_b64_tr_b16 v[54:55], v248 offset:45568
    s_waitcnt lgkmcnt(8)
    v_mfma_f32_32x32x16_bf16 v[96:111], v[32:35], v[208:211], v[96:111]
    v_mfma_f32_32x32x16_bf16 v[64:79], v[36:39], v[208:211], v[64:79]
    ds_read_b64_tr_b16 v[56:57], v242 offset:47104
    ds_read_b64_tr_b16 v[58:59], v242 offset:47616
    ds_read_b64_tr_b16 v[60:61], v248 offset:47104
    ds_read_b64_tr_b16 v[62:63], v248 offset:47616
    s_waitcnt lgkmcnt(8)
    v_mfma_f32_32x32x16_bf16 v[96:111], v[40:43], v[212:215], v[96:111]
    v_mfma_f32_32x32x16_bf16 v[64:79], v[44:47], v[212:215], v[64:79]
    ds_read_b64_tr_b16 v[32:33], v242 offset:49152
    ds_read_b64_tr_b16 v[34:35], v242 offset:49664
    ds_read_b64_tr_b16 v[36:37], v248 offset:49152
    ds_read_b64_tr_b16 v[38:39], v248 offset:49664
    s_waitcnt lgkmcnt(8)
    v_mfma_f32_32x32x16_bf16 v[96:111], v[48:51], v[216:219], v[96:111]
    v_mfma_f32_32x32x16_bf16 v[64:79], v[52:55], v[216:219], v[64:79]
    ds_read_b64_tr_b16 v[40:41], v242 offset:51200
    ds_read_b64_tr_b16 v[42:43], v242 offset:51712
    ds_read_b64_tr_b16 v[44:45], v248 offset:51200
    ds_read_b64_tr_b16 v[46:47], v248 offset:51712
    s_waitcnt lgkmcnt(8)
    v_mfma_f32_32x32x16_bf16 v[96:111], v[56:59], v[220:223], v[96:111]
    v_mfma_f32_32x32x16_bf16 v[64:79], v[60:63], v[220:223], v[64:79]
    ds_read_b64_tr_b16 v[48:49], v242 offset:53248
    ds_read_b64_tr_b16 v[50:51], v242 offset:53760
    ds_read_b64_tr_b16 v[52:53], v248 offset:53248
    ds_read_b64_tr_b16 v[54:55], v248 offset:53760
    s_waitcnt lgkmcnt(8)
    v_mfma_f32_32x32x16_bf16 v[96:111], v[32:35], v[224:227], v[96:111]
    v_mfma_f32_32x32x16_bf16 v[64:79], v[36:39], v[224:227], v[64:79]
    ds_read_b64_tr_b16 v[56:57], v242 offset:55296
    ds_read_b64_tr_b16 v[58:59], v242 offset:55808
    ds_read_b64_tr_b16 v[60:61], v248 offset:55296
    ds_read_b64_tr_b16 v[62:63], v248 offset:55808
    s_waitcnt lgkmcnt(8)
    v_mfma_f32_32x32x16_bf16 v[96:111], v[40:43], v[228:231], v[96:111]
    v_mfma_f32_32x32x16_bf16 v[64:79], v[44:47], v[228:231], v[64:79]
    s_waitcnt lgkmcnt(4)
    v_mfma_f32_32x32x16_bf16 v[96:111], v[48:51], v[232:235], v[96:111]
    v_mfma_f32_32x32x16_bf16 v[64:79], v[52:55], v[232:235], v[64:79]
    s_waitcnt lgkmcnt(0)
    v_mfma_f32_32x32x16_bf16 v[96:111], v[56:59], v[236:239], v[96:111]
    v_mfma_f32_32x32x16_bf16 v[64:79], v[60:63], v[236:239], v[64:79]
    s_waitcnt vmcnt(0)
    v_cmp_eq_u32 vcc, v240, v10
    s_nop 3
    s_cmp_eq_u64 vcc, exec
    s_cselect_b32 s66, 1, 0
    s_and_b32 s64, s2, 1
    s_lshl_b32 s64, s64, 2
    s_and_b32 s62, s47, 3
    s_add_u32 s64, s64, s62
    s_lshl_b32 s64, s64, 7
    s_add_u32 s7, s64, 0x1500000
    s_bfe_u32 s62, s53, 0x60002
    s_lshl_b32 s62, s62, 10
    s_bfe_u32 s63, s53, 0x20000
    s_lshl_b32 s63, s63, 2
    s_add_u32 s62, s62, s63
    v_mov_b32 v2, s62
    s_bfe_u32 s62, s53, 0x6000a
    s_lshl_b32 s62, s62, 10
    s_bfe_u32 s63, s53, 0x20008
    s_lshl_b32 s63, s63, 2
    s_add_u32 s62, s62, s63
    s_mov_b32 exec_lo, 0xaaaaaaaa
    s_mov_b32 exec_hi, 0xaaaaaaaa
    v_mov_b32 v2, s62
    s_mov_b32 exec_lo, 0
    s_mov_b32 exec_hi, -1
    v_add_u32 v2, 16, v2
    s_mov_b32 exec_lo, -1
    v_cvt_pk_bf16_f32 v96, v96, v97
    v_cvt_pk_bf16_f32 v97, v98, v99
    v_cvt_pk_bf16_f32 v98, v100, v101
    v_cvt_pk_bf16_f32 v99, v102, v103
    v_cvt_pk_bf16_f32 v100, v104, v105
    v_cvt_pk_bf16_f32 v101, v106, v107
    v_cvt_pk_bf16_f32 v102, v108, v109
    v_cvt_pk_bf16_f32 v103, v110, v111
    v_mfma_f32_32x32x16_bf16 v[32:47], v[112:115], v[96:99], 0
    s_nop 0
    v_mfma_f32_32x32x16_bf16 v[32:47], v[116:119], v[100:103], v[32:47]
    v_cvt_pk_bf16_f32 v64, v64, v65
    v_cvt_pk_bf16_f32 v65, v66, v67
    v_cvt_pk_bf16_f32 v66, v68, v69
    v_cvt_pk_bf16_f32 v67, v70, v71
    v_cvt_pk_bf16_f32 v68, v72, v73
    v_cvt_pk_bf16_f32 v69, v74, v75
    v_cvt_pk_bf16_f32 v70, v76, v77
    v_cvt_pk_bf16_f32 v71, v78, v79
    v_mfma_f32_32x32x16_bf16 v[208:223], v[20:23], v[64:67], 0
    s_nop 0
    v_mfma_f32_32x32x16_bf16 v[208:223], v[24:27], v[68:71], v[208:223]
    v_mul_f32 v30, s42, v30
    v_min_f32 v30, 0x42a00000, v30
    v_exp_f32 v30, v30
    v_and_b32 v249, 31, v1
    v_lshlrev_b32 v249, 2, v249
    v_add_f32 v31, 1.0, v30
    v_rcp_f32 v31, v31
    s_mov_b32 exec_hi, 0
    s_nop 0
    buffer_store_dword v31, v249, s[12:15], s5 offen sc1
    s_mov_b32 exec_hi, -1
    s_nop 11
    v_max3_f32 v12, v32, v33, v34
    v_max3_f32 v20, v208, v209, v210
    v_min3_f32 v14, v32, v33, v34
    v_min3_f32 v22, v208, v209, v210
    v_max3_f32 v13, v35, v36, v37
    v_max3_f32 v21, v211, v212, v213
    v_min3_f32 v15, v35, v36, v37
    v_min3_f32 v23, v211, v212, v213
    v_max3_f32 v12, v12, v38, v39
    v_max3_f32 v20, v20, v214, v215
    v_min3_f32 v14, v14, v38, v39
    v_min3_f32 v22, v22, v214, v215
    v_max3_f32 v13, v13, v40, v41
    v_max3_f32 v21, v21, v216, v217
    v_min3_f32 v15, v15, v40, v41
    v_min3_f32 v23, v23, v216, v217
    v_max3_f32 v12, v12, v42, v43
    v_max3_f32 v20, v20, v218, v219
    v_min3_f32 v14, v14, v42, v43
    v_min3_f32 v22, v22, v218, v219
    v_mov_b32 v60, 0
    v_mov_b32 v236, 0
    v_mov_b32 v61, 0
    v_mov_b32 v237, 0
    v_mov_b32 v62, 0
    v_mov_b32 v238, 0
    v_mov_b32 v63, 0
    v_mov_b32 v239, 0
    s_mov_b32 exec_hi, 0
    v_max3_f32 v13, v13, v44, v45
    v_max3_f32 v21, v21, v220, v221
    v_min3_f32 v15, v15, v44, v45
    v_min3_f32 v23, v23, v220, v221
    v_max3_f32 v12, v12, v46, v47
    v_max3_f32 v20, v20, v222, v223
    v_min3_f32 v14, v14, v46, v47
    v_min3_f32 v22, v22, v222, v223
    s_mov_b32 exec_hi, -1
    v_max_f32 v12, v12, v13
    v_max_f32 v20, v20, v21
    v_min_f32 v14, v14, v15
    v_min_f32 v22, v22, v23
    v_mov_b32 v13, v12
    v_mov_b32 v21, v20
    v_mov_b32 v15, v14
    v_mov_b32 v23, v22
    v_permlane32_swap_b32 v12, v13
    v_permlane32_swap_b32 v20, v21
    v_permlane32_swap_b32 v14, v15
    v_permlane32_swap_b32 v22, v23
    v_max_f32 v12, v12, v13
    v_max_f32 v20, v20, v21
    v_min_f32 v14, v14, v15
    v_min_f32 v22, v22, v23
    v_mul_f32 v12, s42, v12
    v_mul_f32 v20, s42, v20
    v_mul_f32 v14, s42, v14
    v_mul_f32 v22, s42, v22
    v_pk_fma_f32 v[48:49], v[32:33], s[42:43], v[14:15] op_sel_hi:[1,1,0] neg_lo:[1,0,0] neg_hi:[1,0,0]
    v_pk_fma_f32 v[224:225], v[208:209], s[42:43], v[22:23] op_sel_hi:[1,1,0] neg_lo:[1,0,0] neg_hi:[1,0,0]
    v_pk_fma_f32 v[50:51], v[34:35], s[42:43], v[14:15] op_sel_hi:[1,1,0] neg_lo:[1,0,0] neg_hi:[1,0,0]
    v_pk_fma_f32 v[226:227], v[210:211], s[42:43], v[22:23] op_sel_hi:[1,1,0] neg_lo:[1,0,0] neg_hi:[1,0,0]
    v_pk_fma_f32 v[52:53], v[36:37], s[42:43], v[14:15] op_sel_hi:[1,1,0] neg_lo:[1,0,0] neg_hi:[1,0,0]
    v_pk_fma_f32 v[228:229], v[212:213], s[42:43], v[22:23] op_sel_hi:[1,1,0] neg_lo:[1,0,0] neg_hi:[1,0,0]
    v_pk_fma_f32 v[32:33], v[32:33], s[42:43], v[12:13] op_sel_hi:[1,1,0] neg_lo:[0,0,1] neg_hi:[0,0,1]
    v_pk_fma_f32 v[208:209], v[208:209], s[42:43], v[20:21] op_sel_hi:[1,1,0] neg_lo:[0,0,1] neg_hi:[0,0,1]
    v_pk_fma_f32 v[34:35], v[34:35], s[42:43], v[12:13] op_sel_hi:[1,1,0] neg_lo:[0,0,1] neg_hi:[0,0,1]
    v_pk_fma_f32 v[210:211], v[210:211], s[42:43], v[20:21] op_sel_hi:[1,1,0] neg_lo:[0,0,1] neg_hi:[0,0,1]
    v_pk_fma_f32 v[36:37], v[36:37], s[42:43], v[12:13] op_sel_hi:[1,1,0] neg_lo:[0,0,1] neg_hi:[0,0,1]
    v_pk_fma_f32 v[212:213], v[212:213], s[42:43], v[20:21] op_sel_hi:[1,1,0] neg_lo:[0,0,1] neg_hi:[0,0,1]
    v_exp_f32 v48, v48
    v_exp_f32 v224, v224
    v_exp_f32 v49, v49
    v_exp_f32 v225, v225
    v_exp_f32 v50, v50
    v_exp_f32 v226, v226
    v_exp_f32 v51, v51
    v_exp_f32 v227, v227
    v_exp_f32 v52, v52
    v_exp_f32 v228, v228
    v_exp_f32 v53, v53
    v_exp_f32 v229, v229
    v_exp_f32 v32, v32
    v_exp_f32 v208, v208
    v_exp_f32 v33, v33
    v_exp_f32 v209, v209
    v_exp_f32 v34, v34
    v_exp_f32 v210, v210
    v_exp_f32 v35, v35
    v_exp_f32 v211, v211
    v_exp_f32 v36, v36
    v_exp_f32 v212, v212
    v_exp_f32 v37, v37
    v_exp_f32 v213, v213
    s_barrier
    v_pk_fma_f32 v[54:55], v[38:39], s[42:43], v[14:15] op_sel_hi:[1,1,0] neg_lo:[1,0,0] neg_hi:[1,0,0]
    v_pk_fma_f32 v[230:231], v[214:215], s[42:43], v[22:23] op_sel_hi:[1,1,0] neg_lo:[1,0,0] neg_hi:[1,0,0]
    v_pk_fma_f32 v[56:57], v[40:41], s[42:43], v[14:15] op_sel_hi:[1,1,0] neg_lo:[1,0,0] neg_hi:[1,0,0]
    v_pk_fma_f32 v[232:233], v[216:217], s[42:43], v[22:23] op_sel_hi:[1,1,0] neg_lo:[1,0,0] neg_hi:[1,0,0]
    v_pk_fma_f32 v[58:59], v[42:43], s[42:43], v[14:15] op_sel_hi:[1,1,0] neg_lo:[1,0,0] neg_hi:[1,0,0]
    v_pk_fma_f32 v[234:235], v[218:219], s[42:43], v[22:23] op_sel_hi:[1,1,0] neg_lo:[1,0,0] neg_hi:[1,0,0]
    v_pk_fma_f32 v[38:39], v[38:39], s[42:43], v[12:13] op_sel_hi:[1,1,0] neg_lo:[0,0,1] neg_hi:[0,0,1]
    v_pk_fma_f32 v[214:215], v[214:215], s[42:43], v[20:21] op_sel_hi:[1,1,0] neg_lo:[0,0,1] neg_hi:[0,0,1]
    v_pk_fma_f32 v[40:41], v[40:41], s[42:43], v[12:13] op_sel_hi:[1,1,0] neg_lo:[0,0,1] neg_hi:[0,0,1]
    v_pk_fma_f32 v[216:217], v[216:217], s[42:43], v[20:21] op_sel_hi:[1,1,0] neg_lo:[0,0,1] neg_hi:[0,0,1]
    v_pk_fma_f32 v[42:43], v[42:43], s[42:43], v[12:13] op_sel_hi:[1,1,0] neg_lo:[0,0,1] neg_hi:[0,0,1]
    v_pk_fma_f32 v[218:219], v[218:219], s[42:43], v[20:21] op_sel_hi:[1,1,0] neg_lo:[0,0,1] neg_hi:[0,0,1]
    v_exp_f32 v54, v54
    v_exp_f32 v230, v230
    v_exp_f32 v55, v55
    v_exp_f32 v231, v231
    v_exp_f32 v56, v56
    v_exp_f32 v232, v232
    v_exp_f32 v57, v57
    v_exp_f32 v233, v233
    v_exp_f32 v58, v58
    v_exp_f32 v234, v234
    v_exp_f32 v59, v59
    v_exp_f32 v235, v235
    v_exp_f32 v38, v38
    v_exp_f32 v214, v214
    v_exp_f32 v39, v39
    v_exp_f32 v215, v215
    v_exp_f32 v40, v40
    v_exp_f32 v216, v216
    v_exp_f32 v41, v41
    v_exp_f32 v217, v217
    v_exp_f32 v42, v42
    v_exp_f32 v218, v218
    v_exp_f32 v43, v43
    v_exp_f32 v219, v219
    s_mov_b32 exec_hi, 0
    v_pk_fma_f32 v[60:61], v[44:45], s[42:43], v[14:15] op_sel_hi:[1,1,0] neg_lo:[1,0,0] neg_hi:[1,0,0]
    v_pk_fma_f32 v[236:237], v[220:221], s[42:43], v[22:23] op_sel_hi:[1,1,0] neg_lo:[1,0,0] neg_hi:[1,0,0]
    v_pk_fma_f32 v[62:63], v[46:47], s[42:43], v[14:15] op_sel_hi:[1,1,0] neg_lo:[1,0,0] neg_hi:[1,0,0]
    v_pk_fma_f32 v[238:239], v[222:223], s[42:43], v[22:23] op_sel_hi:[1,1,0] neg_lo:[1,0,0] neg_hi:[1,0,0]
    v_pk_fma_f32 v[44:45], v[44:45], s[42:43], v[12:13] op_sel_hi:[1,1,0] neg_lo:[0,0,1] neg_hi:[0,0,1]
    v_pk_fma_f32 v[220:221], v[220:221], s[42:43], v[20:21] op_sel_hi:[1,1,0] neg_lo:[0,0,1] neg_hi:[0,0,1]
    v_pk_fma_f32 v[46:47], v[46:47], s[42:43], v[12:13] op_sel_hi:[1,1,0] neg_lo:[0,0,1] neg_hi:[0,0,1]
    v_pk_fma_f32 v[222:223], v[222:223], s[42:43], v[20:21] op_sel_hi:[1,1,0] neg_lo:[0,0,1] neg_hi:[0,0,1]
    v_exp_f32 v60, v60
    v_exp_f32 v236, v236
    v_exp_f32 v61, v61
    v_exp_f32 v237, v237
    v_exp_f32 v62, v62
    v_exp_f32 v238, v238
    v_exp_f32 v63, v63
    v_exp_f32 v239, v239
    v_exp_f32 v44, v44
    v_exp_f32 v220, v220
    v_exp_f32 v45, v45
    v_exp_f32 v221, v221
    v_exp_f32 v46, v46
    v_exp_f32 v222, v222
    v_exp_f32 v47, v47
    v_exp_f32 v223, v223
    s_mov_b32 exec_hi, -1
    v_pk_add_f32 v[16:17], v[32:33], v[34:35]
    v_pk_add_f32 v[24:25], v[208:209], v[210:211]
    v_pk_add_f32 v[18:19], v[48:49], v[50:51]
    v_pk_add_f32 v[26:27], v[224:225], v[226:227]
    v_pk_add_f32 v[16:17], v[16:17], v[36:37]
    v_pk_add_f32 v[24:25], v[24:25], v[212:213]
    v_pk_add_f32 v[18:19], v[18:19], v[52:53]
    v_pk_add_f32 v[26:27], v[26:27], v[228:229]
    v_pk_add_f32 v[16:17], v[16:17], v[38:39]
    v_pk_add_f32 v[24:25], v[24:25], v[214:215]
    v_pk_add_f32 v[18:19], v[18:19], v[54:55]
    v_pk_add_f32 v[26:27], v[26:27], v[230:231]
    v_pk_add_f32 v[16:17], v[16:17], v[40:41]
    v_pk_add_f32 v[24:25], v[24:25], v[216:217]
    v_pk_add_f32 v[18:19], v[18:19], v[56:57]
    v_pk_add_f32 v[26:27], v[26:27], v[232:233]
    v_pk_add_f32 v[16:17], v[16:17], v[42:43]
    v_pk_add_f32 v[24:25], v[24:25], v[218:219]
    v_pk_add_f32 v[18:19], v[18:19], v[58:59]
    v_pk_add_f32 v[26:27], v[26:27], v[234:235]
    v_pk_add_f32 v[16:17], v[16:17], v[44:45]
    v_pk_add_f32 v[24:25], v[24:25], v[220:221]
    v_pk_add_f32 v[18:19], v[18:19], v[60:61]
    v_pk_add_f32 v[26:27], v[26:27], v[236:237]
    v_pk_add_f32 v[16:17], v[16:17], v[46:47]
    v_pk_add_f32 v[24:25], v[24:25], v[222:223]
    v_pk_add_f32 v[18:19], v[18:19], v[62:63]
    v_pk_add_f32 v[26:27], v[26:27], v[238:239]
    v_add_f32 v16, v16, v17
    v_add_f32 v24, v24, v25
    v_add_f32 v18, v18, v19
    v_add_f32 v26, v26, v27
    v_mov_b32 v13, v16
    v_mov_b32 v21, v24
    v_mov_b32 v15, v18
    v_mov_b32 v23, v26
    v_permlane32_swap_b32 v16, v13
    v_permlane32_swap_b32 v24, v21
    v_permlane32_swap_b32 v18, v15
    v_permlane32_swap_b32 v26, v23
    v_add_f32 v16, v16, v13
    v_add_f32 v24, v24, v21
    v_add_f32 v18, v18, v15
    v_add_f32 v26, v26, v23
    v_rcp_f32 v18, v18
    v_rcp_f32 v26, v26
    v_mul_f32 v28, 0x358637bd, v16
    v_mul_f32 v29, 0x358637bd, v24
    v_mul_f32 v18, v18, v16
    v_mul_f32 v26, v26, v24
    buffer_load_dword v10, v2, s[12:15], s7 offen sc1
    buffer_load_dwordx4 v[128:131], v244, s[12:15], s23 offen offset:0 sc1
    buffer_load_dwordx4 v[132:135], v244, s[12:15], s23 offen offset:1024 sc1
    buffer_load_dwordx4 v[136:139], v244, s[12:15], s23 offen offset:2048 sc1
    buffer_load_dwordx4 v[140:143], v244, s[12:15], s23 offen offset:3072 sc1
    v_pk_mul_f32 v[48:49], v[48:49], v[18:19] op_sel_hi:[1,0]
    v_pk_mul_f32 v[224:225], v[224:225], v[26:27] op_sel_hi:[1,0]
    v_pk_mul_f32 v[50:51], v[50:51], v[18:19] op_sel_hi:[1,0]
    v_pk_mul_f32 v[226:227], v[226:227], v[26:27] op_sel_hi:[1,0]
    v_pk_mul_f32 v[52:53], v[52:53], v[18:19] op_sel_hi:[1,0]
    v_pk_mul_f32 v[228:229], v[228:229], v[26:27] op_sel_hi:[1,0]
    v_pk_mul_f32 v[54:55], v[54:55], v[18:19] op_sel_hi:[1,0]
    v_pk_mul_f32 v[230:231], v[230:231], v[26:27] op_sel_hi:[1,0]
    v_pk_mul_f32 v[56:57], v[56:57], v[18:19] op_sel_hi:[1,0]
    v_pk_mul_f32 v[232:233], v[232:233], v[26:27] op_sel_hi:[1,0]
    v_pk_mul_f32 v[58:59], v[58:59], v[18:19] op_sel_hi:[1,0]
    v_pk_mul_f32 v[234:235], v[234:235], v[26:27] op_sel_hi:[1,0]
    v_pk_mul_f32 v[60:61], v[60:61], v[18:19] op_sel_hi:[1,0]
    v_pk_mul_f32 v[236:237], v[236:237], v[26:27] op_sel_hi:[1,0]
    v_pk_mul_f32 v[62:63], v[62:63], v[18:19] op_sel_hi:[1,0]
    v_pk_mul_f32 v[238:239], v[238:239], v[26:27] op_sel_hi:[1,0]
    v_cvt_pk_bf16_f32 v80, v32, v33
    v_cvt_pk_bf16_f32 v96, v208, v209
    v_cvt_pk_bf16_f32 v88, v48, v49
    v_cvt_pk_bf16_f32 v104, v224, v225
    v_cvt_pk_bf16_f32 v81, v34, v35
    v_cvt_pk_bf16_f32 v97, v210, v211
    v_cvt_pk_bf16_f32 v89, v50, v51
    v_cvt_pk_bf16_f32 v105, v226, v227
    v_cvt_pk_bf16_f32 v82, v36, v37
    v_cvt_pk_bf16_f32 v98, v212, v213
    v_cvt_pk_bf16_f32 v90, v52, v53
    v_cvt_pk_bf16_f32 v106, v228, v229
    v_cvt_pk_bf16_f32 v83, v38, v39
    v_cvt_pk_bf16_f32 v99, v214, v215
    v_cvt_pk_bf16_f32 v91, v54, v55
    v_cvt_pk_bf16_f32 v107, v230, v231
    v_cvt_pk_bf16_f32 v84, v40, v41
    v_cvt_pk_bf16_f32 v100, v216, v217
    v_cvt_pk_bf16_f32 v92, v56, v57
    v_cvt_pk_bf16_f32 v108, v232, v233
    v_cvt_pk_bf16_f32 v85, v42, v43
    v_cvt_pk_bf16_f32 v101, v218, v219
    v_cvt_pk_bf16_f32 v93, v58, v59
    v_cvt_pk_bf16_f32 v109, v234, v235
    v_cvt_pk_bf16_f32 v86, v44, v45
    v_cvt_pk_bf16_f32 v102, v220, v221
    v_cvt_pk_bf16_f32 v94, v60, v61
    v_cvt_pk_bf16_f32 v110, v236, v237
    v_cvt_pk_bf16_f32 v87, v46, v47
    v_cvt_pk_bf16_f32 v103, v222, v223
    v_cvt_pk_bf16_f32 v95, v62, v63
    v_cvt_pk_bf16_f32 v111, v238, v239
    s_lshl_b32 s62, s55, 1
    s_sub_u32 s62, s62, 8192
    v_add_u32 v15, s62, v244
    v_and_b32 v16, 3, v1
    v_lshlrev_b32 v16, 2, v16
    s_waitcnt vmcnt(0)
    v_perm_b32 v12, v129, v128, s20
    v_perm_b32 v13, v131, v130, s21
    v_bitop3_b32 v14, v12, v13, v11 bitop3:0x56
    v_perm_b32 v12, v133, v132, s20
    v_perm_b32 v13, v135, v134, s21
    v_bitop3_b32 v12, v12, v13, v11 bitop3:0x56
    v_or_b32 v14, v14, v12
    v_perm_b32 v12, v137, v136, s20
    v_perm_b32 v13, v139, v138, s21
    v_bitop3_b32 v12, v12, v13, v11 bitop3:0x56
    v_or_b32 v14, v14, v12
    v_perm_b32 v12, v141, v140, s20
    v_perm_b32 v13, v143, v142, s21
    v_bitop3_b32 v12, v12, v13, v11 bitop3:0x56
    v_or_b32 v14, v14, v12
    v_cmp_eq_u32 vcc, 0, v14
    s_nop 3
    s_cmp_eq_u64 vcc, exec
    s_cbranch_scc1 pd_35
    s_mov_b32 s3, 200000
pl_36:
    s_sleep 1
    buffer_load_dwordx4 v[128:131], v244, s[12:15], s23 offen offset:0 sc1
    buffer_load_dwordx4 v[132:135], v244, s[12:15], s23 offen offset:1024 sc1
    buffer_load_dwordx4 v[136:139], v244, s[12:15], s23 offen offset:2048 sc1
    buffer_load_dwordx4 v[140:143], v244, s[12:15], s23 offen offset:3072 sc1
    s_waitcnt vmcnt(0)
    v_perm_b32 v12, v129, v128, s20
    v_perm_b32 v13, v131, v130, s21
    v_bitop3_b32 v14, v12, v13, v11 bitop3:0x56
    v_perm_b32 v12, v133, v132, s20
    v_perm_b32 v13, v135, v134, s21
    v_bitop3_b32 v12, v12, v13, v11 bitop3:0x56
    v_or_b32 v14, v14, v12
    v_perm_b32 v12, v137, v136, s20
    v_perm_b32 v13, v139, v138, s21
    v_bitop3_b32 v12, v12, v13, v11 bitop3:0x56
    v_or_b32 v14, v14, v12
    v_perm_b32 v12, v141, v140, s20
    v_perm_b32 v13, v143, v142, s21
    v_bitop3_b32 v12, v12, v13, v11 bitop3:0x56
    v_or_b32 v14, v14, v12
    v_cmp_eq_u32 vcc, 0, v14
    s_nop 3
    s_cmp_eq_u64 vcc, exec
    s_cbranch_scc1 pd_35
    s_sub_u32 s3, s3, 1
    s_cbranch_scc0 pl_36
pd_35:
    v_cvt_pk_bf16_f32 v128, v128, v129
    v_cvt_pk_bf16_f32 v129, v130, v131
    v_cvt_pk_bf16_f32 v130, v132, v133
    v_cvt_pk_bf16_f32 v131, v134, v135
    v_cvt_pk_bf16_f32 v132, v136, v137
    v_cvt_pk_bf16_f32 v133, v138, v139
    v_cvt_pk_bf16_f32 v134, v140, v141
    v_cvt_pk_bf16_f32 v135, v142, v143
    ds_write_b128 v15, v[128:131] offset:0
    ds_write_b128 v15, v[132:135] offset:1024
    s_waitcnt lgkmcnt(0)
    s_lshl_b64 exec, 1, s47
    ds_write_b32 v16, v11 offset:8192
    s_mov_b64 exec, -1
    s_mov_b32 s3, 2000000
gs_37:
    ds_read_b32 v17, v16 offset:8192
    s_waitcnt lgkmcnt(0)
    v_cmp_eq_u32 vcc, v11, v17
    s_nop 3
    s_cmp_eq_u64 vcc, exec
    s_cbranch_scc1 gs_38
    s_sub_u32 s3, s3, 1
    s_cbranch_scc0 gs_37
gs_38:
    ds_read_b128 v[176:179], v244 offset:0
    ds_read_b128 v[180:183], v244 offset:1024
    ds_read_b128 v[184:187], v244 offset:2048
    ds_read_b128 v[188:191], v244 offset:3072
    ds_read_b128 v[192:195], v244 offset:4096
    ds_read_b128 v[196:199], v244 offset:5120
    ds_read_b128 v[200:203], v244 offset:6144
    ds_read_b128 v[204:207], v244 offset:7168
    s_waitcnt lgkmcnt(0)
    v_mfma_f32_32x32x16_bf16 v[32:47], v[176:179], v[80:83], 0
    v_mfma_f32_32x32x16_bf16 v[48:63], v[192:195], v[96:99], 0
    v_mfma_f32_32x32x16_bf16 v[32:47], v[180:183], v[84:87], v[32:47]
    v_mfma_f32_32x32x16_bf16 v[48:63], v[196:199], v[100:103], v[48:63]
    v_mfma_f32_32x32x16_bf16 v[32:47], v[184:187], v[88:91], v[32:47]
    v_mfma_f32_32x32x16_bf16 v[48:63], v[200:203], v[104:107], v[48:63]
    v_mfma_f32_32x32x16_bf16 v[32:47], v[188:191], v[92:95], v[32:47]
    v_mfma_f32_32x32x16_bf16 v[48:63], v[204:207], v[108:111], v[48:63]
    s_nop 10
    v_mov_b32 v12, v44
    v_mov_b32 v14, v60
    v_mov_b32 v13, v44
    v_mov_b32 v15, v60
    s_nop 0
    v_permlane32_swap_b32 v13, v12
    v_permlane32_swap_b32 v15, v14
    v_add_f32 v12, v28, v12
    v_add_f32 v14, v29, v14
    v_rcp_f32 v12, v12
    v_rcp_f32 v14, v14
    v_mul_f32 v12, v12, v30
    v_mul_f32 v14, v14, v30
    v_mul_f32 v32, v32, v12
    v_mul_f32 v48, v48, v14
    v_mul_f32 v33, v33, v12
    v_mul_f32 v49, v49, v14
    v_mul_f32 v34, v34, v12
    v_mul_f32 v50, v50, v14
    v_mul_f32 v35, v35, v12
    v_mul_f32 v51, v51, v14
    v_mul_f32 v36, v36, v12
    v_mul_f32 v52, v52, v14
    v_mul_f32 v37, v37, v12
    v_mul_f32 v53, v53, v14
    v_mul_f32 v38, v38, v12
    v_mul_f32 v54, v54, v14
    v_mul_f32 v39, v39, v12
    v_mul_f32 v55, v55, v14
    v_mul_f32 v40, v40, v12
    v_mul_f32 v56, v56, v14
    v_mul_f32 v41, v41, v12
    v_mul_f32 v57, v57, v14
    v_mul_f32 v42, v42, v12
    v_mul_f32 v58, v58, v14
    v_mul_f32 v43, v43, v12
    v_mul_f32 v59, v59, v14
    v_mul_f32 v44, v44, v12
    v_mul_f32 v60, v60, v14
    v_mul_f32 v45, v45, v12
    v_mul_f32 v61, v61, v14
    v_mul_f32 v46, v46, v12
    v_mul_f32 v62, v62, v14
    v_mul_f32 v47, v47, v12
    v_mul_f32 v63, v63, v14
    v_cvt_pk_bf16_f32 v32, v32, v33
    v_cvt_pk_bf16_f32 v48, v48, v49
    v_cvt_pk_bf16_f32 v33, v34, v35
    v_cvt_pk_bf16_f32 v49, v50, v51
    v_cvt_pk_bf16_f32 v34, v36, v37
    v_cvt_pk_bf16_f32 v50, v52, v53
    v_cvt_pk_bf16_f32 v35, v38, v39
    v_cvt_pk_bf16_f32 v51, v54, v55
    v_cvt_pk_bf16_f32 v36, v40, v41
    v_cvt_pk_bf16_f32 v52, v56, v57
    v_cvt_pk_bf16_f32 v37, v42, v43
    v_cvt_pk_bf16_f32 v53, v58, v59
    v_cvt_pk_bf16_f32 v38, v44, v45
    v_cvt_pk_bf16_f32 v54, v60, v61
    v_cvt_pk_bf16_f32 v39, v46, v47
    v_cvt_pk_bf16_f32 v55, v62, v63
    s_mov_b32 exec_lo, 0
    v_mov_b32 v38, 0
    v_mov_b32 v54, 0
    v_mov_b32 v39, 0
    v_mov_b32 v55, 0
    s_mov_b32 exec_lo, -1
    buffer_store_dwordx4 v[32:35], v244, s[12:15], s4 offen offset:0 sc1
    buffer_store_dwordx4 v[36:39], v244, s[12:15], s4 offen offset:1024 sc1
    buffer_store_dwordx4 v[48:51], v244, s[12:15], s4 offen offset:2048 sc1
    buffer_store_dwordx4 v[52:55], v244, s[12:15], s4 offen offset:3072 sc1
    s_mov_b32 s67, 3
    s_setprio 0
    s_branch phase2_nw
phase2:
    s_waitcnt vmcnt(0)
phase2_nw:
    v_mov_b32 v7, v244
    v_mov_b32 v4, v245
    s_and_b32 s64, s2, 1
    s_lshl_b32 s64, s64, 2
    s_and_b32 s62, s47, 3
    s_add_u32 s64, s64, s62
    s_and_b32 s62, s53, 255
    s_bfe_u32 s63, s53, 0x80008
    s_sub_u32 s48, s63, s62
    s_mul_i32 s48, s48, 114688
    s_mul_i32 s56, s62, 114688
    s_mul_i32 s57, s64, 14336
    s_add_u32 s56, s56, s57
    s_lshl_b32 s62, s62, 3
    s_add_u32 s62, s62, s64
    s_lshl_b32 s62, s62, 12
    s_add_u32 s58, s62, 0x800000
    s_lshl_b32 s63, s63, 3
    s_add_u32 s63, s63, s64
    s_lshl_b32 s63, s63, 12
    s_add_u32 s59, s63, 0x800000
    s_mov_b32 s61, 0
    v_and_b32 v9, 3, v1
    v_lshlrev_b32 v9, 12, v9
    v_add_u32 v9, 151424, v9
    v_and_b32 v8, 0x3fff3fff, v11
    s_cmp_eq_u32 s67, 3
    s_cbranch_scc1 loop_2
    s_cmp_ge_u32 s47, 4
    s_cbranch_scc1 loop_1
    s_lshl_b64 exec, 1, s47
    ds_write_b32 v9, v8 offset:32
    s_mov_b64 exec, -1
    s_waitcnt vmcnt(63)
    v_cmp_eq_u32 vcc, v10, v11
    s_nop 3
    s_cmp_eq_u32 vcc_lo, -1
    s_cbranch_scc1 pd_39
    s_mov_b32 s3, 200000
pl_40:
    s_sleep 1
    buffer_load_dword v10, v2, s[12:15], s7 offen sc1
    s_waitcnt vmcnt(0)
    v_cmp_eq_u32 vcc, v10, v11
    s_nop 3
    s_cmp_eq_u32 vcc_lo, -1
    s_cbranch_scc1 pd_39
    s_sub_u32 s3, s3, 1
    s_cbranch_scc0 pl_40
pd_39:
    s_bfe_u32 s57, s46, 0x40000
    s_lshl_b32 s57, s57, 11
    s_add_u32 s57, s57, s56
    s_add_u32 s49, s57, s48
    buffer_load_dwordx4 v[12:15], v7, s[12:15], s57 offen offset:0 sc1
    buffer_load_dwordx4 v[16:19], v7, s[12:15], s49 offen offset:0 sc1
    buffer_load_dwordx4 v[20:23], v7, s[12:15], s57 offen offset:1024 sc1
    buffer_load_dwordx4 v[24:27], v7, s[12:15], s49 offen offset:1024 sc1
    s_bfe_u32 s57, s46, 0x40004
    s_lshl_b32 s57, s57, 11
    s_add_u32 s57, s57, s56
    s_add_u32 s49, s57, s48
    buffer_load_dwordx4 v[176:179], v7, s[12:15], s57 offen offset:0 sc1
    buffer_load_dwordx4 v[180:183], v7, s[12:15], s49 offen offset:0 sc1
    buffer_load_dwordx4 v[184:187], v7, s[12:15], s57 offen offset:1024 sc1
    buffer_load_dword v10, v2, s[12:15], s7 offen sc1
    buffer_load_dwordx4 v[188:191], v7, s[12:15], s49 offen offset:1024 sc1
    s_bfe_u32 s57, s46, 0x40008
    s_lshl_b32 s57, s57, 11
    s_add_u32 s57, s57, s56
    s_add_u32 s49, s57, s48
    buffer_load_dwordx4 v[192:195], v7, s[12:15], s57 offen offset:0 sc1
    buffer_load_dwordx4 v[196:199], v7, s[12:15], s49 offen offset:0 sc1
    v_add_u32 v5, 16384, v4
    v_xor_b32 v6, 64, v5
    ds_read_b64_tr_b16 v[128:129], v5 offset:0
    ds_read_b64_tr_b16 v[130:131], v5 offset:1024
    ds_read_b64_tr_b16 v[132:133], v6 offset:0
    ds_read_b64_tr_b16 v[134:135], v6 offset:1024
    ds_read_b64_tr_b16 v[136:137], v5 offset:2048
    ds_read_b64_tr_b16 v[138:139], v5 offset:3072
    ds_read_b64_tr_b16 v[140:141], v6 offset:2048
    ds_read_b64_tr_b16 v[142:143], v6 offset:3072
    v_add_u32 v5, 32768, v4
    v_xor_b32 v6, 64, v5
    ds_read_b64_tr_b16 v[144:145], v5 offset:0
    ds_read_b64_tr_b16 v[146:147], v5 offset:1024
    ds_read_b64_tr_b16 v[148:149], v6 offset:0
    ds_read_b64_tr_b16 v[150:151], v6 offset:1024
    ds_read_b64_tr_b16 v[152:153], v5 offset:2048
    ds_read_b64_tr_b16 v[154:155], v5 offset:3072
    ds_read_b64_tr_b16 v[156:157], v6 offset:2048
    ds_read_b64_tr_b16 v[158:159], v6 offset:3072
    v_add_u32 v5, 49152, v4
    v_xor_b32 v6, 64, v5
    ds_read_b64_tr_b16 v[160:161], v5 offset:0
    ds_read_b64_tr_b16 v[162:163], v5 offset:1024
    ds_read_b64_tr_b16 v[164:165], v6 offset:0
    ds_read_b64_tr_b16 v[166:167], v6 offset:1024
    ds_read_b64_tr_b16 v[168:169], v5 offset:2048
    ds_read_b64_tr_b16 v[170:171], v5 offset:3072
    ds_read_b64_tr_b16 v[172:173], v6 offset:2048
    ds_read_b64_tr_b16 v[174:175], v6 offset:3072
    v_bfe_u32 v240, v0, 3, 5
    v_and_b32 v241, 7, v0
    v_lshlrev_b32 v241, 4, v241
    s_lshl_b32 s63, s54, 7
    buffer_load_dwordx4 v[244:247], v241, s[32:35], s63 offen
    v_and_b32 v28, 31, v1
    v_bfe_u32 v29, v1, 1, 2
    v_and_b32 v30, 1, v1
    v_lshl_add_u32 v29, v30, 2, v29
    v_lshrrev_b32 v30, 5, v1
    v_xor_b32 v29, v29, v30
    v_lshlrev_b32 v29, 4, v29
    s_and_b32 s64, s47, 3
    s_lshl_b32 s64, s64, 12
    s_and_b32 s62, s47, 4
    s_lshl_b32 s62, s62, 14
    s_add_u32 s64, s64, s62
    v_lshl_add_u32 v248, v28, 7, v29
    v_add_u32 v248, s64, v248
    v_xor_b32 v249, 32, v248
    v_xor_b32 v250, 64, v248
    v_xor_b32 v251, 96, v248
    v_bfe_u32 v29, v240, 1, 2
    v_and_b32 v30, 1, v240
    v_lshl_add_u32 v29, v30, 2, v29
    v_and_b32 v30, 3, v0
    v_lshlrev_b32 v30, 1, v30
    v_xor_b32 v29, v29, v30
    v_lshlrev_b32 v28, 7, v240
    v_lshl_add_u32 v28, v29, 4, v28
    v_and_b32 v29, 4, v0
    v_lshlrev_b32 v29, 12, v29
    v_add_u32 v28, v28, v29
    v_xor_b32 v29, 16, v28
    s_and_b32 s62, s47, 4
    s_lshl_b32 s62, s62, 13
    s_add_u32 s62, s62, 65536
    v_add_u32 v30, s62, v28
    v_xor_b32 v31, 16, v30
    v_lshlrev_b32 v242, 2, v240
    v_mul_u32_u24 v240, 896, v240
    v_add_u32 v240, v240, v241
    s_lshr_b32 s62, s53, 16
    s_mul_i32 s51, s62, 28672
    s_lshl_b32 s63, s54, 7
    s_add_u32 s51, s51, s63
    s_and_b32 s64, s2, 1
    s_lshl_b32 s64, s64, 2
    s_and_b32 s63, s47, 3
    s_add_u32 s64, s64, s63
    s_lshr_b32 s63, s62, 2
    s_lshl_b32 s63, s63, 3
    s_add_u32 s63, s63, s64
    s_lshl_b32 s63, s63, 2
    s_and_b32 s62, s62, 3
    s_add_u32 s63, s63, s62
    s_lshl_b32 s63, s63, 7
    s_add_u32 s60, s63, 0x1400000
    s_lshl_b32 s52, s2, 14
    s_lshl_b32 s62, s55, 1
    s_add_u32 s52, s52, s62
    s_add_u32 s52, s52, 0x1000000
    s_mov_b32 s20, 0x0c0c0400
    s_mov_b32 s21, 0x04000c0c
    s_mov_b32 s22, -1
    s_mov_b32 s23, s22
    s_mov_b32 s8, 0x7060500
    s_mov_b32 s9, 0x7060501
    s_mov_b32 s10, 0x7060502
    s_mov_b32 s11, 0x7060503
    s_waitcnt lgkmcnt(0)
    s_waitcnt vmcnt(11)
    v_mfma_f32_32x32x16_bf16 v[32:47], v[128:131], v[12:15], 0
    v_mfma_f32_32x32x16_bf16 v[96:111], v[132:135], v[12:15], 0
    buffer_load_dwordx4 v[200:203], v7, s[12:15], s57 offen offset:1024 sc1
    s_waitcnt vmcnt(11)
    v_mfma_f32_32x32x16_bf16 v[48:63], v[128:131], v[16:19], 0
    v_mfma_f32_32x32x16_bf16 v[112:127], v[132:135], v[16:19], 0
    buffer_load_dwordx4 v[204:207], v7, s[12:15], s49 offen offset:1024 sc1
    s_waitcnt vmcnt(11)
    v_mfma_f32_32x32x16_bf16 v[32:47], v[136:139], v[20:23], v[32:47]
    v_mfma_f32_32x32x16_bf16 v[96:111], v[140:143], v[20:23], v[96:111]
    s_bfe_u32 s57, s46, 0x4000c
    s_lshl_b32 s57, s57, 11
    s_add_u32 s57, s57, s56
    s_add_u32 s49, s57, s48
    buffer_load_dwordx4 v[12:15], v7, s[12:15], s57 offen offset:0 sc1
    s_waitcnt vmcnt(11)
    v_mfma_f32_32x32x16_bf16 v[48:63], v[136:139], v[24:27], v[48:63]
    v_mfma_f32_32x32x16_bf16 v[112:127], v[140:143], v[24:27], v[112:127]
    buffer_load_dwordx4 v[16:19], v7, s[12:15], s49 offen offset:0 sc1
    s_waitcnt vmcnt(11)
    v_mfma_f32_32x32x16_bf16 v[32:47], v[144:147], v[176:179], v[32:47]
    v_mfma_f32_32x32x16_bf16 v[96:111], v[148:151], v[176:179], v[96:111]
    v_add_u32 v5, 65536, v4
    v_xor_b32 v6, 64, v5
    ds_read_b64_tr_b16 v[128:129], v5 offset:0
    ds_read_b64_tr_b16 v[130:131], v5 offset:1024
    ds_read_b64_tr_b16 v[132:133], v6 offset:0
    ds_read_b64_tr_b16 v[134:135], v6 offset:1024
    ds_read_b64_tr_b16 v[136:137], v5 offset:2048
    ds_read_b64_tr_b16 v[138:139], v5 offset:3072
    ds_read_b64_tr_b16 v[140:141], v6 offset:2048
    ds_read_b64_tr_b16 v[142:143], v6 offset:3072
    buffer_load_dwordx4 v[20:23], v7, s[12:15], s57 offen offset:1024 sc1
    s_waitcnt vmcnt(11)
    v_mfma_f32_32x32x16_bf16 v[48:63], v[144:147], v[180:183], v[48:63]
    v_mfma_f32_32x32x16_bf16 v[112:127], v[148:151], v[180:183], v[112:127]
    buffer_load_dwordx4 v[24:27], v7, s[12:15], s49 offen offset:1024 sc1
    s_waitcnt vmcnt(11)
    v_mfma_f32_32x32x16_bf16 v[32:47], v[152:155], v[184:187], v[32:47]
    v_mfma_f32_32x32x16_bf16 v[96:111], v[156:159], v[184:187], v[96:111]
    s_waitcnt vmcnt(10)
    v_cmp_eq_u32 vcc, v10, v11
    s_nop 3
    s_cmp_eq_u64 vcc, exec
    s_cbranch_scc1 pd_41
    s_mov_b32 s3, 200000
pl_42:
    s_sleep 1
    buffer_load_dword v10, v2, s[12:15], s7 offen sc1
    s_waitcnt vmcnt(0)
    v_cmp_eq_u32 vcc, v10, v11
    s_nop 3
    s_cmp_eq_u64 vcc, exec
    s_cbranch_scc1 pd_41
    s_sub_u32 s3, s3, 1
    s_cbranch_scc0 pl_42
pd_41:
    s_add_u32 s7, s7, 65536
    v_or_b32 v2, 16, v2
    s_bfe_u32 s57, s46, 0x40010
    s_lshl_b32 s57, s57, 11
    s_add_u32 s57, s57, s56
    s_add_u32 s49, s57, s48
    buffer_load_dwordx4 v[176:179], v7, s[12:15], s57 offen offset:0 sc1
    s_waitcnt vmcnt(10)
    v_mfma_f32_32x32x16_bf16 v[48:63], v[152:155], v[188:191], v[48:63]
    v_mfma_f32_32x32x16_bf16 v[112:127], v[156:159], v[188:191], v[112:127]
    buffer_load_dwordx4 v[180:183], v7, s[12:15], s49 offen offset:0 sc1
    s_waitcnt vmcnt(10)
    v_mfma_f32_32x32x16_bf16 v[32:47], v[160:163], v[192:195], v[32:47]
    v_mfma_f32_32x32x16_bf16 v[96:111], v[164:167], v[192:195], v[96:111]
    v_add_u32 v5, 81920, v4
    v_xor_b32 v6, 64, v5
    ds_read_b64_tr_b16 v[144:145], v5 offset:0
    ds_read_b64_tr_b16 v[146:147], v5 offset:1024
    ds_read_b64_tr_b16 v[148:149], v6 offset:0
    ds_read_b64_tr_b16 v[150:151], v6 offset:1024
    ds_read_b64_tr_b16 v[152:153], v5 offset:2048
    ds_read_b64_tr_b16 v[154:155], v5 offset:3072
    ds_read_b64_tr_b16 v[156:157], v6 offset:2048
    ds_read_b64_tr_b16 v[158:159], v6 offset:3072
    buffer_load_dwordx4 v[184:187], v7, s[12:15], s57 offen offset:1024 sc1
    s_waitcnt vmcnt(10)
    v_mfma_f32_32x32x16_bf16 v[48:63], v[160:163], v[196:199], v[48:63]
    v_mfma_f32_32x32x16_bf16 v[112:127], v[164:167], v[196:199], v[112:127]
    buffer_load_dwordx4 v[188:191], v7, s[12:15], s49 offen offset:1024 sc1
    s_waitcnt vmcnt(9)
    v_mfma_f32_32x32x16_bf16 v[32:47], v[168:171], v[200:203], v[32:47]
    v_mfma_f32_32x32x16_bf16 v[96:111], v[172:175], v[200:203], v[96:111]
    s_bfe_u32 s57, s46, 0x40014
    s_lshl_b32 s57, s57, 11
    s_add_u32 s57, s57, s56
    s_add_u32 s49, s57, s48
    buffer_load_dwordx4 v[192:195], v7, s[12:15], s57 offen offset:0 sc1
    s_waitcnt vmcnt(9)
    v_mfma_f32_32x32x16_bf16 v[48:63], v[168:171], v[204:207], v[48:63]
    v_mfma_f32_32x32x16_bf16 v[112:127], v[172:175], v[204:207], v[112:127]
    buffer_load_dwordx4 v[196:199], v7, s[12:15], s49 offen offset:0 sc1
    s_waitcnt lgkmcnt(0)
    s_waitcnt vmcnt(9)
    v_mfma_f32_32x32x16_bf16 v[32:47], v[128:131], v[12:15], v[32:47]
    v_mfma_f32_32x32x16_bf16 v[96:111], v[132:135], v[12:15], v[96:111]
    v_add_u32 v5, 98304, v4
    v_xor_b32 v6, 64, v5
    ds_read_b64_tr_b16 v[160:161], v5 offset:0
    ds_read_b64_tr_b16 v[162:163], v5 offset:1024
    ds_read_b64_tr_b16 v[164:165], v6 offset:0
    ds_read_b64_tr_b16 v[166:167], v6 offset:1024
    ds_read_b64_tr_b16 v[168:169], v5 offset:2048
    ds_read_b64_tr_b16 v[170:171], v5 offset:3072
    ds_read_b64_tr_b16 v[172:173], v6 offset:2048
    ds_read_b64_tr_b16 v[174:175], v6 offset:3072
    buffer_load_dwordx4 v[200:203], v7, s[12:15], s57 offen offset:1024 sc1
    s_waitcnt vmcnt(9)
    v_mfma_f32_32x32x16_bf16 v[48:63], v[128:131], v[16:19], v[48:63]
    v_mfma_f32_32x32x16_bf16 v[112:127], v[132:135], v[16:19], v[112:127]
    buffer_load_dwordx4 v[204:207], v7, s[12:15], s49 offen offset:1024 sc1
    s_waitcnt vmcnt(9)
    v_mfma_f32_32x32x16_bf16 v[32:47], v[136:139], v[20:23], v[32:47]
    v_mfma_f32_32x32x16_bf16 v[96:111], v[140:143], v[20:23], v[96:111]
    s_bfe_u32 s57, s46, 0x40018
    s_lshl_b32 s57, s57, 11
    s_add_u32 s57, s57, s56
    s_add_u32 s49, s57, s48
    buffer_load_dwordx4 v[12:15], v7, s[12:15], s57 offen offset:0 sc1
    s_waitcnt vmcnt(9)
    v_mfma_f32_32x32x16_bf16 v[48:63], v[136:139], v[24:27], v[48:63]
    v_mfma_f32_32x32x16_bf16 v[112:127], v[140:143], v[24:27], v[112:127]
    buffer_load_dwordx4 v[16:19], v7, s[12:15], s49 offen offset:0 sc1
    s_waitcnt lgkmcnt(0)
    s_waitcnt vmcnt(9)
    v_mfma_f32_32x32x16_bf16 v[32:47], v[144:147], v[176:179], v[32:47]
    v_mfma_f32_32x32x16_bf16 v[96:111], v[148:151], v[176:179], v[96:111]
    v_add_u32 v5, 114688, v4
    v_xor_b32 v6, 64, v5
    ds_read_b64_tr_b16 v[128:129], v5 offset:0
    ds_read_b64_tr_b16 v[130:131], v5 offset:1024
    ds_read_b64_tr_b16 v[132:133], v6 offset:0
    ds_read_b64_tr_b16 v[134:135], v6 offset:1024
    ds_read_b64_tr_b16 v[136:137], v5 offset:2048
    ds_read_b64_tr_b16 v[138:139], v5 offset:3072
    ds_read_b64_tr_b16 v[140:141], v6 offset:2048
    ds_read_b64_tr_b16 v[142:143], v6 offset:3072
    buffer_load_dwordx4 v[20:23], v7, s[12:15], s57 offen offset:1024 sc1
    s_waitcnt vmcnt(9)
    v_mfma_f32_32x32x16_bf16 v[48:63], v[144:147], v[180:183], v[48:63]
    v_mfma_f32_32x32x16_bf16 v[112:127], v[148:151], v[180:183], v[112:127]
    buffer_load_dwordx4 v[24:27], v7, s[12:15], s49 offen offset:1024 sc1
    buffer_load_dword v3, v2, s[12:15], s7 offen sc1
    s_waitcnt vmcnt(10)
    v_mfma_f32_32x32x16_bf16 v[32:47], v[152:155], v[184:187], v[32:47]
    v_mfma_f32_32x32x16_bf16 v[96:111], v[156:159], v[184:187], v[96:111]
    s_waitcnt vmcnt(9)
    v_mfma_f32_32x32x16_bf16 v[48:63], v[152:155], v[188:191], v[48:63]
    v_mfma_f32_32x32x16_bf16 v[112:127], v[156:159], v[188:191], v[112:127]
    s_waitcnt vmcnt(0)
    v_cmp_eq_u32 vcc, v3, v11
    s_nop 3
    s_cmp_eq_u64 vcc, exec
    s_cbranch_scc0 oc_43
    s_call_b64 s[18:19], o_issue
    s_branch oc_44
oc_43:
    buffer_load_dword v3, v2, s[12:15], s7 offen sc1
oc_44:
    s_waitcnt lgkmcnt(0)
    v_mfma_f32_32x32x16_bf16 v[32:47], v[160:163], v[192:195], v[32:47]
    v_mfma_f32_32x32x16_bf16 v[96:111], v[164:167], v[192:195], v[96:111]
    s_lshl_b64 exec, 1, s47
    ds_write_b32 v9, v8 offset:16
    s_mov_b64 exec, -1
    v_mfma_f32_32x32x16_bf16 v[48:63], v[160:163], v[196:199], v[48:63]
    v_mfma_f32_32x32x16_bf16 v[112:127], v[164:167], v[196:199], v[112:127]
    v_mfma_f32_32x32x16_bf16 v[32:47], v[168:171], v[200:203], v[32:47]
    v_mfma_f32_32x32x16_bf16 v[96:111], v[172:175], v[200:203], v[96:111]
    v_mfma_f32_32x32x16_bf16 v[48:63], v[168:171], v[204:207], v[48:63]
    v_mfma_f32_32x32x16_bf16 v[112:127], v[172:175], v[204:207], v[112:127]
    s_waitcnt lgkmcnt(0)
    v_mfma_f32_32x32x16_bf16 v[32:47], v[128:131], v[12:15], v[32:47]
    v_mfma_f32_32x32x16_bf16 v[96:111], v[132:135], v[12:15], v[96:111]
    s_cmp_eq_u32 s61, 0
    s_cbranch_scc0 oc_45
    s_waitcnt vmcnt(0)
    v_cmp_eq_u32 vcc, v3, v11
    s_nop 3
    s_cmp_eq_u64 vcc, exec
    s_cbranch_scc0 oc_45
    s_call_b64 s[18:19], o_issue
oc_45:
    v_mfma_f32_32x32x16_bf16 v[48:63], v[128:131], v[16:19], v[48:63]
    v_mfma_f32_32x32x16_bf16 v[112:127], v[132:135], v[16:19], v[112:127]
    v_mfma_f32_32x32x16_bf16 v[32:47], v[136:139], v[20:23], v[32:47]
    v_mfma_f32_32x32x16_bf16 v[96:111], v[140:143], v[20:23], v[96:111]
    s_mov_b32 s3, 2000000
cw_46:
    ds_read_b32 v6, v9 offset:48
    s_waitcnt lgkmcnt(0)
    v_cmp_eq_u32 vcc, v8, v6
    s_nop 3
    s_cmp_eq_u64 vcc, exec
    s_cbranch_scc1 cw_47
    s_sub_u32 s3, s3, 1
    s_cbranch_scc0 cw_46
cw_47:
    v_mfma_f32_32x32x16_bf16 v[48:63], v[136:139], v[24:27], v[48:63]
    v_mfma_f32_32x32x16_bf16 v[112:127], v[140:143], v[24:27], v[112:127]
    s_cmp_eq_u32 s61, 0
    s_cbranch_scc0 oh_48
    buffer_load_dword v10, v2, s[12:15], s7 offen sc1
    s_waitcnt vmcnt(0)
    v_cmp_eq_u32 vcc, v10, v11
    s_nop 3
    s_cmp_eq_u64 vcc, exec
    s_cbranch_scc1 pd_49
    s_mov_b32 s3, 200000
pl_50:
    s_sleep 1
    buffer_load_dword v10, v2, s[12:15], s7 offen sc1
    s_waitcnt vmcnt(0)
    v_cmp_eq_u32 vcc, v10, v11
    s_nop 3
    s_cmp_eq_u64 vcc, exec
    s_cbranch_scc1 pd_49
    s_sub_u32 s3, s3, 1
    s_cbranch_scc0 pl_50
pd_49:
    s_call_b64 s[18:19], o_issue
oh_48:
    s_waitcnt vmcnt(0) lgkmcnt(0)
    v_mfma_f32_32x32x16_bf16 v[32:47], v[64:67], v[208:211], v[32:47]
    v_mfma_f32_32x32x16_bf16 v[32:47], v[72:75], v[212:215], v[32:47]
    v_mfma_f32_32x32x16_bf16 v[32:47], v[80:83], v[216:219], v[32:47]
    v_mfma_f32_32x32x16_bf16 v[32:47], v[88:91], v[220:223], v[32:47]
    v_lshlrev_b32 v136, 16, v244
    v_and_b32 v137, 0xffff0000, v244
    v_lshlrev_b32 v138, 16, v245
    v_and_b32 v139, 0xffff0000, v245
    v_lshlrev_b32 v140, 16, v246
    v_and_b32 v141, 0xffff0000, v246
    v_lshlrev_b32 v142, 16, v247
    v_and_b32 v143, 0xffff0000, v247
    v_mfma_f32_32x32x16_bf16 v[96:111], v[68:71], v[208:211], v[96:111]
    v_mfma_f32_32x32x16_bf16 v[96:111], v[76:79], v[212:215], v[96:111]
    v_mfma_f32_32x32x16_bf16 v[96:111], v[84:87], v[216:219], v[96:111]
    v_mfma_f32_32x32x16_bf16 v[96:111], v[92:95], v[220:223], v[96:111]
    v_mfma_f32_32x32x16_bf16 v[48:63], v[64:67], v[224:227], v[48:63]
    v_mfma_f32_32x32x16_bf16 v[48:63], v[72:75], v[228:231], v[48:63]
    v_mfma_f32_32x32x16_bf16 v[48:63], v[80:83], v[232:235], v[48:63]
    v_mfma_f32_32x32x16_bf16 v[48:63], v[88:91], v[236:239], v[48:63]
    ds_write_b128 v248, v[32:35]
    ds_write_b128 v249, v[36:39]
    ds_write_b128 v250, v[40:43]
    ds_write_b128 v251, v[44:47]
    v_mfma_f32_32x32x16_bf16 v[112:127], v[68:71], v[224:227], v[112:127]
    v_mfma_f32_32x32x16_bf16 v[112:127], v[76:79], v[228:231], v[112:127]
    v_mfma_f32_32x32x16_bf16 v[112:127], v[84:87], v[232:235], v[112:127]
    v_mfma_f32_32x32x16_bf16 v[112:127], v[92:95], v[236:239], v[112:127]
    ds_write_b128 v248, v[96:99] offset:16384
    ds_write_b128 v249, v[100:103] offset:16384
    ds_write_b128 v250, v[104:107] offset:16384
    ds_write_b128 v251, v[108:111] offset:16384
    ds_write_b128 v248, v[48:51] offset:32768
    ds_write_b128 v249, v[52:55] offset:32768
    ds_write_b128 v250, v[56:59] offset:32768
    ds_write_b128 v251, v[60:63] offset:32768
    s_nop 3
    ds_write_b128 v248, v[112:115] offset:49152
    ds_write_b128 v249, v[116:119] offset:49152
    ds_write_b128 v250, v[120:123] offset:49152
    ds_write_b128 v251, v[124:127] offset:49152
    s_xor_b32 s57, s52, 16384
    s_add_u32 s49, s57, 8192
    s_waitcnt lgkmcnt(0)
    s_lshl_b64 exec, 1, s47
    ds_write_b32 v9, v8 offset:0
    s_mov_b64 exec, -1
    s_mov_b32 s3, 2000000
cw_51:
    ds_read_b32 v6, v9 offset:0
    s_waitcnt lgkmcnt(0)
    v_cmp_eq_u32 vcc, v8, v6
    s_nop 3
    s_cmp_eq_u64 vcc, exec
    s_cbranch_scc1 cw_52
    s_sub_u32 s3, s3, 1
    s_cbranch_scc0 cw_51
cw_52:
    ds_read_b128 v[32:35], v28 offset:0
    ds_read_b128 v[36:39], v29 offset:0
    ds_read_b128 v[40:43], v28 offset:4096
    ds_read_b128 v[44:47], v29 offset:4096
    ds_read_b128 v[48:51], v28 offset:8192
    ds_read_b128 v[52:55], v29 offset:8192
    ds_read_b128 v[56:59], v28 offset:12288
    ds_read_b128 v[60:63], v29 offset:12288
    ds_read_b128 v[96:99], v28 offset:32768
    ds_read_b128 v[100:103], v29 offset:32768
    ds_read_b128 v[104:107], v28 offset:36864
    ds_read_b128 v[108:111], v29 offset:36864
    ds_read_b128 v[112:115], v28 offset:40960
    ds_read_b128 v[116:119], v29 offset:40960
    ds_read_b128 v[120:123], v28 offset:45056
    ds_read_b128 v[124:127], v29 offset:45056
    s_waitcnt lgkmcnt(12)
    v_add_f32 v32, v32, v40
    v_add_f32 v33, v33, v41
    v_add_f32 v34, v34, v42
    v_add_f32 v35, v35, v43
    v_add_f32 v36, v36, v44
    v_add_f32 v37, v37, v45
    v_add_f32 v38, v38, v46
    v_add_f32 v39, v39, v47
    s_waitcnt lgkmcnt(10)
    v_add_f32 v32, v32, v48
    v_add_f32 v33, v33, v49
    v_add_f32 v34, v34, v50
    v_add_f32 v35, v35, v51
    v_add_f32 v36, v36, v52
    v_add_f32 v37, v37, v53
    v_add_f32 v38, v38, v54
    v_add_f32 v39, v39, v55
    s_waitcnt lgkmcnt(8)
    v_add_f32 v32, v32, v56
    v_add_f32 v33, v33, v57
    v_add_f32 v34, v34, v58
    v_add_f32 v35, v35, v59
    v_add_f32 v36, v36, v60
    v_add_f32 v37, v37, v61
    v_add_f32 v38, v38, v62
    v_add_f32 v39, v39, v63
    v_perm_b32 v32, v32, v11, s8
    v_perm_b32 v33, v33, v11, s9
    v_perm_b32 v34, v34, v11, s10
    v_perm_b32 v35, v35, v11, s11
    buffer_store_dwordx4 v[32:35], v7, s[12:15], s57 offen offset:0 sc1
    v_perm_b32 v36, v36, v11, s8
    v_perm_b32 v37, v37, v11, s9
    v_perm_b32 v38, v38, v11, s10
    v_perm_b32 v39, v39, v11, s11
    buffer_store_dwordx4 v[36:39], v7, s[12:15], s57 offen offset:1024 sc1
    s_waitcnt lgkmcnt(4)
    v_add_f32 v96, v96, v104
    v_add_f32 v97, v97, v105
    v_add_f32 v98, v98, v106
    v_add_f32 v99, v99, v107
    v_add_f32 v100, v100, v108
    v_add_f32 v101, v101, v109
    v_add_f32 v102, v102, v110
    v_add_f32 v103, v103, v111
    s_waitcnt lgkmcnt(2)
    v_add_f32 v96, v96, v112
    v_add_f32 v97, v97, v113
    v_add_f32 v98, v98, v114
    v_add_f32 v99, v99, v115
    v_add_f32 v100, v100, v116
    v_add_f32 v101, v101, v117
    v_add_f32 v102, v102, v118
    v_add_f32 v103, v103, v119
    s_waitcnt lgkmcnt(0)
    v_add_f32 v96, v96, v120
    v_add_f32 v97, v97, v121
    v_add_f32 v98, v98, v122
    v_add_f32 v99, v99, v123
    v_add_f32 v100, v100, v124
    v_add_f32 v101, v101, v125
    v_add_f32 v102, v102, v126
    v_add_f32 v103, v103, v127
    v_perm_b32 v96, v96, v11, s8
    v_perm_b32 v97, v97, v11, s9
    v_perm_b32 v98, v98, v11, s10
    v_perm_b32 v99, v99, v11, s11
    buffer_store_dwordx4 v[96:99], v7, s[12:15], s49 offen offset:0 sc1
    v_perm_b32 v100, v100, v11, s8
    v_perm_b32 v101, v101, v11, s9
    v_perm_b32 v102, v102, v11, s10
    v_perm_b32 v103, v103, v11, s11
    buffer_store_dwordx4 v[100:103], v7, s[12:15], s49 offen offset:1024 sc1
    s_branch join_f
loop_1:
    s_waitcnt vmcnt(63)
    v_cmp_eq_u32 vcc, v10, v11
    s_nop 3
    s_cmp_eq_u32 vcc_lo, -1
    s_cbranch_scc1 pd_53
    s_mov_b32 s3, 200000
pl_54:
    s_sleep 1
    buffer_load_dword v10, v2, s[12:15], s7 offen sc1
    s_waitcnt vmcnt(0)
    v_cmp_eq_u32 vcc, v10, v11
    s_nop 3
    s_cmp_eq_u32 vcc_lo, -1
    s_cbranch_scc1 pd_53
    s_sub_u32 s3, s3, 1
    s_cbranch_scc0 pl_54
pd_53:
    s_bfe_u32 s57, s46, 0x40000
    s_lshl_b32 s57, s57, 11
    s_add_u32 s57, s57, s56
    s_add_u32 s49, s57, s48
    buffer_load_dwordx4 v[12:15], v7, s[12:15], s57 offen offset:0 sc1
    buffer_load_dwordx4 v[16:19], v7, s[12:15], s49 offen offset:0 sc1
    buffer_load_dwordx4 v[20:23], v7, s[12:15], s57 offen offset:1024 sc1
    buffer_load_dwordx4 v[24:27], v7, s[12:15], s49 offen offset:1024 sc1
    s_bfe_u32 s57, s46, 0x40004
    s_lshl_b32 s57, s57, 11
    s_add_u32 s57, s57, s56
    s_add_u32 s49, s57, s48
    buffer_load_dwordx4 v[176:179], v7, s[12:15], s57 offen offset:0 sc1
    buffer_load_dwordx4 v[180:183], v7, s[12:15], s49 offen offset:0 sc1
    buffer_load_dword v10, v2, s[12:15], s7 offen sc1
    s_mov_b32 s3, 2000000
cw_55:
    ds_read_b32 v6, v9 offset:32
    s_waitcnt lgkmcnt(0)
    v_cmp_eq_u32 vcc, v8, v6
    s_nop 3
    s_cmp_eq_u64 vcc, exec
    s_cbranch_scc1 cw_56
    s_sub_u32 s3, s3, 1
    s_cbranch_scc0 cw_55
cw_56:
    v_add_u32 v5, 16384, v4
    v_xor_b32 v6, 64, v5
    ds_read_b64_tr_b16 v[128:129], v5 offset:0
    ds_read_b64_tr_b16 v[130:131], v5 offset:1024
    ds_read_b64_tr_b16 v[132:133], v6 offset:0
    ds_read_b64_tr_b16 v[134:135], v6 offset:1024
    ds_read_b64_tr_b16 v[136:137], v5 offset:2048
    ds_read_b64_tr_b16 v[138:139], v5 offset:3072
    ds_read_b64_tr_b16 v[140:141], v6 offset:2048
    ds_read_b64_tr_b16 v[142:143], v6 offset:3072
    v_add_u32 v5, 32768, v4
    v_xor_b32 v6, 64, v5
    ds_read_b64_tr_b16 v[144:145], v5 offset:0
    ds_read_b64_tr_b16 v[146:147], v5 offset:1024
    ds_read_b64_tr_b16 v[148:149], v6 offset:0
    ds_read_b64_tr_b16 v[150:151], v6 offset:1024
    ds_read_b64_tr_b16 v[152:153], v5 offset:2048
    ds_read_b64_tr_b16 v[154:155], v5 offset:3072
    ds_read_b64_tr_b16 v[156:157], v6 offset:2048
    ds_read_b64_tr_b16 v[158:159], v6 offset:3072
    v_add_u32 v5, 49152, v4
    v_xor_b32 v6, 64, v5
    ds_read_b64_tr_b16 v[160:161], v5 offset:0
    ds_read_b64_tr_b16 v[162:163], v5 offset:1024
    ds_read_b64_tr_b16 v[164:165], v6 offset:0
    ds_read_b64_tr_b16 v[166:167], v6 offset:1024
    ds_read_b64_tr_b16 v[168:169], v5 offset:2048
    ds_read_b64_tr_b16 v[170:171], v5 offset:3072
    ds_read_b64_tr_b16 v[172:173], v6 offset:2048
    ds_read_b64_tr_b16 v[174:175], v6 offset:3072
    v_bfe_u32 v240, v0, 3, 5
    v_and_b32 v241, 7, v0
    v_lshlrev_b32 v241, 4, v241
    s_lshl_b32 s63, s54, 7
    buffer_load_dwordx4 v[244:247], v241, s[32:35], s63 offen
    v_and_b32 v28, 31, v1
    v_bfe_u32 v29, v1, 1, 2
    v_and_b32 v30, 1, v1
    v_lshl_add_u32 v29, v30, 2, v29
    v_lshrrev_b32 v30, 5, v1
    v_xor_b32 v29, v29, v30
    v_lshlrev_b32 v29, 4, v29
    s_and_b32 s64, s47, 3
    s_lshl_b32 s64, s64, 12
    s_and_b32 s62, s47, 4
    s_lshl_b32 s62, s62, 14
    s_add_u32 s64, s64, s62
    v_lshl_add_u32 v248, v28, 7, v29
    v_add_u32 v248, s64, v248
    v_xor_b32 v249, 32, v248
    v_xor_b32 v250, 64, v248
    v_xor_b32 v251, 96, v248
    v_bfe_u32 v29, v240, 1, 2
    v_and_b32 v30, 1, v240
    v_lshl_add_u32 v29, v30, 2, v29
    v_and_b32 v30, 3, v0
    v_lshlrev_b32 v30, 1, v30
    v_xor_b32 v29, v29, v30
    v_lshlrev_b32 v28, 7, v240
    v_lshl_add_u32 v28, v29, 4, v28
    v_and_b32 v29, 4, v0
    v_lshlrev_b32 v29, 12, v29
    v_add_u32 v28, v28, v29
    v_xor_b32 v29, 16, v28
    s_and_b32 s62, s47, 4
    s_lshl_b32 s62, s62, 13
    s_add_u32 s62, s62, 65536
    v_add_u32 v30, s62, v28
    v_xor_b32 v31, 16, v30
    v_lshlrev_b32 v242, 2, v240
    v_mul_u32_u24 v240, 896, v240
    v_add_u32 v240, v240, v241
    s_lshr_b32 s62, s53, 16
    s_mul_i32 s51, s62, 28672
    s_lshl_b32 s63, s54, 7
    s_add_u32 s51, s51, s63
    s_and_b32 s64, s2, 1
    s_lshl_b32 s64, s64, 2
    s_and_b32 s63, s47, 3
    s_add_u32 s64, s64, s63
    s_lshr_b32 s63, s62, 2
    s_lshl_b32 s63, s63, 3
    s_add_u32 s63, s63, s64
    s_lshl_b32 s63, s63, 2
    s_and_b32 s62, s62, 3
    s_add_u32 s63, s63, s62
    s_lshl_b32 s63, s63, 7
    s_add_u32 s60, s63, 0x1400000
    s_lshl_b32 s52, s2, 14
    s_lshl_b32 s62, s55, 1
    s_add_u32 s52, s52, s62
    s_add_u32 s52, s52, 0x1000000
    s_mov_b32 s20, 0x0c0c0400
    s_mov_b32 s21, 0x04000c0c
    s_mov_b32 s22, -1
    s_mov_b32 s23, s22
    s_waitcnt lgkmcnt(0)
    s_waitcnt vmcnt(7)
    v_mfma_f32_32x32x16_bf16 v[32:47], v[128:131], v[12:15], 0
    v_mfma_f32_32x32x16_bf16 v[96:111], v[132:135], v[12:15], 0
    s_lshl_b64 exec, 1, s47
    ds_write_b32 v9, v8 offset:48
    s_mov_b64 exec, -1
    buffer_load_dwordx4 v[184:187], v7, s[12:15], s57 offen offset:1024 sc1
    s_waitcnt vmcnt(7)
    v_mfma_f32_32x32x16_bf16 v[48:63], v[128:131], v[16:19], 0
    v_mfma_f32_32x32x16_bf16 v[112:127], v[132:135], v[16:19], 0
    buffer_load_dwordx4 v[188:191], v7, s[12:15], s49 offen offset:1024 sc1
    s_waitcnt vmcnt(7)
    v_mfma_f32_32x32x16_bf16 v[32:47], v[136:139], v[20:23], v[32:47]
    v_mfma_f32_32x32x16_bf16 v[96:111], v[140:143], v[20:23], v[96:111]
    s_bfe_u32 s57, s46, 0x40008
    s_lshl_b32 s57, s57, 11
    s_add_u32 s57, s57, s56
    s_add_u32 s49, s57, s48
    buffer_load_dwordx4 v[192:195], v7, s[12:15], s57 offen offset:0 sc1
    s_waitcnt vmcnt(7)
    v_mfma_f32_32x32x16_bf16 v[48:63], v[136:139], v[24:27], v[48:63]
    v_mfma_f32_32x32x16_bf16 v[112:127], v[140:143], v[24:27], v[112:127]
    buffer_load_dwordx4 v[196:199], v7, s[12:15], s49 offen offset:0 sc1
    s_waitcnt vmcnt(7)
    v_mfma_f32_32x32x16_bf16 v[32:47], v[144:147], v[176:179], v[32:47]
    v_mfma_f32_32x32x16_bf16 v[96:111], v[148:151], v[176:179], v[96:111]
    v_add_u32 v5, 65536, v4
    v_xor_b32 v6, 64, v5
    ds_read_b64_tr_b16 v[128:129], v5 offset:0
    ds_read_b64_tr_b16 v[130:131], v5 offset:1024
    ds_read_b64_tr_b16 v[132:133], v6 offset:0
    ds_read_b64_tr_b16 v[134:135], v6 offset:1024
    ds_read_b64_tr_b16 v[136:137], v5 offset:2048
    ds_read_b64_tr_b16 v[138:139], v5 offset:3072
    ds_read_b64_tr_b16 v[140:141], v6 offset:2048
    ds_read_b64_tr_b16 v[142:143], v6 offset:3072
    buffer_load_dwordx4 v[200:203], v7, s[12:15], s57 offen offset:1024 sc1
    s_waitcnt vmcnt(7)
    v_mfma_f32_32x32x16_bf16 v[48:63], v[144:147], v[180:183], v[48:63]
    v_mfma_f32_32x32x16_bf16 v[112:127], v[148:151], v[180:183], v[112:127]
    buffer_load_dwordx4 v[204:207], v7, s[12:15], s49 offen offset:1024 sc1
    s_waitcnt vmcnt(5)
    v_mfma_f32_32x32x16_bf16 v[32:47], v[152:155], v[184:187], v[32:47]
    v_mfma_f32_32x32x16_bf16 v[96:111], v[156:159], v[184:187], v[96:111]
    s_bfe_u32 s57, s46, 0x4000c
    s_lshl_b32 s57, s57, 11
    s_add_u32 s57, s57, s56
    s_add_u32 s49, s57, s48
    buffer_load_dwordx4 v[12:15], v7, s[12:15], s57 offen offset:0 sc1
    s_waitcnt vmcnt(5)
    v_mfma_f32_32x32x16_bf16 v[48:63], v[152:155], v[188:191], v[48:63]
    v_mfma_f32_32x32x16_bf16 v[112:127], v[156:159], v[188:191], v[112:127]
    buffer_load_dwordx4 v[16:19], v7, s[12:15], s49 offen offset:0 sc1
    s_waitcnt vmcnt(5)
    v_mfma_f32_32x32x16_bf16 v[32:47], v[160:163], v[192:195], v[32:47]
    v_mfma_f32_32x32x16_bf16 v[96:111], v[164:167], v[192:195], v[96:111]
    v_add_u32 v5, 81920, v4
    v_xor_b32 v6, 64, v5
    ds_read_b64_tr_b16 v[144:145], v5 offset:0
    ds_read_b64_tr_b16 v[146:147], v5 offset:1024
    ds_read_b64_tr_b16 v[148:149], v6 offset:0
    ds_read_b64_tr_b16 v[150:151], v6 offset:1024
    ds_read_b64_tr_b16 v[152:153], v5 offset:2048
    ds_read_b64_tr_b16 v[154:155], v5 offset:3072
    ds_read_b64_tr_b16 v[156:157], v6 offset:2048
    ds_read_b64_tr_b16 v[158:159], v6 offset:3072
    buffer_load_dwordx4 v[20:23], v7, s[12:15], s57 offen offset:1024 sc1
    s_waitcnt vmcnt(5)
    v_mfma_f32_32x32x16_bf16 v[48:63], v[160:163], v[196:199], v[48:63]
    v_mfma_f32_32x32x16_bf16 v[112:127], v[164:167], v[196:199], v[112:127]
    buffer_load_dwordx4 v[24:27], v7, s[12:15], s49 offen offset:1024 sc1
    s_waitcnt vmcnt(5)
    v_mfma_f32_32x32x16_bf16 v[32:47], v[168:171], v[200:203], v[32:47]
    v_mfma_f32_32x32x16_bf16 v[96:111], v[172:175], v[200:203], v[96:111]
    s_waitcnt vmcnt(11)
    v_cmp_eq_u32 vcc, v10, v11
    s_nop 3
    s_cmp_eq_u64 vcc, exec
    s_cbranch_scc1 pd_57
    s_mov_b32 s3, 200000
pl_58:
    s_sleep 1
    buffer_load_dword v10, v2, s[12:15], s7 offen sc1
    s_waitcnt vmcnt(0)
    v_cmp_eq_u32 vcc, v10, v11
    s_nop 3
    s_cmp_eq_u64 vcc, exec
    s_cbranch_scc1 pd_57
    s_sub_u32 s3, s3, 1
    s_cbranch_scc0 pl_58
pd_57:
    s_add_u32 s7, s7, 65536
    v_or_b32 v2, 16, v2
    s_bfe_u32 s57, s46, 0x40010
    s_lshl_b32 s57, s57, 11
    s_add_u32 s57, s57, s56
    s_add_u32 s49, s57, s48
    buffer_load_dwordx4 v[176:179], v7, s[12:15], s57 offen offset:0 sc1
    s_waitcnt vmcnt(5)
    v_mfma_f32_32x32x16_bf16 v[48:63], v[168:171], v[204:207], v[48:63]
    v_mfma_f32_32x32x16_bf16 v[112:127], v[172:175], v[204:207], v[112:127]
    buffer_load_dwordx4 v[180:183], v7, s[12:15], s49 offen offset:0 sc1
    s_waitcnt lgkmcnt(0)
    s_waitcnt vmcnt(5)
    v_mfma_f32_32x32x16_bf16 v[32:47], v[128:131], v[12:15], v[32:47]
    v_mfma_f32_32x32x16_bf16 v[96:111], v[132:135], v[12:15], v[96:111]
    v_add_u32 v5, 98304, v4
    v_xor_b32 v6, 64, v5
    ds_read_b64_tr_b16 v[160:161], v5 offset:0
    ds_read_b64_tr_b16 v[162:163], v5 offset:1024
    ds_read_b64_tr_b16 v[164:165], v6 offset:0
    ds_read_b64_tr_b16 v[166:167], v6 offset:1024
    ds_read_b64_tr_b16 v[168:169], v5 offset:2048
    ds_read_b64_tr_b16 v[170:171], v5 offset:3072
    ds_read_b64_tr_b16 v[172:173], v6 offset:2048
    ds_read_b64_tr_b16 v[174:175], v6 offset:3072
    buffer_load_dwordx4 v[184:187], v7, s[12:15], s57 offen offset:1024 sc1
    s_waitcnt vmcnt(5)
    v_mfma_f32_32x32x16_bf16 v[48:63], v[128:131], v[16:19], v[48:63]
    v_mfma_f32_32x32x16_bf16 v[112:127], v[132:135], v[16:19], v[112:127]
    buffer_load_dwordx4 v[188:191], v7, s[12:15], s49 offen offset:1024 sc1
    s_waitcnt vmcnt(5)
    v_mfma_f32_32x32x16_bf16 v[32:47], v[136:139], v[20:23], v[32:47]
    v_mfma_f32_32x32x16_bf16 v[96:111], v[140:143], v[20:23], v[96:111]
    s_bfe_u32 s57, s46, 0x40014
    s_lshl_b32 s57, s57, 11
    s_add_u32 s57, s57, s56
    s_add_u32 s49, s57, s48
    buffer_load_dwordx4 v[192:195], v7, s[12:15], s57 offen offset:0 sc1
    s_waitcnt vmcnt(5)
    v_mfma_f32_32x32x16_bf16 v[48:63], v[136:139], v[24:27], v[48:63]
    v_mfma_f32_32x32x16_bf16 v[112:127], v[140:143], v[24:27], v[112:127]
    buffer_load_dwordx4 v[196:199], v7, s[12:15], s49 offen offset:0 sc1
    s_waitcnt lgkmcnt(0)
    s_waitcnt vmcnt(5)
    v_mfma_f32_32x32x16_bf16 v[32:47], v[144:147], v[176:179], v[32:47]
    v_mfma_f32_32x32x16_bf16 v[96:111], v[148:151], v[176:179], v[96:111]
    v_add_u32 v5, 114688, v4
    v_xor_b32 v6, 64, v5
    ds_read_b64_tr_b16 v[128:129], v5 offset:0
    ds_read_b64_tr_b16 v[130:131], v5 offset:1024
    ds_read_b64_tr_b16 v[132:133], v6 offset:0
    ds_read_b64_tr_b16 v[134:135], v6 offset:1024
    ds_read_b64_tr_b16 v[136:137], v5 offset:2048
    ds_read_b64_tr_b16 v[138:139], v5 offset:3072
    ds_read_b64_tr_b16 v[140:141], v6 offset:2048
    ds_read_b64_tr_b16 v[142:143], v6 offset:3072
    buffer_load_dwordx4 v[200:203], v7, s[12:15], s57 offen offset:1024 sc1
    s_waitcnt vmcnt(5)
    v_mfma_f32_32x32x16_bf16 v[48:63], v[144:147], v[180:183], v[48:63]
    v_mfma_f32_32x32x16_bf16 v[112:127], v[148:151], v[180:183], v[112:127]
    buffer_load_dwordx4 v[204:207], v7, s[12:15], s49 offen offset:1024 sc1
    s_waitcnt vmcnt(5)
    v_mfma_f32_32x32x16_bf16 v[32:47], v[152:155], v[184:187], v[32:47]
    v_mfma_f32_32x32x16_bf16 v[96:111], v[156:159], v[184:187], v[96:111]
    s_bfe_u32 s57, s46, 0x40018
    s_lshl_b32 s57, s57, 11
    s_add_u32 s57, s57, s56
    s_add_u32 s49, s57, s48
    buffer_load_dwordx4 v[12:15], v7, s[12:15], s57 offen offset:0 sc1
    s_waitcnt vmcnt(5)
    v_mfma_f32_32x32x16_bf16 v[48:63], v[152:155], v[188:191], v[48:63]
    v_mfma_f32_32x32x16_bf16 v[112:127], v[156:159], v[188:191], v[112:127]
    buffer_load_dwordx4 v[16:19], v7, s[12:15], s49 offen offset:0 sc1
    s_waitcnt lgkmcnt(0)
    s_waitcnt vmcnt(5)
    v_mfma_f32_32x32x16_bf16 v[32:47], v[160:163], v[192:195], v[32:47]
    v_mfma_f32_32x32x16_bf16 v[96:111], v[164:167], v[192:195], v[96:111]
    buffer_load_dwordx4 v[20:23], v7, s[12:15], s57 offen offset:1024 sc1
    s_waitcnt vmcnt(5)
    v_mfma_f32_32x32x16_bf16 v[48:63], v[160:163], v[196:199], v[48:63]
    v_mfma_f32_32x32x16_bf16 v[112:127], v[164:167], v[196:199], v[112:127]
    buffer_load_dwordx4 v[24:27], v7, s[12:15], s49 offen offset:1024 sc1
    buffer_load_dword v3, v2, s[12:15], s7 offen sc1
    s_waitcnt vmcnt(6)
    v_mfma_f32_32x32x16_bf16 v[32:47], v[168:171], v[200:203], v[32:47]
    v_mfma_f32_32x32x16_bf16 v[96:111], v[172:175], v[200:203], v[96:111]
    s_waitcnt vmcnt(0)
    v_cmp_eq_u32 vcc, v3, v11
    s_nop 3
    s_cmp_eq_u64 vcc, exec
    s_cbranch_scc0 oc_59
    s_call_b64 s[18:19], o_issue
    s_branch oc_60
oc_59:
    buffer_load_dword v3, v2, s[12:15], s7 offen sc1
oc_60:
    v_mfma_f32_32x32x16_bf16 v[48:63], v[168:171], v[204:207], v[48:63]
    v_mfma_f32_32x32x16_bf16 v[112:127], v[172:175], v[204:207], v[112:127]
    s_waitcnt lgkmcnt(0)
    v_mfma_f32_32x32x16_bf16 v[32:47], v[128:131], v[12:15], v[32:47]
    v_mfma_f32_32x32x16_bf16 v[96:111], v[132:135], v[12:15], v[96:111]
    v_mfma_f32_32x32x16_bf16 v[48:63], v[128:131], v[16:19], v[48:63]
    v_mfma_f32_32x32x16_bf16 v[112:127], v[132:135], v[16:19], v[112:127]
    v_mfma_f32_32x32x16_bf16 v[32:47], v[136:139], v[20:23], v[32:47]
    v_mfma_f32_32x32x16_bf16 v[96:111], v[140:143], v[20:23], v[96:111]
    s_cmp_eq_u32 s61, 0
    s_cbranch_scc0 oc_61
    s_waitcnt vmcnt(0)
    v_cmp_eq_u32 vcc, v3, v11
    s_nop 3
    s_cmp_eq_u64 vcc, exec
    s_cbranch_scc0 oc_61
    s_call_b64 s[18:19], o_issue
oc_61:
    s_mov_b32 s3, 2000000
cw_62:
    ds_read_b32 v6, v9 offset:16
    s_waitcnt lgkmcnt(0)
    v_cmp_eq_u32 vcc, v8, v6
    s_nop 3
    s_cmp_eq_u64 vcc, exec
    s_cbranch_scc1 cw_63
    s_sub_u32 s3, s3, 1
    s_cbranch_scc0 cw_62
cw_63:
    v_mfma_f32_32x32x16_bf16 v[48:63], v[136:139], v[24:27], v[48:63]
    v_mfma_f32_32x32x16_bf16 v[112:127], v[140:143], v[24:27], v[112:127]
    s_cmp_eq_u32 s61, 0
    s_cbranch_scc0 oh_64
    buffer_load_dword v10, v2, s[12:15], s7 offen sc1
    s_waitcnt vmcnt(0)
    v_cmp_eq_u32 vcc, v10, v11
    s_nop 3
    s_cmp_eq_u64 vcc, exec
    s_cbranch_scc1 pd_65
    s_mov_b32 s3, 200000
pl_66:
    s_sleep 1
    buffer_load_dword v10, v2, s[12:15], s7 offen sc1
    s_waitcnt vmcnt(0)
    v_cmp_eq_u32 vcc, v10, v11
    s_nop 3
    s_cmp_eq_u64 vcc, exec
    s_cbranch_scc1 pd_65
    s_sub_u32 s3, s3, 1
    s_cbranch_scc0 pl_66
pd_65:
    s_call_b64 s[18:19], o_issue
oh_64:
    s_waitcnt vmcnt(0) lgkmcnt(0)
    v_mfma_f32_32x32x16_bf16 v[32:47], v[64:67], v[208:211], v[32:47]
    v_mfma_f32_32x32x16_bf16 v[32:47], v[72:75], v[212:215], v[32:47]
    v_mfma_f32_32x32x16_bf16 v[32:47], v[80:83], v[216:219], v[32:47]
    v_mfma_f32_32x32x16_bf16 v[32:47], v[88:91], v[220:223], v[32:47]
    v_lshlrev_b32 v136, 16, v244
    v_and_b32 v137, 0xffff0000, v244
    v_lshlrev_b32 v138, 16, v245
    v_and_b32 v139, 0xffff0000, v245
    v_lshlrev_b32 v140, 16, v246
    v_and_b32 v141, 0xffff0000, v246
    v_lshlrev_b32 v142, 16, v247
    v_and_b32 v143, 0xffff0000, v247
    v_mfma_f32_32x32x16_bf16 v[96:111], v[68:71], v[208:211], v[96:111]
    v_mfma_f32_32x32x16_bf16 v[96:111], v[76:79], v[212:215], v[96:111]
    v_mfma_f32_32x32x16_bf16 v[96:111], v[84:87], v[216:219], v[96:111]
    v_mfma_f32_32x32x16_bf16 v[96:111], v[92:95], v[220:223], v[96:111]
    v_mfma_f32_32x32x16_bf16 v[48:63], v[64:67], v[224:227], v[48:63]
    v_mfma_f32_32x32x16_bf16 v[48:63], v[72:75], v[228:231], v[48:63]
    v_mfma_f32_32x32x16_bf16 v[48:63], v[80:83], v[232:235], v[48:63]
    v_mfma_f32_32x32x16_bf16 v[48:63], v[88:91], v[236:239], v[48:63]
    ds_write_b128 v248, v[32:35]
    ds_write_b128 v249, v[36:39]
    ds_write_b128 v250, v[40:43]
    ds_write_b128 v251, v[44:47]
    v_mfma_f32_32x32x16_bf16 v[112:127], v[68:71], v[224:227], v[112:127]
    v_mfma_f32_32x32x16_bf16 v[112:127], v[76:79], v[228:231], v[112:127]
    v_mfma_f32_32x32x16_bf16 v[112:127], v[84:87], v[232:235], v[112:127]
    v_mfma_f32_32x32x16_bf16 v[112:127], v[92:95], v[236:239], v[112:127]
    ds_write_b128 v248, v[96:99] offset:16384
    ds_write_b128 v249, v[100:103] offset:16384
    ds_write_b128 v250, v[104:107] offset:16384
    ds_write_b128 v251, v[108:111] offset:16384
    ds_write_b128 v248, v[48:51] offset:32768
    ds_write_b128 v249, v[52:55] offset:32768
    ds_write_b128 v250, v[56:59] offset:32768
    ds_write_b128 v251, v[60:63] offset:32768
    s_nop 3
    ds_write_b128 v248, v[112:115] offset:49152
    ds_write_b128 v249, v[116:119] offset:49152
    ds_write_b128 v250, v[120:123] offset:49152
    ds_write_b128 v251, v[124:127] offset:49152
    s_branch join_f
loop_2:
    s_waitcnt vmcnt(63)
    v_cmp_eq_u32 vcc, v10, v11
    s_nop 3
    s_cmp_eq_u32 vcc_lo, -1
    s_cbranch_scc1 pd_67
    s_mov_b32 s3, 200000
pl_68:
    s_cmp_eq_u32 s67, 3
    s_cbranch_scc0 ff_69
    s_waitcnt vmcnt(0)
    s_call_b64 s[18:19], o_flag
ff_69:
    s_sleep 1
    buffer_load_dword v10, v2, s[12:15], s7 offen sc1
    s_waitcnt vmcnt(0)
    v_cmp_eq_u32 vcc, v10, v11
    s_nop 3
    s_cmp_eq_u32 vcc_lo, -1
    s_cbranch_scc1 pd_67
    s_sub_u32 s3, s3, 1
    s_cbranch_scc0 pl_68
pd_67:
    s_bfe_u32 s57, s46, 0x40000
    s_lshl_b32 s57, s57, 11
    s_add_u32 s57, s57, s56
    buffer_load_dwordx4 v[12:15], v7, s[12:15], s57 offen offset:0 sc1
    buffer_load_dword v10, v2, s[12:15], s7 offen sc1
    buffer_load_dwordx4 v[16:19], v7, s[12:15], s57 offen offset:1024 sc1
    s_bfe_u32 s57, s46, 0x40004
    s_lshl_b32 s57, s57, 11
    s_add_u32 s57, s57, s56
    buffer_load_dwordx4 v[20:23], v7, s[12:15], s57 offen offset:0 sc1
    buffer_load_dwordx4 v[24:27], v7, s[12:15], s57 offen offset:1024 sc1
    s_cmp_eq_u32 s67, 3
    s_cbranch_scc0 ff_70
    s_waitcnt vmcnt(5)
    s_call_b64 s[18:19], o_flag
ff_70:
    s_bfe_u32 s57, s46, 0x40008
    s_lshl_b32 s57, s57, 11
    s_add_u32 s57, s57, s56
    buffer_load_dwordx4 v[176:179], v7, s[12:15], s57 offen offset:0 sc1
    buffer_load_dwordx4 v[180:183], v7, s[12:15], s57 offen offset:1024 sc1
    s_bfe_u32 s57, s46, 0x4000c
    s_lshl_b32 s57, s57, 11
    s_add_u32 s57, s57, s56
    buffer_load_dwordx4 v[184:187], v7, s[12:15], s57 offen offset:0 sc1
    s_mov_b32 s3, 2000000
cw_71:
    ds_read_b32 v6, v9 offset:32
    s_waitcnt lgkmcnt(0)
    v_cmp_eq_u32 vcc, v8, v6
    s_nop 3
    s_cmp_eq_u64 vcc, exec
    s_cbranch_scc1 cw_72
    s_sub_u32 s3, s3, 1
    s_cbranch_scc0 cw_71
cw_72:
    v_add_u32 v5, 16384, v4
    v_xor_b32 v6, 64, v5
    ds_read_b64_tr_b16 v[128:129], v5 offset:0
    ds_read_b64_tr_b16 v[130:131], v5 offset:1024
    ds_read_b64_tr_b16 v[132:133], v6 offset:0
    ds_read_b64_tr_b16 v[134:135], v6 offset:1024
    ds_read_b64_tr_b16 v[136:137], v5 offset:2048
    ds_read_b64_tr_b16 v[138:139], v5 offset:3072
    ds_read_b64_tr_b16 v[140:141], v6 offset:2048
    ds_read_b64_tr_b16 v[142:143], v6 offset:3072
    v_add_u32 v5, 32768, v4
    v_xor_b32 v6, 64, v5
    ds_read_b64_tr_b16 v[144:145], v5 offset:0
    ds_read_b64_tr_b16 v[146:147], v5 offset:1024
    ds_read_b64_tr_b16 v[148:149], v6 offset:0
    ds_read_b64_tr_b16 v[150:151], v6 offset:1024
    ds_read_b64_tr_b16 v[152:153], v5 offset:2048
    ds_read_b64_tr_b16 v[154:155], v5 offset:3072
    ds_read_b64_tr_b16 v[156:157], v6 offset:2048
    ds_read_b64_tr_b16 v[158:159], v6 offset:3072
    v_add_u32 v5, 49152, v4
    v_xor_b32 v6, 64, v5
    ds_read_b64_tr_b16 v[160:161], v5 offset:0
    ds_read_b64_tr_b16 v[162:163], v5 offset:1024
    ds_read_b64_tr_b16 v[164:165], v6 offset:0
    ds_read_b64_tr_b16 v[166:167], v6 offset:1024
    ds_read_b64_tr_b16 v[168:169], v5 offset:2048
    ds_read_b64_tr_b16 v[170:171], v5 offset:3072
    ds_read_b64_tr_b16 v[172:173], v6 offset:2048
    ds_read_b64_tr_b16 v[174:175], v6 offset:3072
    v_bfe_u32 v240, v0, 3, 5
    v_and_b32 v241, 7, v0
    v_lshlrev_b32 v241, 4, v241
    s_lshl_b32 s63, s54, 7
    buffer_load_dwordx4 v[244:247], v241, s[32:35], s63 offen
    v_and_b32 v28, 31, v1
    v_bfe_u32 v29, v1, 1, 2
    v_and_b32 v30, 1, v1
    v_lshl_add_u32 v29, v30, 2, v29
    v_lshrrev_b32 v30, 5, v1
    v_xor_b32 v29, v29, v30
    v_lshlrev_b32 v29, 4, v29
    s_and_b32 s64, s47, 3
    s_lshl_b32 s64, s64, 12
    s_and_b32 s62, s47, 4
    s_lshl_b32 s62, s62, 14
    s_add_u32 s64, s64, s62
    v_lshl_add_u32 v248, v28, 7, v29
    v_add_u32 v248, s64, v248
    v_xor_b32 v249, 32, v248
    v_xor_b32 v250, 64, v248
    v_xor_b32 v251, 96, v248
    v_bfe_u32 v29, v240, 1, 2
    v_and_b32 v30, 1, v240
    v_lshl_add_u32 v29, v30, 2, v29
    v_and_b32 v30, 3, v0
    v_lshlrev_b32 v30, 1, v30
    v_xor_b32 v29, v29, v30
    v_lshlrev_b32 v28, 7, v240
    v_lshl_add_u32 v28, v29, 4, v28
    v_and_b32 v29, 4, v0
    v_lshlrev_b32 v29, 12, v29
    v_add_u32 v28, v28, v29
    v_xor_b32 v29, 16, v28
    v_add_u32 v30, 32768, v28
    v_xor_b32 v31, 16, v30
    v_lshlrev_b32 v242, 2, v240
    v_mul_u32_u24 v240, 896, v240
    v_add_u32 v240, v240, v241
    s_lshr_b32 s62, s53, 16
    s_mul_i32 s51, s62, 28672
    s_lshl_b32 s63, s54, 7
    s_add_u32 s51, s51, s63
    s_and_b32 s64, s2, 1
    s_lshl_b32 s64, s64, 2
    s_and_b32 s63, s47, 3
    s_add_u32 s64, s64, s63
    s_lshr_b32 s63, s62, 2
    s_lshl_b32 s63, s63, 3
    s_add_u32 s63, s63, s64
    s_lshl_b32 s63, s63, 2
    s_and_b32 s62, s62, 3
    s_add_u32 s63, s63, s62
    s_lshl_b32 s63, s63, 7
    s_add_u32 s60, s63, 0x1400000
    s_lshl_b32 s52, s2, 14
    s_lshl_b32 s62, s55, 1
    s_add_u32 s52, s52, s62
    s_add_u32 s52, s52, 0x1000000
    s_mov_b32 s20, 0x0c0c0400
    s_mov_b32 s21, 0x04000c0c
    s_mov_b32 s22, 0x0f0f0f0f
    s_bitcmp1_b32 s2, 0
    s_cselect_b32 s22, 0xf0f0f0f0, s22
    s_mov_b32 s23, s22
    s_waitcnt lgkmcnt(0)
    s_waitcnt vmcnt(8)
    v_mfma_f32_32x32x16_bf16 v[32:47], v[128:131], v[12:15], 0
    v_mfma_f32_32x32x16_bf16 v[96:111], v[132:135], v[12:15], 0
    s_lshl_b64 exec, 1, s47
    ds_write_b32 v9, v8 offset:48
    s_mov_b64 exec, -1
    buffer_load_dwordx4 v[188:191], v7, s[12:15], s57 offen offset:1024 sc1
    s_waitcnt vmcnt(7)
    v_mfma_f32_32x32x16_bf16 v[32:47], v[136:139], v[16:19], v[32:47]
    v_mfma_f32_32x32x16_bf16 v[96:111], v[140:143], v[16:19], v[96:111]
    s_waitcnt vmcnt(8)
    v_cmp_eq_u32 vcc, v10, v11
    s_nop 3
    s_cmp_eq_u64 vcc, exec
    s_cbranch_scc1 pd_73
    s_mov_b32 s3, 200000
pl_74:
    s_sleep 1
    buffer_load_dword v10, v2, s[12:15], s7 offen sc1
    s_waitcnt vmcnt(0)
    v_cmp_eq_u32 vcc, v10, v11
    s_nop 3
    s_cmp_eq_u64 vcc, exec
    s_cbranch_scc1 pd_73
    s_sub_u32 s3, s3, 1
    s_cbranch_scc0 pl_74
pd_73:
    s_add_u32 s7, s7, 65536
    v_or_b32 v2, 16, v2
    s_bfe_u32 s57, s46, 0x40010
    s_lshl_b32 s57, s57, 11
    s_add_u32 s57, s57, s56
    buffer_load_dwordx4 v[192:195], v7, s[12:15], s57 offen offset:0 sc1
    s_waitcnt vmcnt(7)
    v_mfma_f32_32x32x16_bf16 v[32:47], v[144:147], v[20:23], v[32:47]
    v_mfma_f32_32x32x16_bf16 v[96:111], v[148:151], v[20:23], v[96:111]
    v_add_u32 v5, 65536, v4
    v_xor_b32 v6, 64, v5
    ds_read_b64_tr_b16 v[128:129], v5 offset:0
    ds_read_b64_tr_b16 v[130:131], v5 offset:1024
    ds_read_b64_tr_b16 v[132:133], v6 offset:0
    ds_read_b64_tr_b16 v[134:135], v6 offset:1024
    ds_read_b64_tr_b16 v[136:137], v5 offset:2048
    ds_read_b64_tr_b16 v[138:139], v5 offset:3072
    ds_read_b64_tr_b16 v[140:141], v6 offset:2048
    ds_read_b64_tr_b16 v[142:143], v6 offset:3072
    buffer_load_dwordx4 v[196:199], v7, s[12:15], s57 offen offset:1024 sc1
    s_waitcnt vmcnt(7)
    v_mfma_f32_32x32x16_bf16 v[32:47], v[152:155], v[24:27], v[32:47]
    v_mfma_f32_32x32x16_bf16 v[96:111], v[156:159], v[24:27], v[96:111]
    s_bfe_u32 s57, s46, 0x40014
    s_lshl_b32 s57, s57, 11
    s_add_u32 s57, s57, s56
    buffer_load_dwordx4 v[200:203], v7, s[12:15], s57 offen offset:0 sc1
    s_waitcnt vmcnt(7)
    v_mfma_f32_32x32x16_bf16 v[32:47], v[160:163], v[176:179], v[32:47]
    v_mfma_f32_32x32x16_bf16 v[96:111], v[164:167], v[176:179], v[96:111]
    v_add_u32 v5, 81920, v4
    v_xor_b32 v6, 64, v5
    ds_read_b64_tr_b16 v[144:145], v5 offset:0
    ds_read_b64_tr_b16 v[146:147], v5 offset:1024
    ds_read_b64_tr_b16 v[148:149], v6 offset:0
    ds_read_b64_tr_b16 v[150:151], v6 offset:1024
    ds_read_b64_tr_b16 v[152:153], v5 offset:2048
    ds_read_b64_tr_b16 v[154:155], v5 offset:3072
    ds_read_b64_tr_b16 v[156:157], v6 offset:2048
    ds_read_b64_tr_b16 v[158:159], v6 offset:3072
    buffer_load_dwordx4 v[204:207], v7, s[12:15], s57 offen offset:1024 sc1
    s_waitcnt vmcnt(7)
    v_mfma_f32_32x32x16_bf16 v[32:47], v[168:171], v[180:183], v[32:47]
    v_mfma_f32_32x32x16_bf16 v[96:111], v[172:175], v[180:183], v[96:111]
    s_bfe_u32 s57, s46, 0x40018
    s_lshl_b32 s57, s57, 11
    s_add_u32 s57, s57, s56
    buffer_load_dwordx4 v[12:15], v7, s[12:15], s57 offen offset:0 sc1
    s_waitcnt lgkmcnt(0)
    s_waitcnt vmcnt(7)
    v_mfma_f32_32x32x16_bf16 v[32:47], v[128:131], v[184:187], v[32:47]
    v_mfma_f32_32x32x16_bf16 v[96:111], v[132:135], v[184:187], v[96:111]
    v_add_u32 v5, 98304, v4
    v_xor_b32 v6, 64, v5
    ds_read_b64_tr_b16 v[160:161], v5 offset:0
    ds_read_b64_tr_b16 v[162:163], v5 offset:1024
    ds_read_b64_tr_b16 v[164:165], v6 offset:0
    ds_read_b64_tr_b16 v[166:167], v6 offset:1024
    ds_read_b64_tr_b16 v[168:169], v5 offset:2048
    ds_read_b64_tr_b16 v[170:171], v5 offset:3072
    ds_read_b64_tr_b16 v[172:173], v6 offset:2048
    ds_read_b64_tr_b16 v[174:175], v6 offset:3072
    buffer_load_dwordx4 v[16:19], v7, s[12:15], s57 offen offset:1024 sc1
    buffer_load_dword v3, v2, s[12:15], s7 offen sc1
    s_waitcnt vmcnt(7)
    v_mfma_f32_32x32x16_bf16 v[32:47], v[136:139], v[188:191], v[32:47]
    v_mfma_f32_32x32x16_bf16 v[96:111], v[140:143], v[188:191], v[96:111]
    s_waitcnt vmcnt(0)
    v_cmp_eq_u32 vcc, v3, v11
    s_nop 3
    s_cmp_eq_u64 vcc, exec
    s_cbranch_scc0 oc_75
    s_call_b64 s[18:19], o_issue1
    s_branch oc_76
oc_75:
    buffer_load_dword v3, v2, s[12:15], s7 offen sc1
oc_76:
    s_waitcnt lgkmcnt(0)
    v_mfma_f32_32x32x16_bf16 v[32:47], v[144:147], v[192:195], v[32:47]
    v_mfma_f32_32x32x16_bf16 v[96:111], v[148:151], v[192:195], v[96:111]
    v_add_u32 v5, 114688, v4
    v_xor_b32 v6, 64, v5
    ds_read_b64_tr_b16 v[128:129], v5 offset:0
    ds_read_b64_tr_b16 v[130:131], v5 offset:1024
    ds_read_b64_tr_b16 v[132:133], v6 offset:0
    ds_read_b64_tr_b16 v[134:135], v6 offset:1024
    ds_read_b64_tr_b16 v[136:137], v5 offset:2048
    ds_read_b64_tr_b16 v[138:139], v5 offset:3072
    ds_read_b64_tr_b16 v[140:141], v6 offset:2048
    ds_read_b64_tr_b16 v[142:143], v6 offset:3072
    v_mfma_f32_32x32x16_bf16 v[32:47], v[152:155], v[196:199], v[32:47]
    v_mfma_f32_32x32x16_bf16 v[96:111], v[156:159], v[196:199], v[96:111]
    s_waitcnt lgkmcnt(0)
    v_mfma_f32_32x32x16_bf16 v[32:47], v[160:163], v[200:203], v[32:47]
    v_mfma_f32_32x32x16_bf16 v[96:111], v[164:167], v[200:203], v[96:111]
    v_mfma_f32_32x32x16_bf16 v[32:47], v[168:171], v[204:207], v[32:47]
    v_mfma_f32_32x32x16_bf16 v[96:111], v[172:175], v[204:207], v[96:111]
    s_cmp_eq_u32 s61, 0
    s_cbranch_scc0 oc_77
    s_waitcnt vmcnt(0)
    v_cmp_eq_u32 vcc, v3, v11
    s_nop 3
    s_cmp_eq_u64 vcc, exec
    s_cbranch_scc0 oc_77
    s_call_b64 s[18:19], o_issue1
oc_77:
    s_waitcnt lgkmcnt(0)
    v_mfma_f32_32x32x16_bf16 v[32:47], v[128:131], v[12:15], v[32:47]
    v_mfma_f32_32x32x16_bf16 v[96:111], v[132:135], v[12:15], v[96:111]
    s_mov_b32 s3, 2000000
cw_78:
    ds_read_b32 v6, v9 offset:16
    s_waitcnt lgkmcnt(0)
    v_cmp_eq_u32 vcc, v8, v6
    s_nop 3
    s_cmp_eq_u64 vcc, exec
    s_cbranch_scc1 cw_79
    s_sub_u32 s3, s3, 1
    s_cbranch_scc0 cw_78
cw_79:
    v_mfma_f32_32x32x16_bf16 v[32:47], v[136:139], v[16:19], v[32:47]
    v_mfma_f32_32x32x16_bf16 v[96:111], v[140:143], v[16:19], v[96:111]
    s_cmp_eq_u32 s61, 0
    s_cbranch_scc0 oh_80
    buffer_load_dword v10, v2, s[12:15], s7 offen sc1
    s_waitcnt vmcnt(0)
    v_cmp_eq_u32 vcc, v10, v11
    s_nop 3
    s_cmp_eq_u64 vcc, exec
    s_cbranch_scc1 pd_81
    s_mov_b32 s3, 200000
pl_82:
    s_sleep 1
    buffer_load_dword v10, v2, s[12:15], s7 offen sc1
    s_waitcnt vmcnt(0)
    v_cmp_eq_u32 vcc, v10, v11
    s_nop 3
    s_cmp_eq_u64 vcc, exec
    s_cbranch_scc1 pd_81
    s_sub_u32 s3, s3, 1
    s_cbranch_scc0 pl_82
pd_81:
    s_call_b64 s[18:19], o_issue1
oh_80:
    s_waitcnt vmcnt(0) lgkmcnt(0)
    v_mfma_f32_32x32x16_bf16 v[32:47], v[64:67], v[208:211], v[32:47]
    v_mfma_f32_32x32x16_bf16 v[32:47], v[72:75], v[212:215], v[32:47]
    v_mfma_f32_32x32x16_bf16 v[32:47], v[80:83], v[216:219], v[32:47]
    v_mfma_f32_32x32x16_bf16 v[32:47], v[88:91], v[220:223], v[32:47]
    v_lshlrev_b32 v136, 16, v244
    v_and_b32 v137, 0xffff0000, v244
    v_lshlrev_b32 v138, 16, v245
    v_and_b32 v139, 0xffff0000, v245
    v_lshlrev_b32 v140, 16, v246
    v_and_b32 v141, 0xffff0000, v246
    v_lshlrev_b32 v142, 16, v247
    v_and_b32 v143, 0xffff0000, v247
    v_mfma_f32_32x32x16_bf16 v[96:111], v[68:71], v[208:211], v[96:111]
    v_mfma_f32_32x32x16_bf16 v[96:111], v[76:79], v[212:215], v[96:111]
    v_mfma_f32_32x32x16_bf16 v[96:111], v[84:87], v[216:219], v[96:111]
    v_mfma_f32_32x32x16_bf16 v[96:111], v[92:95], v[220:223], v[96:111]
    ds_write_b128 v248, v[32:35]
    ds_write_b128 v249, v[36:39]
    ds_write_b128 v250, v[40:43]
    ds_write_b128 v251, v[44:47]
    s_nop 7
    ds_write_b128 v248, v[96:99] offset:16384
    ds_write_b128 v249, v[100:103] offset:16384
    ds_write_b128 v250, v[104:107] offset:16384
    ds_write_b128 v251, v[108:111] offset:16384
join_f:
    s_waitcnt lgkmcnt(0)
    s_barrier
    buffer_load_dword v252, v242, s[12:15], s60 offen sc1
    ds_read_b128 v[208:211], v30 offset:0
    ds_read_b128 v[212:215], v31 offset:0
    ds_read_b128 v[216:219], v30 offset:4096
    ds_read_b128 v[220:223], v31 offset:4096
    ds_read_b128 v[224:227], v30 offset:8192
    ds_read_b128 v[228:231], v31 offset:8192
    ds_read_b128 v[232:235], v30 offset:12288
    ds_read_b128 v[236:239], v31 offset:12288
    s_waitcnt lgkmcnt(6)
    v_pk_add_f32 v[136:137], v[136:137], v[208:209]
    v_pk_add_f32 v[138:139], v[138:139], v[210:211]
    v_pk_add_f32 v[140:141], v[140:141], v[212:213]
    v_pk_add_f32 v[142:143], v[142:143], v[214:215]
    s_waitcnt lgkmcnt(4)
    v_pk_add_f32 v[136:137], v[136:137], v[216:217]
    v_pk_add_f32 v[138:139], v[138:139], v[218:219]
    v_pk_add_f32 v[140:141], v[140:141], v[220:221]
    v_pk_add_f32 v[142:143], v[142:143], v[222:223]
    s_waitcnt lgkmcnt(2)
    v_pk_add_f32 v[136:137], v[136:137], v[224:225]
    v_pk_add_f32 v[138:139], v[138:139], v[226:227]
    v_pk_add_f32 v[140:141], v[140:141], v[228:229]
    v_pk_add_f32 v[142:143], v[142:143], v[230:231]
    s_waitcnt lgkmcnt(0)
    v_pk_add_f32 v[136:137], v[136:137], v[232:233]
    v_pk_add_f32 v[138:139], v[138:139], v[234:235]
    v_pk_add_f32 v[140:141], v[140:141], v[236:237]
    v_pk_add_f32 v[142:143], v[142:143], v[238:239]
    s_waitcnt vmcnt(0)
    buffer_load_dwordx4 v[128:131], v7, s[12:15], s52 offen offset:0 sc1
    buffer_load_dwordx4 v[132:135], v7, s[12:15], s52 offen offset:1024 sc1
    s_waitcnt vmcnt(0)
    v_perm_b32 v72, v129, v128, s20
    v_perm_b32 v73, v131, v130, s21
    v_or_b32 v72, v72, v73
    v_xor_b32 v74, v72, v11
    v_perm_b32 v72, v133, v132, s20
    v_perm_b32 v73, v135, v134, s21
    v_or_b32 v72, v72, v73
    v_xor_b32 v75, v72, v11
    v_or_b32 v74, v74, v75
    v_cmp_eq_u32 vcc, 0, v74
    s_nop 3
    s_cmp_eq_u64 vcc, exec
    s_cbranch_scc1 pd_83
    s_mov_b32 s3, 200000
pl_84:
    s_sleep 1
    buffer_load_dwordx4 v[128:131], v7, s[12:15], s52 offen offset:0 sc1
    buffer_load_dwordx4 v[132:135], v7, s[12:15], s52 offen offset:1024 sc1
    s_waitcnt vmcnt(0)
    v_perm_b32 v72, v129, v128, s20
    v_perm_b32 v73, v131, v130, s21
    v_or_b32 v72, v72, v73
    v_xor_b32 v74, v72, v11
    v_perm_b32 v72, v133, v132, s20
    v_perm_b32 v73, v135, v134, s21
    v_or_b32 v72, v72, v73
    v_xor_b32 v75, v72, v11
    v_or_b32 v74, v74, v75
    v_cmp_eq_u32 vcc, 0, v74
    s_nop 3
    s_cmp_eq_u64 vcc, exec
    s_cbranch_scc1 pd_83
    s_sub_u32 s3, s3, 1
    s_cbranch_scc0 pl_84
pd_83:
    v_pk_add_f32 v[136:137], v[136:137], v[128:129]
    v_pk_add_f32 v[138:139], v[138:139], v[130:131]
    v_pk_add_f32 v[140:141], v[140:141], v[132:133]
    v_pk_add_f32 v[142:143], v[142:143], v[134:135]
    v_pk_mul_f32 v[136:137], v[136:137], v[252:253] op_sel_hi:[1,0]
    v_pk_mul_f32 v[138:139], v[138:139], v[252:253] op_sel_hi:[1,0]
    v_pk_mul_f32 v[140:141], v[140:141], v[252:253] op_sel_hi:[1,0]
    v_pk_mul_f32 v[142:143], v[142:143], v[252:253] op_sel_hi:[1,0]
    v_cvt_pk_bf16_f32 v136, v136, v137
    v_cvt_pk_bf16_f32 v137, v138, v139
    v_cvt_pk_bf16_f32 v138, v140, v141
    v_cvt_pk_bf16_f32 v139, v142, v143
    s_mov_b64 exec, s[22:23]
    buffer_store_dwordx4 v[136:139], v240, s[36:39], s51 offen
    s_mov_b64 exec, -1
attn_exit:
the_end:
    s_endpgm
o_issue:
    buffer_load_dwordx4 v[224:227], v7, s[12:15], s59 offen offset:0 sc1
    buffer_load_dwordx4 v[228:231], v7, s[12:15], s59 offen offset:1024 sc1
    buffer_load_dwordx4 v[232:235], v7, s[12:15], s59 offen offset:2048 sc1
    buffer_load_dwordx4 v[236:239], v7, s[12:15], s59 offen offset:3072 sc1
o_issue1:
    buffer_load_dwordx4 v[208:211], v7, s[12:15], s58 offen offset:0 sc1
    buffer_load_dwordx4 v[212:215], v7, s[12:15], s58 offen offset:1024 sc1
    buffer_load_dwordx4 v[216:219], v7, s[12:15], s58 offen offset:2048 sc1
    buffer_load_dwordx4 v[220:223], v7, s[12:15], s58 offen offset:3072 sc1
    v_add_u32 v5, 131072, v4
    v_xor_b32 v6, 64, v5
    ds_read_b64_tr_b16 v[64:65], v5 offset:0
    ds_read_b64_tr_b16 v[66:67], v5 offset:1024
    ds_read_b64_tr_b16 v[68:69], v6 offset:0
    ds_read_b64_tr_b16 v[70:71], v6 offset:1024
    ds_read_b64_tr_b16 v[72:73], v5 offset:2048
    ds_read_b64_tr_b16 v[74:75], v5 offset:3072
    ds_read_b64_tr_b16 v[76:77], v6 offset:2048
    ds_read_b64_tr_b16 v[78:79], v6 offset:3072
    v_add_u32 v5, 147456, v4
    v_xor_b32 v6, 64, v5
    ds_read_b64_tr_b16 v[80:81], v5 offset:0
    ds_read_b64_tr_b16 v[82:83], v5 offset:1024
    ds_read_b64_tr_b16 v[84:85], v6 offset:0
    ds_read_b64_tr_b16 v[86:87], v6 offset:1024
    ds_read_b64_tr_b16 v[88:89], v5 offset:2048
    ds_read_b64_tr_b16 v[90:91], v5 offset:3072
    ds_read_b64_tr_b16 v[92:93], v6 offset:2048
    ds_read_b64_tr_b16 v[94:95], v6 offset:3072
    s_mov_b32 s61, 1
    s_setpc_b64 s[18:19]
o_flag:
    s_mov_b64 exec, 1
    s_cmp_eq_u32 s66, 1
    s_cbranch_scc1 hs_85
    buffer_store_dword v11, off, s[12:15], s6 sc1
    s_branch hs_86
hs_85:
    buffer_store_dword v11, off, s[12:15], s6
hs_86:
    s_mov_b64 exec, -1
    s_mov_b32 s67, 2
    s_setpc_b64 s[18:19]
code_end:
.section .rodata,"a"
.p2align 6
.amdhsa_kernel gated_mix__linear_kernel_hedgehog__dense_activation_gelu__prompt_kernel
  .amdhsa_next_free_vgpr 256
  .amdhsa_next_free_sgpr 102
  .amdhsa_accum_offset 256
  .amdhsa_group_segment_fixed_size 0
  .amdhsa_kernarg_size 104
  .amdhsa_user_sgpr_count 2
  .amdhsa_user_sgpr_kernarg_segment_ptr 1
  .amdhsa_system_sgpr_workgroup_id_x 1
  .amdhsa_float_denorm_mode_32 3
.end_amdhsa_kernel
```
